```python
import torch

def _softmax(x, axis=-1):
    return torch.softmax(x, dim=axis)
def _gelu(x):
    return torch.nn.functional.gelu(x, approximate="tanh")
def _silu(x):
    return torch.nn.functional.silu(x)
def _sigmoid(x):
    return torch.sigmoid(x)
def _layernorm(x, axis=-1, eps=1e-5):
    m = x.mean(dim=axis, keepdim=True)
    v = x.var(dim=axis, keepdim=True, unbiased=False)
    return (x - m) / torch.sqrt(v + eps)
def _scatter_add(tgt, idx, src, axis=0):
    return tgt.clone().index_add_(axis, idx, src)
def _segment_sum(src, seg, n):
    out = torch.zeros((n,) + src.shape[1:], dtype=src.dtype)
    return out.index_add_(0, seg, src)
def _pad(x, pw):
    flat = tuple(v for pair in reversed(pw) for v in pair)
    return torch.nn.functional.pad(x, flat)

kernel_name = 'sequential_preLN__ssm_conv_h3__glu_gated_reglu__prompt'

def setup_inputs():

    _w = (lambda a: (lambda t: t.to(torch.bfloat16) if t.is_floating_point() else t)(torch.as_tensor(a)))
    def _A_setup():
        B, S, D = 1, 2048, 576
        ks = 4
        return {
            "q": _w((lambda *s: torch.randn(*s, dtype=torch.bfloat16) * 0.05)(B, S, D)),
            "k": _w((lambda *s: torch.randn(*s, dtype=torch.bfloat16) * 0.2)(B, S, D)),
            "v": _w((lambda *s: torch.randn(*s, dtype=torch.bfloat16) * 0.2)(B, S, D)),
            "shift_k": _w((lambda *s: torch.randn(*s, dtype=torch.bfloat16) * 0.2)(D, ks) * 0.5),
            "ssm_k": _w((lambda *s: torch.randn(*s, dtype=torch.bfloat16) * 0.4)(D, S) * (1.0 / S ** 0.5)),
            "ssm_D": _w((lambda *s: torch.randn(*s, dtype=torch.bfloat16) * 0.2)(D)),
        }
    _A_in = _A_setup()

    def _B_setup():
        B, S, D, F = 1, 2048, 576, 4608
        return {
            "x": _w((lambda *s: torch.randn(*s, dtype=torch.bfloat16) * 0.05)(B, S, D)),
            "W_gate": _w((lambda *s: torch.randn(*s, dtype=torch.bfloat16) * 0.2)(D, F) * (2.0 / D) ** 0.5),
            "W_up": _w((lambda *s: torch.randn(*s, dtype=torch.bfloat16) * 0.2)(D, F) * (2.0 / D) ** 0.5),
            "W_down": _w((lambda *s: torch.randn(*s, dtype=torch.bfloat16) * 0.2)(F, D) * (1.0 / F) ** 0.5),
        }
    _B_in = _B_setup()

    return {
        "A_q": _A_in["q"],
        "A_k": _A_in["k"],
        "A_v": _A_in["v"],
        "A_shift_k": _A_in["shift_k"],
        "A_ssm_k": _A_in["ssm_k"],
        "A_ssm_D": _A_in["ssm_D"],
        "B_x": _B_in["x"],
        "B_W_gate": _B_in["W_gate"],
        "B_W_up": _B_in["W_up"],
        "B_W_down": _B_in["W_down"],
    }

def reference(A_q, A_k, A_v, A_shift_k, A_ssm_k, A_ssm_D, B_x, B_W_gate, B_W_up, B_W_down):
    def _A_ref(q, k, v, shift_k, ssm_k, ssm_D):
        B, S, D = q.shape
        ks = shift_k.shape[-1]
        k_pad = _pad(k, ((0, 0), (ks - 1, 0), (0, 0)))
        k_shift = torch.zeros_like(k)
        for t in range(ks):
            k_shift = k_shift + k_pad[:, t:t + S, :] * shift_k[:, ks - 1 - t][None, None, :]
        kv = k_shift * v
        L = 2 * S
        kv_pad = _pad(kv, ((0, 0), (0, S), (0, 0)))
        kf_pad = _pad(ssm_k, ((0, 0), (0, S)))
        kv_f = (lambda x, axes=(-2,-1): torch.fft.rfft2(x.float(), dim=axes))(kv_pad[:, None, :, :], axes=(1, 2))
        kf_f = (lambda x, axes=(-2,-1): torch.fft.rfft2(x.float(), dim=axes))(kf_pad[:, None, :], axes=(1, 2))
        kf_f = (lambda x, *d: x.permute(*d))(kf_f, 1, 2, 0)
        y_f = kv_f * kf_f[None, :, :, :]
        y = (lambda x, s, axes=(-2,-1): torch.fft.irfft2(x, s=s, dim=axes).to(torch.bfloat16))(y_f, (1, L), axes=(1, 2))[:, 0, :S, :]
        y = y + kv * ssm_D[None, None, :]
        return q * y

    def _B_ref(x, W_gate, W_up, W_down):
        gate = torch.einsum("bsd,df->bsf", x, W_gate)
        up = torch.einsum("bsd,df->bsf", x, W_up)
        gate = gate * (lambda x, dt: x.to(dt))(gate > 0, gate.dtype)
        h = gate * up
        return torch.einsum("bsf,fd->bsd", h, W_down)

    x = A_q
    h = x + _A_ref(_layernorm(x, axis=-1), A_k, A_v, A_shift_k, A_ssm_k, A_ssm_D)
    h2 = h + _B_ref(_layernorm(h, axis=-1), B_W_gate, B_W_up, B_W_down)
    return h2
```

```asm
; @launch kernel=k4_kernel grid=(256,1,1) block=(256,1,1) lds=163840
.amdgcn_target "amdgcn-amd-amdhsa--gfx950"
.text
.globl k4_kernel
.p2align 12
.type k4_kernel,@function
k4_kernel:
    s_cmp_ge_u32 s2, 256
    s_cbranch_scc1 K4_end
    s_load_dwordx2 s[36:37], s[0:1], 8
    s_load_dwordx2 s[64:65], s[0:1], 16
    s_load_dwordx2 s[24:25], s[0:1], 96
    s_load_dwordx2 s[56:57], s[0:1], 24
    s_load_dwordx2 s[52:53], s[0:1], 32
    s_load_dwordx2 s[28:29], s[0:1], 0
    s_load_dwordx2 s[10:11], s[0:1], 96
    s_load_dwordx2 s[50:51], s[0:1], 40
    s_load_dwordx4 s[68:71], s[0:1], 72
    s_load_dwordx4 s[4:7], s[0:1], 56
    s_getpc_b64 s[58:59]
K4_pc:
    s_lshr_b32 s13, s2, 3
    s_lshl_b32 s13, s13, 11
    s_movk_i32 s14, 80
    v_lshrrev_b32 v3, 6, v0
    v_mul_u32_u24 v3, s13, v3
    v_lshl_add_u32 v2, v0, 7, v3
    v_cmp_gt_u32 vcc, CODE_END - K4_pc - 4, v2
    v_cmp_gt_u32 s[60:61], s14, v0
    s_and_b64 exec, vcc, s[60:61]
    s_cbranch_execz K4_pcx
    global_load_dword v127, v2, s[58:59]
K4_pcx:
    s_mov_b64 exec, -1
    s_and_b32 s12, s2, 7
    s_lshr_b32 s13, s2, 3
    v_and_b32 v128, 7, v0
    v_lshrrev_b32 v129, 3, v0
    s_mul_i32 s14, s13, 73728
    s_lshl_b32 s15, s12, 7
    s_add_u32 s14, s14, s15
    v_lshrrev_b32 v1, 6, v0
    s_nop 0
    v_readfirstlane_b32 s3, v1
    v_mul_u32_u24 v104, 2304, v129
    v_lshl_add_u32 v104, v128, 4, v104
    v_add_u32 v104, s14, v104
    v_subrev_u32 v105, 3456, v104
    v_subrev_u32 v106, 2304, v104
    v_subrev_u32 v107, 1152, v104
    s_mov_b32 s38, 2359296
    s_mov_b32 s39, 0x00020000
    s_mov_b32 s66, 2359296
    s_mov_b32 s67, 0x00020000
    s_mov_b32 s26, 58720256
    s_mov_b32 s27, 0x00020000
    s_mov_b32 s58, 4608
    s_mov_b32 s59, 0x00020000
    s_lshl_b32 s8, s12, 2
    s_lshr_b32 s9, s13, 3
    s_add_u32 s8, s8, s9
    s_and_b32 s9, s13, 7
    s_lshl_b32 s15, s12, 9
    v_lshl_add_u32 v122, v128, 6, s15
    v_mov_b32 v24, -1
    v_mov_b32 v25, -1
    v_mov_b32 v26, -1
    v_mov_b32 v27, -1
    s_lshl_b32 s15, s12, 18
    s_lshl_b32 s14, s13, 7
    s_sub_u32 s15, s15, s14
    s_add_u32 s15, s15, 8392576
    v_lshlrev_b32 v109, 12, v129
    v_lshl_add_u32 v109, v128, 4, v109
    v_add_u32 v109, s15, v109
    v_add_u32 v110, 0x20000, v109
    v_and_b32 v108, 1, v129
    v_lshl_add_u32 v108, s3, 1, v108
    s_lshl_b32 s15, s9, 15
    s_lshl_b32 s14, s8, 7
    s_sub_u32 s15, s15, s14
    s_add_u32 s15, s15, 10489728
    v_lshlrev_b32 v111, 12, v108
    v_lshl_add_u32 v111, v128, 4, v111
    v_add_u32 v111, s15, v111
    v_bfe_u32 v2, v0, 4, 2
    v_lshl_add_u32 v111, v2, 28, v111
    s_waitcnt lgkmcnt(0)
    buffer_load_dwordx4 v[32:35], v105, s[36:39], 0 offen
    buffer_load_dwordx4 v[36:39], v106, s[36:39], 0 offen
    buffer_load_dwordx4 v[52:55], v104, s[64:67], 0 offen offset:0
    buffer_load_dwordx4 v[56:59], v104, s[64:67], 0 offen offset:1152
    buffer_load_dwordx4 v[60:63], v122, s[56:59], 0 offen offset:0
    buffer_load_dwordx4 v[48:51], v104, s[36:39], 0 offen offset:1152
    buffer_load_dwordx4 v[40:43], v107, s[36:39], 0 offen
    buffer_load_dwordx4 v[44:47], v104, s[36:39], 0 offen
    buffer_load_dwordx4 v[64:67], v122, s[56:59], 0 offen offset:16
    buffer_load_dwordx4 v[68:71], v122, s[56:59], 0 offen offset:32
    buffer_load_dwordx4 v[72:75], v122, s[56:59], 0 offen offset:48
    v_bfrev_b32 v20, 2
    s_lshl_b32 s42, s3, 10
    buffer_store_dwordx4 v[24:27], v109, s[24:27], 0 offen sc1
    buffer_store_dwordx4 v[24:27], v110, s[24:27], 0 offen sc1
    buffer_store_dwordx4 v[24:27], v111, s[24:27], 0 offen sc1
    s_mov_b32 s54, 2359296
    s_mov_b32 s55, 0x00020000
    s_mov_b32 s30, 2359296
    s_mov_b32 s31, 0x00020000
    s_lshl_b32 s44, s12, 5
    s_add_u32 s62, s44, s13
    s_lshl_b32 s76, s62, 13
    s_add_u32 s77, s76, 4096
    s_lshr_b32 s46, s62, 2
    s_add_u32 s46, s46, 512
    s_lshl_b32 s47, s62, 2
    s_load_dword s17, s[50:51], s47
    s_lshl_b32 s47, s46, 1
    s_and_b32 s47, s47, -4
    s_load_dword s18, s[50:51], s47
    s_add_u32 s50, s10, 47255552
    s_addc_u32 s51, s11, 0
    s_load_dword s16, s[50:51], 0
    s_lshl_b32 s22, s46, 6
    s_lshl_b32 s78, s46, 12
    v_lshlrev_b32 v28, 4, v0
    v_subrev_u32 v167, 16, v28
    v_min_u32 v167, v167, v20
    s_add_u32 s19, s76, 8388608
    s_add_u32 s20, s77, 8388608
    s_add_u32 s21, s78, 8388608
    s_mul_i32 s63, s62, 9216
    s_mov_b32 s101, 32768
    s_mov_b32 s34, 0xfffefffe
    s_mov_b32 s35, 90112
    v_sub_u32 v104, 31, v129
    v_lshlrev_b32 v105, 2, v128
    v_xor_b32 v104, v104, v105
    v_lshlrev_b32 v104, 2, v104
    v_add_u32 v104, 115200, v104
    v_lshl_add_u32 v105, v128, 7, v104
    v_lshl_add_u32 v104, v128, 10, v104
    v_xor_b32 v106, s3, v128
    v_lshlrev_b32 v106, 4, v106
    v_lshl_add_u32 v106, v129, 7, v106
    v_add_u32 v106, 115200, v106
    v_xor_b32 v107, 64, v106
    v_xor_b32 v2, v108, v128
    v_lshlrev_b32 v2, 4, v2
    v_lshl_add_u32 v108, v108, 7, v2
    v_add_u32 v108, 123392, v108
    v_lshrrev_b32 v2, 5, v0
    v_min_u32 v2, 2, v2
    v_lshl_add_u32 v2, v2, 12, v28
    v_add_u32 v2, 103936, v2
    v_subrev_u32 v3, 192, v0
    v_min_u32 v3, 23, v3
    v_mul_u32_u24 v3, 4160, v3
    v_cmp_gt_u32 vcc, 192, v0
    v_mov_b32 v76, 0
    v_mov_b32 v77, 0
    v_mov_b32 v78, 0
    v_mov_b32 v79, 0
    v_cndmask_b32 v2, v3, v2, vcc
    ds_write_b128 v2, v[76:79]
    s_add_u32 s72, s10, 47185920
    s_addc_u32 s73, s11, 0
    s_mov_b32 s74, 131072
    s_mov_b32 s75, 0x00020000
    s_mov_b32 s79, 262144
    v_lshlrev_b32 v166, 7, v0
    v_add_u32 v166, 4096, v166
    v_lshlrev_b32 v136, 5, v128
    v_add_u32 v136, 157184, v136
    s_lshl_b32 s14, s3, 3
    v_add_u32 v135, s14, v136
    s_lshl_b32 s14, s62, 7
    s_add_u32 s14, s14, 4096
    v_lshl_add_u32 v140, v129, 24, v28
    v_add_u32 v140, s14, v140
    v_and_b32 v126, 0x13, v129
    v_bfe_u32 v2, v129, 2, 1
    v_lshl_add_u32 v126, v2, 3, v126
    v_bfe_u32 v2, v129, 3, 1
    v_lshl_add_u32 v126, v2, 2, v126
    v_lshlrev_b32 v126, 5, v126
    v_bfe_u32 v2, v128, 1, 1
    v_lshl_add_u32 v126, v2, 11, v126
    v_lshrrev_b32 v2, 2, v128
    v_mul_u32_u24 v2, 294912, v2
    v_add_u32 v126, v2, v126
    v_and_b32 v2, 1, v128
    v_lshl_add_u32 v126, v2, 4, v126
    s_lshr_b32 s49, s2, 1
    s_lshl_b32 s49, s49, 12
    s_and_b32 s48, s2, 1
    s_lshl_b32 s48, s48, 10
    s_add_u32 s49, s49, s48
    s_cmp_ge_u32 s2, 144
    s_cselect_b32 s49, 589824, s49
    v_add_u32 v126, s49, v126
    s_lshl_b32 s46, s3, 3
    s_sub_u32 s46, 24, s46
    v_add_u32 v2, s46, v128
    v_lshl_add_u32 v123, v2, 3, s12
    s_lshl_b32 s46, s12, 5
    v_add_u32 v2, s46, v2
    v_and_b32 v3, 8, v0
    v_cmp_eq_u32 vcc, 0, v3
    s_nop 1
    v_cndmask_b32 v123, v123, v2, vcc
    v_lshlrev_b32 v123, 7, v123
    v_add_u32 v123, 4096, v123
    v_and_b32 v1, 63, v0
    v_lshlrev_b32 v4, 4, v1
    v_and_b32 v2, 15, v0
    v_bfe_u32 v3, v0, 4, 2
    v_mul_u32_u24 v162, 4160, v128
    v_lshrrev_b32 v5, 3, v2
    v_add_u32 v5, v5, v3
    v_lshl_add_u32 v162, v5, 4, v162
    s_lshr_b32 s44, s3, 1
    s_and_b32 s45, s3, 1
    s_lshl_b32 s46, s45, 8
    s_mul_i32 s47, s44, 33280
    s_add_u32 s47, s47, s46
    v_add_u32 v142, s47, v162
    s_lshl_b32 s48, s3, 7
    s_add_u32 s47, s48, 66560
    v_add_u32 v162, s47, v162
    v_lshlrev_b32 v6, 4, v3
    v_lshlrev_b32 v7, 5, v2
    v_sub_u32 v6, v6, v7
    s_mul_i32 s47, s44, 4608
    s_add_u32 s47, s47, s46
    s_add_u32 s47, s47, 100320
    v_add_u32 v143, s47, v6
    s_and_b32 s49, s13, 3
    s_lshl_b32 s47, s49, 9
    s_add_u32 s46, s48, s47
    s_add_u32 s46, s46, 109536
    v_add_u32 v163, s46, v6
    s_sub_u32 s46, s48, s47
    s_add_u32 s46, s46, 113120
    v_add_u32 v182, s46, v6
    s_mov_b32 s23, 589824
    s_mul_i32 s46, s3, 6144
    s_add_u32 s46, s46, 124416
    v_add_u32 v183, s46, v4
    s_xor_b32 s46, s3, 1
    s_mul_i32 s46, s46, 6144
    s_add_u32 s46, s46, 124416
    v_add_u32 v202, s46, v4
    v_bfe_u32 v6, v0, 2, 2
    v_mul_u32_u24 v7, 6144, v6
    v_and_b32 v8, 3, v0
    v_lshl_add_u32 v7, v8, 4, v7
    v_lshl_add_u32 v7, v3, 6, v7
    s_lshl_b32 s46, s3, 9
    s_add_u32 s46, s46, 128512
    v_add_u32 v203, s46, v7
    v_mul_u32_u24 v165, 73728, v3
    v_lshl_add_u32 v165, v8, 4, v165
    v_lshl_add_u32 v165, v6, 28, v165
    s_sub_u32 s46, 7, s49
    s_cmp_eq_u32 s44, 0
    s_cselect_b32 s46, s46, s49
    s_lshl_b32 s46, s46, 3
    s_add_u32 s46, s46, s45
    s_mul_i32 s46, s46, 36864
    s_add_u32 s46, s46, s22
    s_add_u32 s46, s46, 12582912
    v_add_u32 v165, s46, v165
    v_lshrrev_b32 v7, 1, v3
    v_lshl_add_u32 v6, v6, 1, v7
    v_and_b32 v7, 1, v3
    v_lshl_add_u32 v6, v7, 3, v6
    v_mul_u32_u24 v164, 36864, v6
    v_lshl_add_u32 v164, v8, 4, v164
    s_mul_i32 s46, s45, 1179648
    s_lshl_b32 s47, s62, 7
    s_add_u32 s46, s46, s47
    s_lshl_b32 s47, s44, 6
    s_add_u32 s46, s46, s47
    s_add_u32 s46, s46, 12582912
    v_add_u32 v164, s46, v164
    s_lshr_b32 s46, s62, 3
    s_lshl_b32 s46, s46, 1
    s_and_b32 s47, s62, 1
    s_add_u32 s46, s46, s47
    s_mul_i32 s46, s46, 36864
    s_and_b32 s47, s62, 6
    s_lshl_b32 s47, s47, 3
    s_add_u32 s46, s46, s47
    s_add_u32 s46, s46, 12582912
    v_lshlrev_b32 v132, 6, v0
    v_add_u32 v132, s46, v132
    v_lshlrev_b32 v133, 7, v129
    v_lshl_add_u32 v133, v128, 1, v133
    v_add_u32 v133, s46, v133
    s_mov_b32 s100, 16384
    v_mov_b32 v180, 0
    v_mov_b32 v181, 0
    v_and_b32 v134, 0xf0, v0
    v_lshlrev_b32 v134, 4, v134
    v_bfe_u32 v9, v0, 1, 1
    v_lshl_add_u32 v134, v9, 7, v134
    v_bfe_u32 v9, v0, 2, 2
    v_lshl_add_u32 v134, v9, 4, v134
    v_and_b32 v9, 1, v0
    v_lshl_add_u32 v134, v9, 3, v134
    v_add_u32 v134, 148992, v134
    s_lshr_b32 s46, s62, 1
    s_mul_i32 s46, s46, 18432
    s_and_b32 s47, s62, 1
    s_lshl_b32 s47, s47, 7
    s_add_u32 s46, s46, s47
    v_lshlrev_b32 v139, 4, v128
    v_add_u32 v139, s46, v139
    v_lshl_add_u32 v137, v129, 8, v139
    v_add_u32 v138, 8192, v137
    v_lshrrev_b32 v9, 2, v129
    v_lshl_add_u32 v139, v9, 8, v139
    v_add_u32 v139, 4210688, v139
    v_bfe_u32 v9, v0, 4, 1
    v_lshlrev_b32 v9, 22, v9
    v_sub_u32 v139, v139, v9
    v_bfe_u32 v9, v0, 3, 1
    v_lshl_add_u32 v139, v9, 30, v139
    s_cmp_eq_u32 s3, 0
    s_cbranch_scc1 K4_pg1
    s_cmp_eq_u32 s3, 1
    s_cbranch_scc1 K4_pg2
    s_cmp_eq_u32 s3, 2
    s_cbranch_scc1 K4_pg3
    s_cmp_eq_u32 s3, 3
    s_cbranch_scc1 K4_pg4
K4_vri:
    s_mul_i32 s40, s8, 73728
    s_lshl_b32 s41, s9, 4
    s_add_u32 s40, s40, s41
    s_add_u32 s40, s40, 1024
    v_mul_u32_u24 v216, 2304, v129
    v_lshl_add_u32 v216, v128, 1, v216
    v_add_u32 v216, s40, v216
    v_subrev_u32 v217, 3456, v216
    v_subrev_u32 v218, 2304, v216
    v_subrev_u32 v219, 1152, v216
    v_mov_b32 v112, 0
    v_mov_b32 v113, 0
    v_mov_b32 v114, 0
    v_mov_b32 v115, 0
    v_mov_b32 v116, 0
    v_mov_b32 v117, 0
    v_mov_b32 v118, 0
    v_lshlrev_b32 v220, 3, v128
    s_lshl_b32 s41, s9, 6
    s_add_u32 s41, s41, 4096
    buffer_load_short_d16_hi v112, v217, s[36:39], 0 offen
    buffer_load_short_d16_hi v113, v218, s[36:39], 0 offen
    buffer_load_short_d16_hi v114, v219, s[36:39], 0 offen
    buffer_load_short_d16_hi v115, v216, s[36:39], 0 offen
    buffer_load_short_d16_hi v116, v216, s[36:39], 0 offen offset:1152
    buffer_load_short_d16_hi v117, v216, s[64:67], 0 offen offset:0
    buffer_load_short_d16_hi v118, v216, s[64:67], 0 offen offset:1152
    buffer_load_dwordx2 v[120:121], v220, s[56:59], s41 offen
    buffer_load_dwordx4 v[232:235], v167, s[52:55], s76 offen
    buffer_load_dwordx4 v[236:239], v28, s[52:55], s76 offen
    buffer_load_dwordx4 v[240:243], v167, s[52:55], s77 offen
    buffer_load_dwordx4 v[244:247], v28, s[52:55], s77 offen
    buffer_load_dwordx4 v[248:251], v167, s[52:55], s78 offen
    buffer_load_dwordx4 v[252:255], v28, s[52:55], s78 offen
    s_waitcnt vmcnt(17)
    v_lshlrev_b32 v76, 16, v32
    v_and_b32 v77, 0xffff0000, v32
    v_lshlrev_b32 v78, 16, v36
    v_and_b32 v79, 0xffff0000, v36
    v_lshlrev_b32 v80, 16, v40
    v_and_b32 v81, 0xffff0000, v40
    v_lshlrev_b32 v82, 16, v44
    v_and_b32 v83, 0xffff0000, v44
    v_lshlrev_b32 v84, 16, v48
    v_and_b32 v85, 0xffff0000, v48
    v_lshlrev_b32 v86, 16, v52
    v_and_b32 v87, 0xffff0000, v52
    v_lshlrev_b32 v88, 16, v56
    v_and_b32 v89, 0xffff0000, v56
    v_lshlrev_b32 v90, 16, v60
    v_and_b32 v92, 0xffff0000, v60
    v_lshlrev_b32 v94, 16, v61
    v_and_b32 v96, 0xffff0000, v61
    v_lshlrev_b32 v91, 16, v62
    v_and_b32 v93, 0xffff0000, v62
    v_lshlrev_b32 v95, 16, v63
    v_and_b32 v97, 0xffff0000, v63
    v_pk_mul_f32 v[100:101], v[96:97], v[76:77]
    v_pk_mul_f32 v[102:103], v[96:97], v[78:79]
    v_pk_fma_f32 v[100:101], v[94:95], v[78:79], v[100:101]
    v_pk_fma_f32 v[102:103], v[94:95], v[80:81], v[102:103]
    v_pk_fma_f32 v[100:101], v[92:93], v[80:81], v[100:101]
    v_pk_fma_f32 v[102:103], v[92:93], v[82:83], v[102:103]
    v_pk_fma_f32 v[100:101], v[90:91], v[82:83], v[100:101]
    v_pk_fma_f32 v[102:103], v[90:91], v[84:85], v[102:103]
    v_pk_mul_f32 v[100:101], v[100:101], v[86:87]
    v_pk_mul_f32 v[102:103], v[102:103], v[88:89]
    v_cvt_pk_bf16_f32 v98, v102, v100
    v_cvt_pk_bf16_f32 v99, v103, v101
    v_pk_min_u16 v98, v98, s34
    v_pk_min_u16 v99, v99, s34
    ds_write2_b32 v104, v98, v99 offset0:0 offset1:32
    v_lshlrev_b32 v76, 16, v33
    v_and_b32 v77, 0xffff0000, v33
    v_lshlrev_b32 v78, 16, v37
    v_and_b32 v79, 0xffff0000, v37
    v_lshlrev_b32 v80, 16, v41
    v_and_b32 v81, 0xffff0000, v41
    v_lshlrev_b32 v82, 16, v45
    v_and_b32 v83, 0xffff0000, v45
    v_lshlrev_b32 v84, 16, v49
    v_and_b32 v85, 0xffff0000, v49
    v_lshlrev_b32 v86, 16, v53
    v_and_b32 v87, 0xffff0000, v53
    v_lshlrev_b32 v88, 16, v57
    v_and_b32 v89, 0xffff0000, v57
    v_lshlrev_b32 v90, 16, v64
    v_and_b32 v92, 0xffff0000, v64
    v_lshlrev_b32 v94, 16, v65
    v_and_b32 v96, 0xffff0000, v65
    v_lshlrev_b32 v91, 16, v66
    v_and_b32 v93, 0xffff0000, v66
    v_lshlrev_b32 v95, 16, v67
    v_and_b32 v97, 0xffff0000, v67
    v_pk_mul_f32 v[100:101], v[96:97], v[76:77]
    v_pk_mul_f32 v[102:103], v[96:97], v[78:79]
    v_pk_fma_f32 v[100:101], v[94:95], v[78:79], v[100:101]
    v_pk_fma_f32 v[102:103], v[94:95], v[80:81], v[102:103]
    v_pk_fma_f32 v[100:101], v[92:93], v[80:81], v[100:101]
    v_pk_fma_f32 v[102:103], v[92:93], v[82:83], v[102:103]
    v_pk_fma_f32 v[100:101], v[90:91], v[82:83], v[100:101]
    v_pk_fma_f32 v[102:103], v[90:91], v[84:85], v[102:103]
    v_pk_mul_f32 v[100:101], v[100:101], v[86:87]
    v_pk_mul_f32 v[102:103], v[102:103], v[88:89]
    v_cvt_pk_bf16_f32 v98, v102, v100
    v_cvt_pk_bf16_f32 v99, v103, v101
    v_pk_min_u16 v98, v98, s34
    v_pk_min_u16 v99, v99, s34
    ds_write2_b32 v104, v98, v99 offset0:64 offset1:96
    v_lshlrev_b32 v76, 16, v34
    v_and_b32 v77, 0xffff0000, v34
    v_lshlrev_b32 v78, 16, v38
    v_and_b32 v79, 0xffff0000, v38
    v_lshlrev_b32 v80, 16, v42
    v_and_b32 v81, 0xffff0000, v42
    v_lshlrev_b32 v82, 16, v46
    v_and_b32 v83, 0xffff0000, v46
    v_lshlrev_b32 v84, 16, v50
    v_and_b32 v85, 0xffff0000, v50
    v_lshlrev_b32 v86, 16, v54
    v_and_b32 v87, 0xffff0000, v54
    v_lshlrev_b32 v88, 16, v58
    v_and_b32 v89, 0xffff0000, v58
    v_lshlrev_b32 v90, 16, v68
    v_and_b32 v92, 0xffff0000, v68
    v_lshlrev_b32 v94, 16, v69
    v_and_b32 v96, 0xffff0000, v69
    v_lshlrev_b32 v91, 16, v70
    v_and_b32 v93, 0xffff0000, v70
    v_lshlrev_b32 v95, 16, v71
    v_and_b32 v97, 0xffff0000, v71
    v_pk_mul_f32 v[100:101], v[96:97], v[76:77]
    v_pk_mul_f32 v[102:103], v[96:97], v[78:79]
    v_pk_fma_f32 v[100:101], v[94:95], v[78:79], v[100:101]
    v_pk_fma_f32 v[102:103], v[94:95], v[80:81], v[102:103]
    v_pk_fma_f32 v[100:101], v[92:93], v[80:81], v[100:101]
    v_pk_fma_f32 v[102:103], v[92:93], v[82:83], v[102:103]
    v_pk_fma_f32 v[100:101], v[90:91], v[82:83], v[100:101]
    v_pk_fma_f32 v[102:103], v[90:91], v[84:85], v[102:103]
    v_pk_mul_f32 v[100:101], v[100:101], v[86:87]
    v_pk_mul_f32 v[102:103], v[102:103], v[88:89]
    v_cvt_pk_bf16_f32 v98, v102, v100
    v_cvt_pk_bf16_f32 v99, v103, v101
    v_pk_min_u16 v98, v98, s34
    v_pk_min_u16 v99, v99, s34
    ds_write2_b32 v104, v98, v99 offset0:128 offset1:160
    v_lshlrev_b32 v76, 16, v35
    v_and_b32 v77, 0xffff0000, v35
    v_lshlrev_b32 v78, 16, v39
    v_and_b32 v79, 0xffff0000, v39
    v_lshlrev_b32 v80, 16, v43
    v_and_b32 v81, 0xffff0000, v43
    v_lshlrev_b32 v82, 16, v47
    v_and_b32 v83, 0xffff0000, v47
    v_lshlrev_b32 v84, 16, v51
    v_and_b32 v85, 0xffff0000, v51
    v_lshlrev_b32 v86, 16, v55
    v_and_b32 v87, 0xffff0000, v55
    v_lshlrev_b32 v88, 16, v59
    v_and_b32 v89, 0xffff0000, v59
    v_lshlrev_b32 v90, 16, v72
    v_and_b32 v92, 0xffff0000, v72
    v_lshlrev_b32 v94, 16, v73
    v_and_b32 v96, 0xffff0000, v73
    v_lshlrev_b32 v91, 16, v74
    v_and_b32 v93, 0xffff0000, v74
    v_lshlrev_b32 v95, 16, v75
    v_and_b32 v97, 0xffff0000, v75
    v_pk_mul_f32 v[100:101], v[96:97], v[76:77]
    v_pk_mul_f32 v[102:103], v[96:97], v[78:79]
    v_pk_fma_f32 v[100:101], v[94:95], v[78:79], v[100:101]
    v_pk_fma_f32 v[102:103], v[94:95], v[80:81], v[102:103]
    v_pk_fma_f32 v[100:101], v[92:93], v[80:81], v[100:101]
    v_pk_fma_f32 v[102:103], v[92:93], v[82:83], v[102:103]
    v_pk_fma_f32 v[100:101], v[90:91], v[82:83], v[100:101]
    v_pk_fma_f32 v[102:103], v[90:91], v[84:85], v[102:103]
    v_pk_mul_f32 v[100:101], v[100:101], v[86:87]
    v_pk_mul_f32 v[102:103], v[102:103], v[88:89]
    v_cvt_pk_bf16_f32 v98, v102, v100
    v_cvt_pk_bf16_f32 v99, v103, v101
    v_pk_min_u16 v98, v98, s34
    v_pk_min_u16 v99, v99, s34
    ds_write2_b32 v104, v98, v99 offset0:192 offset1:224
    s_waitcnt vmcnt(14)
    s_waitcnt lgkmcnt(0)
    s_add_u32 s16, s16, 2654435761
    v_mov_b32 v176, s16
    v_mov_b32 v177, s16
    v_mov_b32 v178, s16
    v_mov_b32 v179, s16
    s_barrier
    buffer_store_dwordx4 v[176:179], v140, s[72:75], s101 offen sc1
    v_mov_b32 v22, s16
    ds_read_b128 v[32:35], v106
    ds_read_b128 v[36:39], v107 offset:4096
    s_waitcnt lgkmcnt(1)
    buffer_store_dwordx4 v[32:35], v109, s[24:27], 0 offen sc1
    s_waitcnt lgkmcnt(0)
    buffer_store_dwordx4 v[36:39], v110, s[24:27], 0 offen sc1
    v_add_u32 v104, 0x10000, v28
    v_mul_u32_u24 v130, 1152, v128
    v_add_u32 v130, s63, v130
    v_lshl_add_u32 v131, v129, 2, v130
    v_lshl_add_u32 v130, v129, 4, v130
    buffer_load_dwordx4 v[204:207], v130, s[28:31], 0 offen
    buffer_load_dwordx4 v[208:211], v130, s[28:31], 0 offen offset:512
    buffer_load_dword v212, v131, s[28:31], 0 offen offset:1024
    s_mov_b32 s36, s68
    s_mov_b32 s37, s69
    s_mov_b32 s38, 5308416
    s_mov_b32 s39, 0x00020000
    s_mul_i32 s40, s2, 36864
    v_mul_u32_u24 v141, 1152, v129
    v_lshl_add_u32 v141, v128, 4, v141
    v_add_u32 v141, s40, v141
    buffer_load_dwordx4 v[228:231], v141, s[36:39], 0 offen offset:1024
    s_waitcnt vmcnt(13)
    v_lshlrev_b32 v90, 16, v120
    v_and_b32 v91, 0xffff0000, v120
    v_lshlrev_b32 v92, 16, v121
    v_and_b32 v93, 0xffff0000, v121
    v_mul_f32 v94, v93, v112
    v_mul_f32 v95, v93, v113
    v_fmac_f32 v94, v92, v113
    v_fmac_f32 v95, v92, v114
    v_fmac_f32 v94, v91, v114
    v_fmac_f32 v95, v91, v115
    v_fmac_f32 v94, v90, v115
    v_fmac_f32 v95, v90, v116
    v_mul_f32 v94, v94, v117
    v_mul_f32 v95, v95, v118
    v_cvt_pk_bf16_f32 v119, v95, v94
    v_pk_min_u16 v119, v119, s34
    ds_write_b32 v105, v119 offset:8192
    s_waitcnt lgkmcnt(0)
    s_barrier
    ds_read_b128 v[40:43], v108
    s_waitcnt lgkmcnt(0)
    buffer_store_dwordx4 v[40:43], v111, s[24:27], 0 offen sc1
    v_bfe_u32 v92, v0, 3, 1
    v_bfe_u32 v93, v0, 4, 2
    v_add_u32 v92, v92, v93
    v_cmp_eq_u32 vcc, 1, v92
    v_bfe_u32 v92, v0, 1, 2
    v_sub_u32 v92, 3, v92
    v_and_b32 v93, 1, v0
    v_cndmask_b32 v92, 9, v92, vcc
    v_lshlrev_b32 v93, 4, v93
    s_lshl_b32 s14, s17, 16
    s_and_b32 s17, s17, 0xffff0000
    s_cmp_lt_u32 s3, 2
    s_cselect_b32 s17, s14, s17
    s_bitcmp0_b32 s3, 0
    s_cselect_b32 s17, s17, 0
    s_lshl_b32 s14, s18, 16
    s_and_b32 s18, s18, 0xffff0000
    s_bitcmp0_b32 s22, 6
    s_cselect_b32 s18, s14, s18
    s_cmp_eq_u32 s3, 0
    s_cselect_b32 s18, s18, 0
    v_cmp_eq_u32 vcc, 0, v92
    v_cmp_eq_u32 s[50:51], 1, v92
    v_cmp_eq_u32 s[52:53], 2, v92
    v_cmp_eq_u32 s[54:55], 3, v92
    v_lshrrev_b32 v94, v93, s17
    v_lshrrev_b32 v95, v93, s18
    v_cndmask_b32 v168, 0, v94, vcc
    v_cndmask_b32 v172, 0, v95, vcc
    v_cndmask_b32 v169, 0, v94, s[50:51]
    v_cndmask_b32 v173, 0, v95, s[50:51]
    v_cndmask_b32 v170, 0, v94, s[52:53]
    v_cndmask_b32 v174, 0, v95, s[52:53]
    v_cndmask_b32 v171, 0, v94, s[54:55]
    v_cndmask_b32 v175, 0, v95, s[54:55]
    s_waitcnt vmcnt(12)
    v_alignbit_b32 v44, v233, v232, 16
    v_alignbit_b32 v45, v234, v233, 16
    v_alignbit_b32 v46, v235, v234, 16
    v_alignbit_b32 v47, v236, v235, 16
    v_alignbit_b32 v48, v237, v236, 16
    v_alignbit_b32 v49, v238, v237, 16
    v_alignbit_b32 v50, v239, v238, 16
    ds_write_b128 v28, v[234:237] offset:12496
    v_mov_b32 v52, v233
    v_mov_b32 v53, v234
    v_mov_b32 v54, v235
    v_mov_b32 v55, v236
    v_mov_b32 v56, v237
    v_mov_b32 v57, v238
    ds_write_b128 v28, v[236:239] offset:29136
    v_alignbit_b32 v60, v234, v233, 16
    v_alignbit_b32 v61, v235, v234, 16
    v_alignbit_b32 v62, v236, v235, 16
    v_alignbit_b32 v63, v237, v236, 16
    v_alignbit_b32 v64, v238, v237, 16
    v_alignbit_b32 v65, v239, v238, 16
    ds_write_b128 v28, v[44:47] offset:16
    ds_write_b128 v28, v[46:49] offset:16656
    ds_write_b128 v28, v[52:55] offset:4176
    ds_write_b128 v28, v[54:57] offset:20816
    ds_write_b128 v28, v[60:63] offset:8336
    ds_write_b128 v28, v[62:65] offset:24976
    s_waitcnt vmcnt(10)
    v_alignbit_b32 v68, v241, v240, 16
    v_alignbit_b32 v69, v242, v241, 16
    v_alignbit_b32 v70, v243, v242, 16
    v_alignbit_b32 v71, v244, v243, 16
    v_alignbit_b32 v72, v245, v244, 16
    v_alignbit_b32 v73, v246, v245, 16
    v_alignbit_b32 v74, v247, v246, 16
    ds_write_b128 v28, v[242:245] offset:45776
    v_mov_b32 v76, v241
    v_mov_b32 v77, v242
    v_mov_b32 v78, v243
    v_mov_b32 v79, v244
    v_mov_b32 v80, v245
    v_mov_b32 v81, v246
    ds_write_b128 v28, v[244:247] offset:62416
    v_alignbit_b32 v84, v242, v241, 16
    v_alignbit_b32 v85, v243, v242, 16
    v_alignbit_b32 v86, v244, v243, 16
    v_alignbit_b32 v87, v245, v244, 16
    v_alignbit_b32 v88, v246, v245, 16
    v_alignbit_b32 v89, v247, v246, 16
    ds_write_b128 v28, v[68:71] offset:33296
    ds_write_b128 v28, v[70:73] offset:49936
    ds_write_b128 v28, v[76:79] offset:37456
    ds_write_b128 v28, v[78:81] offset:54096
    ds_write_b128 v28, v[84:87] offset:41616
    ds_write_b128 v28, v[86:89] offset:58256
    buffer_load_dword v124, v123, s[72:75], s101 offen sc1
    s_waitcnt vmcnt(9)
    v_alignbit_b32 v44, v249, v248, 16
    v_alignbit_b32 v45, v250, v249, 16
    v_alignbit_b32 v46, v251, v250, 16
    v_alignbit_b32 v47, v252, v251, 16
    v_alignbit_b32 v48, v253, v252, 16
    v_alignbit_b32 v49, v254, v253, 16
    v_alignbit_b32 v50, v255, v254, 16
    s_branch K4_ps1
K4_pg1:
    s_branch K4_vri
K4_ps1:
    ds_write_b128 v104, v[250:253] offset:13520
    v_mov_b32 v52, v249
    v_mov_b32 v53, v250
    v_mov_b32 v54, v251
    v_mov_b32 v55, v252
    v_mov_b32 v56, v253
    v_mov_b32 v57, v254
    ds_write_b128 v104, v[252:255] offset:30160
    v_alignbit_b32 v60, v250, v249, 16
    v_alignbit_b32 v61, v251, v250, 16
    v_alignbit_b32 v62, v252, v251, 16
    v_alignbit_b32 v63, v253, v252, 16
    v_alignbit_b32 v64, v254, v253, 16
    v_alignbit_b32 v65, v255, v254, 16
    ds_write_b128 v104, v[44:47] offset:1040
    ds_write_b128 v104, v[46:49] offset:17680
    ds_write_b128 v104, v[52:55] offset:5200
    ds_write_b128 v104, v[54:57] offset:21840
    ds_write_b128 v104, v[60:63] offset:9360
    ds_write_b128 v104, v[62:65] offset:26000
    s_waitcnt vmcnt(0)
    v_cmp_ne_u32 vcc, v22, v124
    s_cbranch_vccnz K4_slowp
K4_okp:
    buffer_load_dwordx4 v[32:35], v28, s[24:27], s19 offen sc1
    buffer_load_dwordx4 v[36:39], v28, s[24:27], s20 offen sc1
    buffer_load_dwordx4 v[40:43], v28, s[24:27], s21 offen sc1
    s_waitcnt lgkmcnt(0)
    s_barrier
    s_add_u32 s64, s10, 46137344
    s_addc_u32 s65, s11, 0
    s_mov_b32 s66, 589824
    s_mov_b32 s67, 0x00020000
    buffer_store_dwordx4 v[228:231], v126, s[64:67], 0 offen sc1
    s_lshr_b32 s33, s62, 1
    s_mul_i32 s33, s33, 10240
    s_lshl_b32 s32, s62, 12
    s_add_u32 s33, s33, s32
    s_add_u32 s32, s33, 4194304
    buffer_store_dwordx4 v[24:27], v28, s[24:27], s32 offen sc1
    buffer_store_dwordx4 v[24:27], v164, s[24:27], 0 offen sc1
    buffer_store_dwordx4 v[24:27], v164, s[24:27], s23 offen sc1
    buffer_store_dwordx4 v[24:27], v165, s[24:27], 0 offen sc1
    s_bitcmp1_b32 s2, 3
    s_cselect_b32 s56, s6, s4
    s_cselect_b32 s57, s7, s5
    s_lshr_b32 s60, s2, 4
    s_mul_i32 s60, s60, 36864
    s_add_u32 s60, s60, 0
    s_add_u32 s58, s60, 36864
    s_and_b32 s59, s2, 3
    s_mul_i32 s59, s59, 2304
    s_add_u32 s60, s60, s59
    s_mov_b32 s59, 0x00020000
    v_mul_u32_u24 v125, 3641, v0
    v_lshrrev_b32 v125, 16, v125
    v_mul_u32_u24 v125, 6912, v125
    v_lshl_add_u32 v125, v0, 7, v125
    ds_read_b128 a[0:3], v142 offset:0
    ds_read_b128 a[4:7], v142 offset:512
    ds_read_b128 a[8:11], v142 offset:1024
    ds_read_b128 a[12:15], v142 offset:1536
    ds_read_b128 a[16:19], v142 offset:2048
    ds_read_b128 a[20:23], v142 offset:2560
    ds_read_b128 a[24:27], v142 offset:3072
    ds_read_b128 a[28:31], v142 offset:3584
    s_waitcnt vmcnt(5)
K4_kc:
    ds_write_b128 v104, v[32:35] offset:34304
    ds_write_b128 v104, v[36:39] offset:38912
    ds_write_b128 v104, v[40:43] offset:43520
    v_pk_max_u16 v44, v32, v34
    v_pk_max_u16 v45, v33, v35
    v_pk_max_u16 v44, v44, v36
    v_pk_max_u16 v45, v45, v37
    v_pk_max_u16 v44, v44, v38
    v_pk_max_u16 v45, v45, v39
    v_pk_max_u16 v44, v44, v40
    v_pk_max_u16 v45, v45, v41
    v_pk_max_u16 v44, v44, v42
    v_pk_max_u16 v45, v45, v43
    v_pk_max_u16 v44, v44, v45
    v_pk_min_u16 v45, v44, s34
    v_cmp_ne_u32 vcc, v44, v45
    s_cbranch_vccnz K4_slowk
K4_okk:
    s_waitcnt lgkmcnt(0)
    s_barrier
    ds_read_b128 a[32:35], v143 offset:3584
    ds_read_b128 a[36:39], v143 offset:3072
    ds_read_b128 a[40:43], v143 offset:2560
    ds_read_b128 a[44:47], v143 offset:2048
    ds_read_b128 a[48:51], v143 offset:1536
    ds_read_b128 a[52:55], v143 offset:1024
    ds_read_b128 a[56:59], v143 offset:512
    ds_read_b128 a[60:63], v143 offset:0
    s_waitcnt lgkmcnt(7)
    v_mfma_f32_16x16x32_bf16 v[32:35], a[0:3], a[32:35], 0
    ds_read_b128 a[80:83], v162 offset:0
    ds_read_b128 a[112:115], v163 offset:0
    s_nop 0
    v_mfma_f32_16x16x32_bf16 v[32:35], v[168:171], a[32:35], v[32:35]
    ds_read_b128 a[144:147], v182 offset:0
    ds_read_b128 a[84:87], v162 offset:512
    v_mfma_f32_16x16x32_bf16 v[36:39], a[4:7], a[32:35], 0
    ds_read_b128 a[116:119], v163 offset:512
    ds_read_b128 a[148:151], v182 offset:512
    v_mfma_f32_16x16x32_bf16 v[40:43], a[8:11], a[32:35], 0
    ds_read_b128 a[88:91], v162 offset:1024
    v_mfma_f32_16x16x32_bf16 v[44:47], a[12:15], a[32:35], 0
    v_mfma_f32_16x16x32_bf16 v[48:51], a[16:19], a[32:35], 0
    v_mfma_f32_16x16x32_bf16 v[52:55], a[20:23], a[32:35], 0
    v_mfma_f32_16x16x32_bf16 v[56:59], a[24:27], a[32:35], 0
    v_mfma_f32_16x16x32_bf16 v[60:63], a[28:31], a[32:35], 0
    s_waitcnt lgkmcnt(13)
    v_mfma_f32_16x16x32_bf16 v[36:39], a[0:3], a[36:39], v[36:39]
    ds_read_b128 a[120:123], v163 offset:1024
    v_mfma_f32_16x16x32_bf16 v[36:39], v[168:171], a[36:39], v[36:39]
    v_mfma_f32_16x16x32_bf16 v[40:43], a[4:7], a[36:39], v[40:43]
    v_mfma_f32_16x16x32_bf16 v[44:47], a[8:11], a[36:39], v[44:47]
    v_mfma_f32_16x16x32_bf16 v[48:51], a[12:15], a[36:39], v[48:51]
    v_mfma_f32_16x16x32_bf16 v[52:55], a[16:19], a[36:39], v[52:55]
    v_mfma_f32_16x16x32_bf16 v[56:59], a[20:23], a[36:39], v[56:59]
    v_mfma_f32_16x16x32_bf16 v[60:63], a[24:27], a[36:39], v[60:63]
    s_waitcnt lgkmcnt(13)
    v_mfma_f32_16x16x32_bf16 v[40:43], a[0:3], a[40:43], v[40:43]
    ds_read_b128 a[152:155], v182 offset:1024
    v_mfma_f32_16x16x32_bf16 v[40:43], v[168:171], a[40:43], v[40:43]
    v_mfma_f32_16x16x32_bf16 v[44:47], a[4:7], a[40:43], v[44:47]
    v_mfma_f32_16x16x32_bf16 v[48:51], a[8:11], a[40:43], v[48:51]
    v_mfma_f32_16x16x32_bf16 v[52:55], a[12:15], a[40:43], v[52:55]
    v_mfma_f32_16x16x32_bf16 v[56:59], a[16:19], a[40:43], v[56:59]
    v_mfma_f32_16x16x32_bf16 v[60:63], a[20:23], a[40:43], v[60:63]
    s_waitcnt lgkmcnt(13)
    v_mfma_f32_16x16x32_bf16 v[44:47], a[0:3], a[44:47], v[44:47]
    ds_read_b128 a[92:95], v162 offset:1536
    v_mfma_f32_16x16x32_bf16 v[44:47], v[168:171], a[44:47], v[44:47]
    v_mfma_f32_16x16x32_bf16 v[48:51], a[4:7], a[44:47], v[48:51]
    v_mfma_f32_16x16x32_bf16 v[52:55], a[8:11], a[44:47], v[52:55]
    v_mfma_f32_16x16x32_bf16 v[56:59], a[12:15], a[44:47], v[56:59]
    v_mfma_f32_16x16x32_bf16 v[60:63], a[16:19], a[44:47], v[60:63]
    s_waitcnt lgkmcnt(13)
    v_mfma_f32_16x16x32_bf16 v[48:51], a[0:3], a[48:51], v[48:51]
    ds_read_b128 a[124:127], v163 offset:1536
    v_mfma_f32_16x16x32_bf16 v[48:51], v[168:171], a[48:51], v[48:51]
    v_mfma_f32_16x16x32_bf16 v[52:55], a[4:7], a[48:51], v[52:55]
    v_mfma_f32_16x16x32_bf16 v[56:59], a[8:11], a[48:51], v[56:59]
    v_mfma_f32_16x16x32_bf16 v[60:63], a[12:15], a[48:51], v[60:63]
    s_waitcnt lgkmcnt(13)
    v_mfma_f32_16x16x32_bf16 v[52:55], a[0:3], a[52:55], v[52:55]
    ds_read_b128 a[156:159], v182 offset:1536
    buffer_load_dword v127, v125, s[56:59], s60 offen
    v_mfma_f32_16x16x32_bf16 v[52:55], v[168:171], a[52:55], v[52:55]
    s_bitcmp1_b32 s2, 3
    s_cselect_b32 s56, s6, s4
    s_cselect_b32 s57, s7, s5
    v_mfma_f32_16x16x32_bf16 v[56:59], a[4:7], a[52:55], v[56:59]
    s_lshr_b32 s60, s2, 4
    v_mfma_f32_16x16x32_bf16 v[60:63], a[8:11], a[52:55], v[60:63]
    s_mul_i32 s60, s60, 36864
    s_waitcnt lgkmcnt(13)
    v_mfma_f32_16x16x32_bf16 v[56:59], a[0:3], a[56:59], v[56:59]
    ds_read_b128 a[96:99], v162 offset:2048
    s_add_u32 s60, s60, 589824
    v_mfma_f32_16x16x32_bf16 v[56:59], v[168:171], a[56:59], v[56:59]
    s_add_u32 s58, s60, 36864
    v_mfma_f32_16x16x32_bf16 v[60:63], a[4:7], a[56:59], v[60:63]
    s_and_b32 s59, s2, 3
    s_waitcnt lgkmcnt(13)
    v_mfma_f32_16x16x32_bf16 v[60:63], a[0:3], a[60:63], v[60:63]
    ds_read_b128 a[128:131], v163 offset:2048
    s_mul_i32 s59, s59, 2304
    v_mfma_f32_16x16x32_bf16 v[60:63], v[168:171], a[60:63], v[60:63]
    s_add_u32 s60, s60, s59
    s_waitcnt lgkmcnt(12)
    v_mfma_f32_16x16x32_bf16 v[64:67], a[80:83], a[112:115], 0
    ds_read_b128 a[100:103], v162 offset:2560
    ds_read_b128 a[132:135], v163 offset:2560
    s_mov_b32 s59, 0x00020000
    s_waitcnt lgkmcnt(13)
    v_mfma_f32_16x16x32_bf16 v[68:71], a[80:83], a[144:147], 0
    ds_read_b128 a[104:107], v162 offset:3072
    v_mul_u32_u24 v125, 3641, v0
    v_mfma_f32_16x16x32_bf16 v[64:67], v[172:175], a[112:115], v[64:67]
    v_lshrrev_b32 v125, 16, v125
    v_mfma_f32_16x16x32_bf16 v[68:71], v[172:175], a[144:147], v[68:71]
    v_mul_u32_u24 v125, 6912, v125
    s_waitcnt lgkmcnt(12)
    v_mfma_f32_16x16x32_bf16 v[64:67], a[84:87], a[116:119], v[64:67]
    ds_read_b128 a[136:139], v163 offset:3072
    ds_read_b128 a[108:111], v162 offset:3584
    v_lshl_add_u32 v125, v0, 7, v125
    s_waitcnt lgkmcnt(13)
    v_mfma_f32_16x16x32_bf16 v[68:71], a[84:87], a[148:151], v[68:71]
    ds_read_b128 a[140:143], v163 offset:3584
    s_waitcnt lgkmcnt(12)
    v_mfma_f32_16x16x32_bf16 v[64:67], a[88:91], a[120:123], v[64:67]
    ds_read_b128 a[160:163], v142 offset:64
    ds_read_b128 a[192:195], v143 offset:3648
    s_waitcnt lgkmcnt(13)
    v_mfma_f32_16x16x32_bf16 v[68:71], a[88:91], a[152:155], v[68:71]
    ds_read_b128 a[164:167], v142 offset:576
    s_waitcnt lgkmcnt(12)
    v_mfma_f32_16x16x32_bf16 v[64:67], a[92:95], a[124:127], v[64:67]
    ds_read_b128 a[196:199], v143 offset:3136
    ds_read_b128 a[168:171], v142 offset:1088
    s_waitcnt lgkmcnt(13)
    v_mfma_f32_16x16x32_bf16 v[68:71], a[92:95], a[156:159], v[68:71]
    ds_read_b128 a[200:203], v143 offset:2624
    s_waitcnt lgkmcnt(12)
    v_mfma_f32_16x16x32_bf16 v[64:67], a[96:99], a[128:131], v[64:67]
    ds_read_b128 a[172:175], v142 offset:1600
    ds_read_b128 a[204:207], v143 offset:2112
    s_waitcnt lgkmcnt(12)
    v_mfma_f32_16x16x32_bf16 v[64:67], a[100:103], a[132:135], v[64:67]
    ds_read_b128 a[176:179], v142 offset:2112
    ds_read_b128 a[208:211], v143 offset:1600
    s_waitcnt lgkmcnt(12)
    v_mfma_f32_16x16x32_bf16 v[64:67], a[104:107], a[136:139], v[64:67]
    ds_read_b128 a[180:183], v142 offset:2624
    ds_read_b128 a[212:215], v143 offset:1088
    s_waitcnt lgkmcnt(12)
    v_mfma_f32_16x16x32_bf16 v[64:67], a[108:111], a[140:143], v[64:67]
    ds_read_b128 a[184:187], v142 offset:3136
    ds_read_b128 a[216:219], v143 offset:576
    s_waitcnt lgkmcnt(12)
    v_mfma_f32_16x16x32_bf16 v[32:35], a[160:163], a[192:195], v[32:35]
    ds_read_b128 a[188:191], v142 offset:3648
    ds_read_b128 a[220:223], v143 offset:64
    s_waitcnt lgkmcnt(12)
    v_mfma_f32_16x16x32_bf16 v[36:39], a[160:163], a[196:199], v[36:39]
    ds_read_b128 a[0:3], v162 offset:64
    ds_read_b128 a[32:35], v163 offset:64
    v_mfma_f32_16x16x32_bf16 v[36:39], a[164:167], a[192:195], v[36:39]
    v_mfma_f32_16x16x32_bf16 v[40:43], a[164:167], a[196:199], v[40:43]
    s_waitcnt lgkmcnt(12)
    v_mfma_f32_16x16x32_bf16 v[40:43], a[160:163], a[200:203], v[40:43]
    ds_read_b128 a[64:67], v182 offset:64
    ds_read_b128 a[4:7], v162 offset:576
    v_mfma_f32_16x16x32_bf16 v[40:43], a[168:171], a[192:195], v[40:43]
    v_mfma_f32_16x16x32_bf16 v[44:47], a[164:167], a[200:203], v[44:47]
    v_mfma_f32_16x16x32_bf16 v[44:47], a[168:171], a[196:199], v[44:47]
    v_mfma_f32_16x16x32_bf16 v[48:51], a[168:171], a[200:203], v[48:51]
    s_waitcnt lgkmcnt(12)
    v_mfma_f32_16x16x32_bf16 v[44:47], a[160:163], a[204:207], v[44:47]
    ds_read_b128 a[36:39], v163 offset:576
    ds_read_b128 a[68:71], v182 offset:576
    v_mfma_f32_16x16x32_bf16 v[44:47], a[172:175], a[192:195], v[44:47]
    v_mfma_f32_16x16x32_bf16 v[48:51], a[164:167], a[204:207], v[48:51]
    v_mfma_f32_16x16x32_bf16 v[48:51], a[172:175], a[196:199], v[48:51]
    v_mfma_f32_16x16x32_bf16 v[52:55], a[168:171], a[204:207], v[52:55]
    v_mfma_f32_16x16x32_bf16 v[52:55], a[172:175], a[200:203], v[52:55]
    v_mfma_f32_16x16x32_bf16 v[56:59], a[172:175], a[204:207], v[56:59]
    s_waitcnt lgkmcnt(12)
    v_mfma_f32_16x16x32_bf16 v[48:51], a[160:163], a[208:211], v[48:51]
    ds_read_b128 a[8:11], v162 offset:1088
    ds_read_b128 a[40:43], v163 offset:1088
    v_mfma_f32_16x16x32_bf16 v[48:51], a[176:179], a[192:195], v[48:51]
    v_mfma_f32_16x16x32_bf16 v[52:55], a[164:167], a[208:211], v[52:55]
    v_lshlrev_b32 v166, 24, v0
    v_mfma_f32_16x16x32_bf16 v[52:55], a[176:179], a[196:199], v[52:55]
    s_lshl2_add_u32 s33, s2, s35
    v_mfma_f32_16x16x32_bf16 v[56:59], a[168:171], a[208:211], v[56:59]
    v_mfma_f32_16x16x32_bf16 v[56:59], a[176:179], a[200:203], v[56:59]
    v_mfma_f32_16x16x32_bf16 v[60:63], a[172:175], a[208:211], v[60:63]
    s_waitcnt vmcnt(1)
    s_barrier
    buffer_store_dword v22, v166, s[72:75], s33 offen sc1
    v_mfma_f32_16x16x32_bf16 v[60:63], a[176:179], a[204:207], v[60:63]
    s_waitcnt lgkmcnt(12)
    v_mfma_f32_16x16x32_bf16 v[52:55], a[160:163], a[212:215], v[52:55]
    ds_read_b128 a[72:75], v182 offset:1088
    ds_read_b128 a[12:15], v162 offset:1600
    v_mfma_f32_16x16x32_bf16 v[52:55], a[180:183], a[192:195], v[52:55]
    v_mfma_f32_16x16x32_bf16 v[56:59], a[164:167], a[212:215], v[56:59]
    v_mfma_f32_16x16x32_bf16 v[56:59], a[180:183], a[196:199], v[56:59]
    buffer_load_dword v127, v125, s[56:59], s60 offen
    v_mfma_f32_16x16x32_bf16 v[60:63], a[168:171], a[212:215], v[60:63]
    s_bitcmp1_b32 s2, 3
    s_cselect_b32 s56, s6, s4
    s_cselect_b32 s57, s7, s5
    v_mfma_f32_16x16x32_bf16 v[60:63], a[180:183], a[200:203], v[60:63]
    s_lshr_b32 s60, s2, 4
    s_waitcnt lgkmcnt(12)
    v_mfma_f32_16x16x32_bf16 v[56:59], a[160:163], a[216:219], v[56:59]
    ds_read_b128 a[44:47], v163 offset:1600
    ds_read_b128 a[76:79], v182 offset:1600
    s_mul_i32 s60, s60, 55296
    v_mfma_f32_16x16x32_bf16 v[56:59], a[184:187], a[192:195], v[56:59]
    s_add_u32 s60, s60, 1179648
    v_mfma_f32_16x16x32_bf16 v[60:63], a[164:167], a[216:219], v[60:63]
    s_add_u32 s58, s60, 55296
    v_mfma_f32_16x16x32_bf16 v[60:63], a[184:187], a[196:199], v[60:63]
    s_and_b32 s59, s2, 3
    s_waitcnt lgkmcnt(12)
    v_mfma_f32_16x16x32_bf16 v[60:63], a[160:163], a[220:223], v[60:63]
    ds_read_b128 a[16:19], v162 offset:2112
    ds_read_b128 a[48:51], v163 offset:2112
    s_mul_i32 s59, s59, 2304
    v_mfma_f32_16x16x32_bf16 v[60:63], a[188:191], a[192:195], v[60:63]
    s_add_u32 s60, s60, s59
    s_waitcnt lgkmcnt(12)
    v_mfma_f32_16x16x32_bf16 v[64:67], a[0:3], a[32:35], v[64:67]
    ds_read_b128 a[20:23], v162 offset:2624
    ds_read_b128 a[52:55], v163 offset:2624
    s_mov_b32 s59, 0x00020000
    s_waitcnt lgkmcnt(13)
    v_mfma_f32_16x16x32_bf16 v[68:71], a[0:3], a[64:67], v[68:71]
    ds_read_b128 a[24:27], v162 offset:3136
    v_mul_u32_u24 v125, 3641, v0
    s_waitcnt lgkmcnt(12)
    v_mfma_f32_16x16x32_bf16 v[64:67], a[4:7], a[36:39], v[64:67]
    ds_read_b128 a[56:59], v163 offset:3136
    ds_read_b128 a[28:31], v162 offset:3648
    v_lshrrev_b32 v125, 16, v125
    s_waitcnt lgkmcnt(13)
    v_mfma_f32_16x16x32_bf16 v[68:71], a[4:7], a[68:71], v[68:71]
    ds_read_b128 a[60:63], v163 offset:3648
    v_mul_u32_u24 v125, 6912, v125
    s_waitcnt lgkmcnt(12)
    v_mfma_f32_16x16x32_bf16 v[64:67], a[8:11], a[40:43], v[64:67]
    ds_read_b128 a[80:83], v142 offset:128
    ds_read_b128 a[112:115], v143 offset:3712
    v_lshl_add_u32 v125, v0, 7, v125
    s_waitcnt lgkmcnt(13)
    v_mfma_f32_16x16x32_bf16 v[68:71], a[8:11], a[72:75], v[68:71]
    ds_read_b128 a[84:87], v142 offset:640
    s_waitcnt lgkmcnt(12)
    v_mfma_f32_16x16x32_bf16 v[64:67], a[12:15], a[44:47], v[64:67]
    ds_read_b128 a[116:119], v143 offset:3200
    ds_read_b128 a[88:91], v142 offset:1152
    s_waitcnt lgkmcnt(13)
    v_mfma_f32_16x16x32_bf16 v[68:71], a[12:15], a[76:79], v[68:71]
    ds_read_b128 a[120:123], v143 offset:2688
    s_waitcnt lgkmcnt(12)
    v_mfma_f32_16x16x32_bf16 v[64:67], a[16:19], a[48:51], v[64:67]
    ds_read_b128 a[92:95], v142 offset:1664
    ds_read_b128 a[124:127], v143 offset:2176
    s_waitcnt lgkmcnt(12)
    v_mfma_f32_16x16x32_bf16 v[64:67], a[20:23], a[52:55], v[64:67]
    ds_read_b128 a[96:99], v142 offset:2176
    ds_read_b128 a[128:131], v143 offset:1664
    s_waitcnt lgkmcnt(12)
    v_mfma_f32_16x16x32_bf16 v[64:67], a[24:27], a[56:59], v[64:67]
    ds_read_b128 a[100:103], v142 offset:2688
    ds_read_b128 a[132:135], v143 offset:1152
    s_waitcnt lgkmcnt(12)
    v_mfma_f32_16x16x32_bf16 v[64:67], a[28:31], a[60:63], v[64:67]
    ds_read_b128 a[104:107], v142 offset:3200
    ds_read_b128 a[136:139], v143 offset:640
    s_waitcnt lgkmcnt(12)
    v_mfma_f32_16x16x32_bf16 v[32:35], a[80:83], a[112:115], v[32:35]
    ds_read_b128 a[108:111], v142 offset:3712
    ds_read_b128 a[140:143], v143 offset:128
    s_waitcnt lgkmcnt(12)
    v_mfma_f32_16x16x32_bf16 v[36:39], a[80:83], a[116:119], v[36:39]
    ds_read_b128 a[160:163], v142 offset:192
    ds_read_b128 a[192:195], v143 offset:3776
    v_mfma_f32_16x16x32_bf16 v[36:39], a[84:87], a[112:115], v[36:39]
    v_mfma_f32_16x16x32_bf16 v[40:43], a[84:87], a[116:119], v[40:43]
    s_waitcnt lgkmcnt(12)
    v_mfma_f32_16x16x32_bf16 v[40:43], a[80:83], a[120:123], v[40:43]
    ds_read_b128 a[164:167], v142 offset:704
    ds_read_b128 a[196:199], v143 offset:3264
    v_mfma_f32_16x16x32_bf16 v[40:43], a[88:91], a[112:115], v[40:43]
    v_mfma_f32_16x16x32_bf16 v[44:47], a[84:87], a[120:123], v[44:47]
    v_mfma_f32_16x16x32_bf16 v[44:47], a[88:91], a[116:119], v[44:47]
    v_mfma_f32_16x16x32_bf16 v[48:51], a[88:91], a[120:123], v[48:51]
    s_waitcnt lgkmcnt(12)
    v_mfma_f32_16x16x32_bf16 v[44:47], a[80:83], a[124:127], v[44:47]
    ds_read_b128 a[168:171], v142 offset:1216
    ds_read_b128 a[200:203], v143 offset:2752
    v_mfma_f32_16x16x32_bf16 v[44:47], a[92:95], a[112:115], v[44:47]
    v_mfma_f32_16x16x32_bf16 v[48:51], a[84:87], a[124:127], v[48:51]
    v_mfma_f32_16x16x32_bf16 v[48:51], a[92:95], a[116:119], v[48:51]
    v_mfma_f32_16x16x32_bf16 v[52:55], a[88:91], a[124:127], v[52:55]
    v_mfma_f32_16x16x32_bf16 v[52:55], a[92:95], a[120:123], v[52:55]
    v_mfma_f32_16x16x32_bf16 v[56:59], a[92:95], a[124:127], v[56:59]
    s_waitcnt lgkmcnt(12)
    v_mfma_f32_16x16x32_bf16 v[48:51], a[80:83], a[128:131], v[48:51]
    ds_read_b128 a[172:175], v142 offset:1728
    ds_read_b128 a[204:207], v143 offset:2240
    v_mfma_f32_16x16x32_bf16 v[48:51], a[96:99], a[112:115], v[48:51]
    v_mfma_f32_16x16x32_bf16 v[52:55], a[84:87], a[128:131], v[52:55]
    v_mfma_f32_16x16x32_bf16 v[52:55], a[96:99], a[116:119], v[52:55]
    v_mfma_f32_16x16x32_bf16 v[56:59], a[88:91], a[128:131], v[56:59]
    v_mfma_f32_16x16x32_bf16 v[56:59], a[96:99], a[120:123], v[56:59]
    v_mfma_f32_16x16x32_bf16 v[60:63], a[92:95], a[128:131], v[60:63]
    buffer_load_dword v127, v125, s[56:59], s60 offen
    v_mfma_f32_16x16x32_bf16 v[60:63], a[96:99], a[124:127], v[60:63]
    s_waitcnt lgkmcnt(12)
    v_mfma_f32_16x16x32_bf16 v[52:55], a[80:83], a[132:135], v[52:55]
    ds_read_b128 a[176:179], v142 offset:2240
    ds_read_b128 a[208:211], v143 offset:1728
    v_mfma_f32_16x16x32_bf16 v[52:55], a[100:103], a[112:115], v[52:55]
    v_mfma_f32_16x16x32_bf16 v[56:59], a[84:87], a[132:135], v[56:59]
    v_mfma_f32_16x16x32_bf16 v[56:59], a[100:103], a[116:119], v[56:59]
    v_mfma_f32_16x16x32_bf16 v[60:63], a[88:91], a[132:135], v[60:63]
    v_mfma_f32_16x16x32_bf16 v[60:63], a[100:103], a[120:123], v[60:63]
    s_waitcnt lgkmcnt(12)
    v_mfma_f32_16x16x32_bf16 v[56:59], a[80:83], a[136:139], v[56:59]
    ds_read_b128 a[180:183], v142 offset:2752
    ds_read_b128 a[212:215], v143 offset:1216
    v_mfma_f32_16x16x32_bf16 v[56:59], a[104:107], a[112:115], v[56:59]
    v_mfma_f32_16x16x32_bf16 v[60:63], a[84:87], a[136:139], v[60:63]
    v_mfma_f32_16x16x32_bf16 v[60:63], a[104:107], a[116:119], v[60:63]
    s_waitcnt lgkmcnt(12)
    v_mfma_f32_16x16x32_bf16 v[60:63], a[80:83], a[140:143], v[60:63]
    ds_read_b128 a[184:187], v142 offset:3264
    ds_read_b128 a[216:219], v143 offset:704
    v_mfma_f32_16x16x32_bf16 v[60:63], a[108:111], a[112:115], v[60:63]
    s_waitcnt lgkmcnt(12)
    v_mfma_f32_16x16x32_bf16 v[32:35], a[160:163], a[192:195], v[32:35]
    ds_read_b128 a[188:191], v142 offset:3776
    ds_read_b128 a[220:223], v143 offset:192
    s_waitcnt lgkmcnt(12)
    v_mfma_f32_16x16x32_bf16 v[36:39], a[160:163], a[196:199], v[36:39]
    v_mfma_f32_16x16x32_bf16 v[36:39], a[164:167], a[192:195], v[36:39]
    v_mfma_f32_16x16x32_bf16 v[40:43], a[164:167], a[196:199], v[40:43]
    s_waitcnt lgkmcnt(10)
    v_mfma_f32_16x16x32_bf16 v[40:43], a[160:163], a[200:203], v[40:43]
    v_mfma_f32_16x16x32_bf16 v[40:43], a[168:171], a[192:195], v[40:43]
    v_mfma_f32_16x16x32_bf16 v[44:47], a[164:167], a[200:203], v[44:47]
    v_mfma_f32_16x16x32_bf16 v[44:47], a[168:171], a[196:199], v[44:47]
    v_mfma_f32_16x16x32_bf16 v[48:51], a[168:171], a[200:203], v[48:51]
    s_waitcnt lgkmcnt(8)
    v_mfma_f32_16x16x32_bf16 v[44:47], a[160:163], a[204:207], v[44:47]
    v_mfma_f32_16x16x32_bf16 v[44:47], a[172:175], a[192:195], v[44:47]
    v_mfma_f32_16x16x32_bf16 v[48:51], a[164:167], a[204:207], v[48:51]
    v_mfma_f32_16x16x32_bf16 v[48:51], a[172:175], a[196:199], v[48:51]
    v_mfma_f32_16x16x32_bf16 v[52:55], a[168:171], a[204:207], v[52:55]
    v_mfma_f32_16x16x32_bf16 v[52:55], a[172:175], a[200:203], v[52:55]
    v_mfma_f32_16x16x32_bf16 v[56:59], a[172:175], a[204:207], v[56:59]
    s_waitcnt lgkmcnt(6)
    v_mfma_f32_16x16x32_bf16 v[48:51], a[160:163], a[208:211], v[48:51]
    v_mfma_f32_16x16x32_bf16 v[48:51], a[176:179], a[192:195], v[48:51]
    v_mfma_f32_16x16x32_bf16 v[52:55], a[164:167], a[208:211], v[52:55]
    v_mfma_f32_16x16x32_bf16 v[52:55], a[176:179], a[196:199], v[52:55]
    v_mfma_f32_16x16x32_bf16 v[56:59], a[168:171], a[208:211], v[56:59]
    v_mfma_f32_16x16x32_bf16 v[56:59], a[176:179], a[200:203], v[56:59]
    v_mfma_f32_16x16x32_bf16 v[60:63], a[172:175], a[208:211], v[60:63]
    v_mfma_f32_16x16x32_bf16 v[60:63], a[176:179], a[204:207], v[60:63]
    s_waitcnt lgkmcnt(4)
    v_mfma_f32_16x16x32_bf16 v[52:55], a[160:163], a[212:215], v[52:55]
    v_mfma_f32_16x16x32_bf16 v[52:55], a[180:183], a[192:195], v[52:55]
    v_mfma_f32_16x16x32_bf16 v[56:59], a[164:167], a[212:215], v[56:59]
    v_mfma_f32_16x16x32_bf16 v[56:59], a[180:183], a[196:199], v[56:59]
    v_mfma_f32_16x16x32_bf16 v[60:63], a[168:171], a[212:215], v[60:63]
    v_mfma_f32_16x16x32_bf16 v[60:63], a[180:183], a[200:203], v[60:63]
    s_waitcnt lgkmcnt(2)
    v_mfma_f32_16x16x32_bf16 v[56:59], a[160:163], a[216:219], v[56:59]
    v_mfma_f32_16x16x32_bf16 v[56:59], a[184:187], a[192:195], v[56:59]
    v_mfma_f32_16x16x32_bf16 v[60:63], a[164:167], a[216:219], v[60:63]
    v_mfma_f32_16x16x32_bf16 v[60:63], a[184:187], a[196:199], v[60:63]
    s_waitcnt lgkmcnt(0)
    v_mfma_f32_16x16x32_bf16 v[60:63], a[160:163], a[220:223], v[60:63]
    v_mfma_f32_16x16x32_bf16 v[60:63], a[188:191], a[192:195], v[60:63]
    ds_write_b128 v183, v[64:67] offset:4096
    ds_write_b128 v183, v[68:71] offset:5120
    s_bitcmp1_b32 s3, 0
    s_cbranch_scc1 K4_w1
    s_nop 3
    ds_write_b128 v183, v[48:51] offset:0
    ds_write_b128 v183, v[52:55] offset:1024
    ds_write_b128 v183, v[56:59] offset:2048
    ds_write_b128 v183, v[60:63] offset:3072
    s_branch K4_w2
K4_w1:
    s_nop 3
    ds_write_b128 v183, v[32:35] offset:0
    ds_write_b128 v183, v[36:39] offset:1024
    ds_write_b128 v183, v[40:43] offset:2048
    ds_write_b128 v183, v[44:47] offset:3072
    v_mov_b32 v32, v48
    v_mov_b32 v33, v49
    v_mov_b32 v34, v50
    v_mov_b32 v35, v51
    v_mov_b32 v36, v52
    v_mov_b32 v37, v53
    v_mov_b32 v38, v54
    v_mov_b32 v39, v55
    v_mov_b32 v40, v56
    v_mov_b32 v41, v57
    v_mov_b32 v42, v58
    v_mov_b32 v43, v59
    v_mov_b32 v44, v60
    v_mov_b32 v45, v61
    v_mov_b32 v46, v62
    v_mov_b32 v47, v63
K4_w2:
    s_waitcnt lgkmcnt(0)
    s_barrier
    ds_read_b128 v[96:99], v202 offset:0
    ds_read_b128 v[100:103], v202 offset:1024
    ds_read_b128 v[104:107], v202 offset:2048
    ds_read_b128 v[108:111], v202 offset:3072
    ds_read_b128 v[112:115], v203
    ds_read_b128 v[116:119], v203 offset:256
    s_waitcnt lgkmcnt(4)
    v_pk_add_f32 v[96:97], v[96:97], v[32:33]
    v_pk_add_f32 v[98:99], v[98:99], v[34:35]
    v_pk_add_f32 v[100:101], v[100:101], v[36:37]
    v_pk_add_f32 v[102:103], v[102:103], v[38:39]
    v_cvt_pk_bf16_f32 v76, v96, v97
    v_cvt_pk_bf16_f32 v77, v98, v99
    v_cvt_pk_bf16_f32 v78, v100, v101
    v_cvt_pk_bf16_f32 v79, v102, v103
    v_pk_min_u16 v76, v76, s34
    v_pk_min_u16 v77, v77, s34
    v_pk_min_u16 v78, v78, s34
    v_pk_min_u16 v79, v79, s34
    s_nop 0
    v_permlane16_swap_b32 v76, v78
    v_permlane16_swap_b32 v77, v79
    buffer_store_dwordx4 v[76:79], v164, s[24:27], 0 offen sc1
    s_waitcnt lgkmcnt(2)
    v_pk_add_f32 v[104:105], v[104:105], v[40:41]
    v_pk_add_f32 v[106:107], v[106:107], v[42:43]
    v_pk_add_f32 v[108:109], v[108:109], v[44:45]
    v_pk_add_f32 v[110:111], v[110:111], v[46:47]
    v_cvt_pk_bf16_f32 v80, v104, v105
    v_cvt_pk_bf16_f32 v81, v106, v107
    v_cvt_pk_bf16_f32 v82, v108, v109
    v_cvt_pk_bf16_f32 v83, v110, v111
    v_pk_min_u16 v80, v80, s34
    v_pk_min_u16 v81, v81, s34
    v_pk_min_u16 v82, v82, s34
    v_pk_min_u16 v83, v83, s34
    s_nop 0
    v_permlane16_swap_b32 v80, v82
    v_permlane16_swap_b32 v81, v83
    buffer_store_dwordx4 v[80:83], v164, s[24:27], s23 offen sc1
    s_waitcnt lgkmcnt(0)
    v_add_f32_dpp v112, v112, v112 row_ror:4 row_mask:0xf bank_mask:0xf
    v_add_f32_dpp v113, v113, v113 row_ror:4 row_mask:0xf bank_mask:0xf
    v_add_f32_dpp v114, v114, v114 row_ror:4 row_mask:0xf bank_mask:0xf
    v_add_f32_dpp v115, v115, v115 row_ror:4 row_mask:0xf bank_mask:0xf
    v_add_f32_dpp v116, v116, v116 row_ror:4 row_mask:0xf bank_mask:0xf
    v_add_f32_dpp v117, v117, v117 row_ror:4 row_mask:0xf bank_mask:0xf
    v_add_f32_dpp v118, v118, v118 row_ror:4 row_mask:0xf bank_mask:0xf
    v_add_f32_dpp v119, v119, v119 row_ror:4 row_mask:0xf bank_mask:0xf
    v_add_f32_dpp v112, v112, v112 row_ror:8 row_mask:0xf bank_mask:0xf
    v_add_f32_dpp v113, v113, v113 row_ror:8 row_mask:0xf bank_mask:0xf
    v_add_f32_dpp v114, v114, v114 row_ror:8 row_mask:0xf bank_mask:0xf
    v_add_f32_dpp v115, v115, v115 row_ror:8 row_mask:0xf bank_mask:0xf
    v_add_f32_dpp v116, v116, v116 row_ror:8 row_mask:0xf bank_mask:0xf
    v_add_f32_dpp v117, v117, v117 row_ror:8 row_mask:0xf bank_mask:0xf
    v_add_f32_dpp v118, v118, v118 row_ror:8 row_mask:0xf bank_mask:0xf
    v_add_f32_dpp v119, v119, v119 row_ror:8 row_mask:0xf bank_mask:0xf
    v_cvt_pk_bf16_f32 v84, v112, v113
    v_cvt_pk_bf16_f32 v85, v114, v115
    v_cvt_pk_bf16_f32 v86, v116, v117
    v_cvt_pk_bf16_f32 v87, v118, v119
    v_pk_min_u16 v84, v84, s34
    v_pk_min_u16 v85, v85, s34
    v_pk_min_u16 v86, v86, s34
    v_pk_min_u16 v87, v87, s34
    buffer_store_dwordx4 v[84:87], v165, s[24:27], 0 offen sc1
    buffer_load_dwordx4 v[168:171], v4, s[72:75], s35 offen sc1
    s_bitcmp1_b32 s2, 3
    s_cselect_b32 s56, s6, s4
    s_cselect_b32 s57, s7, s5
    s_lshr_b32 s60, s2, 4
    s_mul_i32 s60, s60, 73728
    s_add_u32 s60, s60, 2064384
    s_add_u32 s58, s60, 73728
    s_and_b32 s59, s2, 3
    s_mul_i32 s59, s59, 2304
    s_add_u32 s60, s60, s59
    s_mov_b32 s59, 0x00020000
    v_mul_u32_u24 v125, 3641, v0
    v_lshrrev_b32 v125, 16, v125
    v_mul_u32_u24 v125, 6912, v125
    v_lshl_add_u32 v125, v0, 7, v125
    buffer_load_dword v127, v125, s[56:59], s60 offen
    v_lshlrev_b32 v144, 16, v204
    v_and_b32 v145, 0xffff0000, v204
    v_lshlrev_b32 v146, 16, v205
    v_and_b32 v147, 0xffff0000, v205
    v_lshlrev_b32 v148, 16, v206
    v_and_b32 v149, 0xffff0000, v206
    v_lshlrev_b32 v150, 16, v207
    v_and_b32 v151, 0xffff0000, v207
    v_lshlrev_b32 v152, 16, v208
    v_and_b32 v153, 0xffff0000, v208
    v_lshlrev_b32 v154, 16, v209
    v_and_b32 v155, 0xffff0000, v209
    v_lshlrev_b32 v156, 16, v210
    v_and_b32 v157, 0xffff0000, v210
    v_lshlrev_b32 v158, 16, v211
    v_and_b32 v159, 0xffff0000, v211
    s_branch K4_ps2
K4_pg2:
    s_branch K4_vri
K4_ps2:
    v_lshlrev_b32 v160, 16, v212
    v_and_b32 v161, 0xffff0000, v212
    v_pk_add_f32 v[216:217], v[144:145], v[146:147]
    v_pk_add_f32 v[218:219], v[148:149], v[150:151]
    v_pk_add_f32 v[216:217], v[216:217], v[152:153]
    v_pk_add_f32 v[218:219], v[218:219], v[154:155]
    v_pk_add_f32 v[216:217], v[216:217], v[156:157]
    v_pk_add_f32 v[218:219], v[218:219], v[158:159]
    v_pk_add_f32 v[216:217], v[216:217], v[160:161]
    v_pk_add_f32 v[216:217], v[216:217], v[218:219]
    v_add_f32 v214, v216, v217
    s_nop 1
    v_add_f32_dpp v214, v214, v214 row_ror:8 row_mask:0xf bank_mask:0xf
    v_mov_b32 v216, v214
    s_nop 1
    v_permlane16_swap_b32 v214, v216
    v_add_f32 v214, v214, v216
    v_mov_b32 v216, v214
    s_nop 1
    v_permlane32_swap_b32 v214, v216
    v_add_f32 v214, v214, v216
    v_mul_f32 v214, 0x3be38e39, v214
    v_pk_add_f32 v[184:185], v[144:145], v[214:215] op_sel_hi:[1,0] neg_lo:[0,1] neg_hi:[0,1]
    v_pk_add_f32 v[186:187], v[146:147], v[214:215] op_sel_hi:[1,0] neg_lo:[0,1] neg_hi:[0,1]
    v_pk_add_f32 v[188:189], v[148:149], v[214:215] op_sel_hi:[1,0] neg_lo:[0,1] neg_hi:[0,1]
    v_pk_add_f32 v[190:191], v[150:151], v[214:215] op_sel_hi:[1,0] neg_lo:[0,1] neg_hi:[0,1]
    v_pk_add_f32 v[192:193], v[152:153], v[214:215] op_sel_hi:[1,0] neg_lo:[0,1] neg_hi:[0,1]
    v_pk_add_f32 v[194:195], v[154:155], v[214:215] op_sel_hi:[1,0] neg_lo:[0,1] neg_hi:[0,1]
    v_pk_add_f32 v[196:197], v[156:157], v[214:215] op_sel_hi:[1,0] neg_lo:[0,1] neg_hi:[0,1]
    v_pk_add_f32 v[198:199], v[158:159], v[214:215] op_sel_hi:[1,0] neg_lo:[0,1] neg_hi:[0,1]
    v_pk_add_f32 v[200:201], v[160:161], v[214:215] op_sel_hi:[1,0] neg_lo:[0,1] neg_hi:[0,1]
    v_pk_mul_f32 v[216:217], v[184:185], v[184:185]
    v_pk_mul_f32 v[218:219], v[186:187], v[186:187]
    v_pk_fma_f32 v[216:217], v[188:189], v[188:189], v[216:217]
    v_pk_fma_f32 v[218:219], v[190:191], v[190:191], v[218:219]
    v_pk_fma_f32 v[216:217], v[192:193], v[192:193], v[216:217]
    v_pk_fma_f32 v[218:219], v[194:195], v[194:195], v[218:219]
    v_pk_fma_f32 v[216:217], v[196:197], v[196:197], v[216:217]
    v_pk_fma_f32 v[218:219], v[198:199], v[198:199], v[218:219]
    v_pk_fma_f32 v[216:217], v[200:201], v[200:201], v[216:217]
    v_pk_add_f32 v[216:217], v[216:217], v[218:219]
    v_add_f32 v215, v216, v217
    s_nop 1
    v_add_f32_dpp v215, v215, v215 row_ror:8 row_mask:0xf bank_mask:0xf
    v_mov_b32 v216, v215
    s_nop 1
    v_permlane16_swap_b32 v215, v216
    v_add_f32 v215, v215, v216
    v_mov_b32 v216, v215
    s_nop 1
    v_permlane32_swap_b32 v215, v216
    v_add_f32 v215, v215, v216
    s_mov_b64 exec, 0xff
    ds_write_b64 v135, v[214:215] offset:0
    s_mov_b64 exec, -1
    s_waitcnt lgkmcnt(0)
    s_barrier
    s_and_b32 s12, s2, 4
    s_bfe_u32 s13, s2, 0x20003
    s_add_u32 s12, s12, s13
    s_and_b32 s13, s2, 3
    s_lshl_b32 s13, s13, 1
    s_lshr_b32 s14, s2, 7
    s_add_u32 s13, s13, s14
    s_bfe_u32 s14, s2, 0x20005
    s_mul_i32 s13, s13, 9
    s_and_b32 s8, s12, 3
    s_mul_i32 s8, s8, 2
    s_add_u32 s15, s14, s8
    s_add_u32 s9, s15, 4
    s_add_u32 s8, s8, 8
    s_cmp_ge_u32 s15, 9
    s_cselect_b32 s45, 9, 0
    s_sub_u32 s15, s15, s45
    s_add_u32 s15, s15, s13
    s_cmp_ge_u32 s9, 9
    s_cselect_b32 s45, 9, 0
    s_sub_u32 s9, s9, s45
    s_add_u32 s9, s9, s13
    s_cmp_ge_u32 s8, 9
    s_cselect_b32 s45, 9, 0
    s_sub_u32 s8, s8, s45
    s_add_u32 s8, s8, s13
    s_lshl_b32 s61, s9, 7
    v_add_u32 v5, 0, v4
    v_add_u32 v6, 18432, v4
    v_add_u32 v7, 36864, v4
    v_add_u32 v8, 55296, v4
    s_lshl_b32 s41, s12, 2
    s_add_u32 s41, s41, s3
    s_mul_i32 s41, s41, 73728
    s_add_u32 s41, s41, 4194304
    v_lshrrev_b32 v2, 3, v0
    v_mul_u32_u24 v2, 9216, v2
    v_bfe_u32 v3, v0, 4, 1
    v_bfe_u32 v9, v0, 6, 1
    v_lshl_add_u32 v3, v9, 1, v3
    v_lshlrev_b32 v3, 1, v3
    v_and_b32 v9, 7, v0
    v_xor_b32 v3, v3, v9
    v_lshl_add_u32 v2, v3, 4, v2
    s_lshl_b32 s40, s15, 7
    s_lshl_b32 s46, s12, 2
    s_add_u32 s46, s46, s3
    s_lshl_b32 s46, s46, 10
    s_add_u32 s46, s46, 4096
    v_lshlrev_b32 v141, 7, v128
    v_add_u32 v141, s46, v141
    v_lshrrev_b32 v9, 4, v1
    v_bfe_u32 v10, v1, 2, 2
    v_lshl_add_u32 v9, v9, 3, v10
    v_lshlrev_b32 v9, 7, v9
    v_and_b32 v10, 3, v1
    v_lshl_add_u32 v9, v10, 3, v9
    v_bfe_u32 v10, v1, 3, 2
    v_lshl_add_u32 v10, v10, 5, v9
    v_xor_b32 v11, 32, v10
    v_xor_b32 v12, 64, v10
    v_xor_b32 v13, 96, v10
    v_add_u32 v14, 0x10000, v10
    v_add_u32 v15, 0x10000, v11
    v_add_u32 v16, 0x10000, v12
    v_add_u32 v17, 0x10000, v13
    ds_read_b128 v[220:223], v136 offset:0
    ds_read_b128 v[224:227], v136 offset:16
    s_waitcnt lgkmcnt(0)
    v_add_f32 v216, v220, v222
    v_add_f32 v217, v224, v226
    v_add_f32 v215, v221, v223
    v_add_f32 v216, v216, v217
    v_add_f32 v215, v215, v225
    v_mul_f32 v216, 0x3e800000, v216
    v_add_f32 v215, v215, v227
    v_sub_f32 v220, v220, v216
    v_sub_f32 v222, v222, v216
    v_sub_f32 v224, v224, v216
    v_sub_f32 v226, v226, v216
    v_mul_f32 v221, v220, v220
    v_fmac_f32 v221, v222, v222
    v_fmac_f32 v221, v224, v224
    v_fmac_f32 v221, v226, v226
    v_sub_f32 v217, v214, v216
    v_fmac_f32 v215, 0x43100000, v221
    v_mov_b32 v216, 0x3727c5ac
    v_fmac_f32 v216, 0x3ae38e39, v215
    v_rsq_f32 v215, v216
    v_pk_add_f32 v[184:185], v[184:185], v[216:217] op_sel:[0,1]
    v_pk_add_f32 v[186:187], v[186:187], v[216:217] op_sel:[0,1]
    v_pk_add_f32 v[188:189], v[188:189], v[216:217] op_sel:[0,1]
    v_pk_add_f32 v[190:191], v[190:191], v[216:217] op_sel:[0,1]
    v_pk_add_f32 v[192:193], v[192:193], v[216:217] op_sel:[0,1]
    v_pk_add_f32 v[194:195], v[194:195], v[216:217] op_sel:[0,1]
    v_pk_add_f32 v[196:197], v[196:197], v[216:217] op_sel:[0,1]
    v_pk_add_f32 v[198:199], v[198:199], v[216:217] op_sel:[0,1]
    v_pk_add_f32 v[200:201], v[200:201], v[216:217] op_sel:[0,1]
    v_pk_mul_f32 v[184:185], v[184:185], v[214:215] op_sel:[0,1]
    v_pk_mul_f32 v[186:187], v[186:187], v[214:215] op_sel:[0,1]
    v_pk_mul_f32 v[188:189], v[188:189], v[214:215] op_sel:[0,1]
    v_pk_mul_f32 v[190:191], v[190:191], v[214:215] op_sel:[0,1]
    v_pk_mul_f32 v[192:193], v[192:193], v[214:215] op_sel:[0,1]
    v_pk_mul_f32 v[194:195], v[194:195], v[214:215] op_sel:[0,1]
    v_pk_mul_f32 v[196:197], v[196:197], v[214:215] op_sel:[0,1]
    v_pk_mul_f32 v[198:199], v[198:199], v[214:215] op_sel:[0,1]
    v_pk_mul_f32 v[200:201], v[200:201], v[214:215] op_sel:[0,1]
    s_mov_b32 s16, s4
    s_mov_b32 s17, s5
    s_mov_b32 s18, 5308416
    s_mov_b32 s19, 0x00020000
    s_mov_b32 s20, s6
    s_mov_b32 s21, s7
    s_mov_b32 s22, 5308416
    s_mov_b32 s23, 0x00020000
    s_add_u32 m0, s42, 0
    s_nop 0
    buffer_load_dwordx4 v2, s[16:19], s40 offen  lds
    s_add_u32 m0, s42, 4096
    s_nop 0
    buffer_load_dwordx4 v2, s[20:23], s40 offen  lds
    s_add_u32 s40, s40, 294912
    s_add_u32 m0, s42, 8192
    s_nop 0
    buffer_load_dwordx4 v2, s[16:19], s40 offen  lds
    s_add_u32 m0, s42, 12288
    s_nop 0
    buffer_load_dwordx4 v2, s[20:23], s40 offen  lds
    s_add_u32 s40, s40, 294912
    s_add_u32 m0, s42, 16384
    s_nop 0
    buffer_load_dwordx4 v2, s[16:19], s40 offen  lds
    s_add_u32 m0, s42, 20480
    s_nop 0
    buffer_load_dwordx4 v2, s[20:23], s40 offen  lds
    s_add_u32 s40, s40, 294912
    s_add_u32 m0, s42, 24576
    s_nop 0
    buffer_load_dwordx4 v2, s[16:19], s40 offen  lds
    s_add_u32 m0, s42, 28672
    s_nop 0
    buffer_load_dwordx4 v2, s[20:23], s40 offen  lds
    s_add_u32 s40, s40, 294912
    s_add_u32 m0, s42, 32768
    s_nop 0
    buffer_load_dwordx4 v2, s[16:19], s40 offen  lds
    s_add_u32 m0, s42, 36864
    s_nop 0
    buffer_load_dwordx4 v2, s[20:23], s40 offen  lds
    s_add_u32 s40, s40, 294912
    s_add_u32 m0, s42, 40960
    s_nop 0
    buffer_load_dwordx4 v2, s[16:19], s40 offen  lds
    s_add_u32 m0, s42, 45056
    s_nop 0
    buffer_load_dwordx4 v2, s[20:23], s40 offen  lds
    s_add_u32 s40, s40, 294912
    s_waitcnt vmcnt(13)
    v_xor_b32 v168, v22, v168
    v_xor_b32 v169, v22, v169
    v_xor_b32 v170, v22, v170
    v_xor_b32 v171, v22, v171
    v_or3_b32 v168, v168, v169, v170
    v_or_b32 v168, v168, v171
    v_cmp_ne_u32 vcc, 0, v168
    s_cbranch_vccnz K4_slowa
K4_oka:
K4_py:
    s_add_u32 m0, s42, 148992
    buffer_load_short_d16_hi v180, v133, s[24:27], s101 offen sc1
    buffer_load_dwordx4 v132, s[24:27], 0 offen sc1 lds
    s_add_u32 m0, s42, 153088
    buffer_load_short_d16_hi v181, v133, s[24:27], s101 offen offset:64 sc1
    buffer_load_dwordx4 v132, s[24:27], s100 offen sc1 lds
    s_cmp_eq_u32 s79, 0
    s_waitcnt vmcnt(0)
    s_cbranch_scc1 K4_pyx
    s_sub_u32 s79, s79, 1
    ds_read_b64_tr_b16 v[204:205], v134 offset:0
    ds_read_b64_tr_b16 v[206:207], v134 offset:64
    ds_read_b64_tr_b16 v[208:209], v134 offset:4096
    ds_read_b64_tr_b16 v[210:211], v134 offset:4160
    v_max_u32 v216, v180, v181
    s_waitcnt lgkmcnt(0)
    v_pk_max_u16 v217, v204, v205
    v_pk_max_u16 v216, v216, v206
    v_pk_max_u16 v217, v217, v207
    v_pk_max_u16 v216, v216, v208
    v_pk_max_u16 v217, v217, v209
    v_pk_max_u16 v216, v216, v210
    v_pk_max_u16 v217, v217, v211
    v_pk_max_u16 v216, v216, v217
    v_pk_min_u16 v217, v216, s34
    v_cmp_ne_u32 vcc, v216, v217
    s_cbranch_vccnz K4_py
K4_pyx:
    v_lshlrev_b32 v164, 16, v204
    v_and_b32 v165, 0xffff0000, v204
    v_lshlrev_b32 v166, 16, v205
    v_and_b32 v167, 0xffff0000, v205
    v_lshlrev_b32 v168, 16, v206
    v_and_b32 v169, 0xffff0000, v206
    v_lshlrev_b32 v170, 16, v207
    v_and_b32 v171, 0xffff0000, v207
    v_lshlrev_b32 v172, 16, v208
    v_and_b32 v173, 0xffff0000, v208
    v_lshlrev_b32 v174, 16, v209
    v_and_b32 v175, 0xffff0000, v209
    v_lshlrev_b32 v176, 16, v210
    v_and_b32 v177, 0xffff0000, v210
    v_lshlrev_b32 v178, 16, v211
    v_and_b32 v179, 0xffff0000, v211
    v_pk_fma_f32 v[144:145], v[184:185], v[164:165], v[144:145]
    v_pk_fma_f32 v[146:147], v[186:187], v[166:167], v[146:147]
    v_pk_fma_f32 v[148:149], v[188:189], v[168:169], v[148:149]
    v_pk_fma_f32 v[150:151], v[190:191], v[170:171], v[150:151]
    v_pk_fma_f32 v[152:153], v[192:193], v[172:173], v[152:153]
    v_pk_fma_f32 v[154:155], v[194:195], v[174:175], v[154:155]
    v_pk_fma_f32 v[156:157], v[196:197], v[176:177], v[156:157]
    v_pk_fma_f32 v[158:159], v[198:199], v[178:179], v[158:159]
    v_pk_fma_f32 v[160:161], v[200:201], v[180:181], v[160:161]
    v_cvt_pk_bf16_f32 v204, v144, v145
    v_cvt_pk_bf16_f32 v205, v146, v147
    v_cvt_pk_bf16_f32 v206, v148, v149
    v_cvt_pk_bf16_f32 v207, v150, v151
    v_cvt_pk_bf16_f32 v208, v152, v153
    v_cvt_pk_bf16_f32 v209, v154, v155
    v_cvt_pk_bf16_f32 v210, v156, v157
    v_cvt_pk_bf16_f32 v211, v158, v159
    v_cvt_pk_bf16_f32 v212, v160, v161
    v_lshlrev_b32 v144, 16, v204
    v_and_b32 v145, 0xffff0000, v204
    v_lshlrev_b32 v146, 16, v205
    v_and_b32 v147, 0xffff0000, v205
    v_lshlrev_b32 v148, 16, v206
    v_and_b32 v149, 0xffff0000, v206
    v_lshlrev_b32 v150, 16, v207
    v_and_b32 v151, 0xffff0000, v207
    v_lshlrev_b32 v152, 16, v208
    v_and_b32 v153, 0xffff0000, v208
    v_lshlrev_b32 v154, 16, v209
    v_and_b32 v155, 0xffff0000, v209
    v_lshlrev_b32 v156, 16, v210
    v_and_b32 v157, 0xffff0000, v210
    v_lshlrev_b32 v158, 16, v211
    v_and_b32 v159, 0xffff0000, v211
    v_lshlrev_b32 v160, 16, v212
    v_and_b32 v161, 0xffff0000, v212
    v_pk_add_f32 v[216:217], v[144:145], v[146:147]
    v_pk_add_f32 v[218:219], v[148:149], v[150:151]
    v_pk_add_f32 v[216:217], v[216:217], v[152:153]
    v_pk_add_f32 v[218:219], v[218:219], v[154:155]
    v_pk_add_f32 v[216:217], v[216:217], v[156:157]
    v_pk_add_f32 v[218:219], v[218:219], v[158:159]
    v_pk_add_f32 v[216:217], v[216:217], v[160:161]
    v_pk_add_f32 v[216:217], v[216:217], v[218:219]
    v_add_f32 v214, v216, v217
    s_nop 1
    v_add_f32_dpp v214, v214, v214 row_ror:8 row_mask:0xf bank_mask:0xf
    v_mov_b32 v216, v214
    s_nop 1
    v_permlane16_swap_b32 v214, v216
    v_add_f32 v214, v214, v216
    v_mov_b32 v216, v214
    s_nop 1
    v_permlane32_swap_b32 v214, v216
    v_add_f32 v214, v214, v216
    v_mul_f32 v214, 0x3be38e39, v214
    v_pk_add_f32 v[184:185], v[144:145], v[214:215] op_sel_hi:[1,0] neg_lo:[0,1] neg_hi:[0,1]
    v_pk_add_f32 v[186:187], v[146:147], v[214:215] op_sel_hi:[1,0] neg_lo:[0,1] neg_hi:[0,1]
    v_pk_add_f32 v[188:189], v[148:149], v[214:215] op_sel_hi:[1,0] neg_lo:[0,1] neg_hi:[0,1]
    v_pk_add_f32 v[190:191], v[150:151], v[214:215] op_sel_hi:[1,0] neg_lo:[0,1] neg_hi:[0,1]
    v_pk_add_f32 v[192:193], v[152:153], v[214:215] op_sel_hi:[1,0] neg_lo:[0,1] neg_hi:[0,1]
    v_pk_add_f32 v[194:195], v[154:155], v[214:215] op_sel_hi:[1,0] neg_lo:[0,1] neg_hi:[0,1]
    v_pk_add_f32 v[196:197], v[156:157], v[214:215] op_sel_hi:[1,0] neg_lo:[0,1] neg_hi:[0,1]
    v_pk_add_f32 v[198:199], v[158:159], v[214:215] op_sel_hi:[1,0] neg_lo:[0,1] neg_hi:[0,1]
    v_pk_add_f32 v[200:201], v[160:161], v[214:215] op_sel_hi:[1,0] neg_lo:[0,1] neg_hi:[0,1]
    v_pk_mul_f32 v[216:217], v[184:185], v[184:185]
    v_pk_mul_f32 v[218:219], v[186:187], v[186:187]
    v_pk_fma_f32 v[216:217], v[188:189], v[188:189], v[216:217]
    v_pk_fma_f32 v[218:219], v[190:191], v[190:191], v[218:219]
    v_pk_fma_f32 v[216:217], v[192:193], v[192:193], v[216:217]
    v_pk_fma_f32 v[218:219], v[194:195], v[194:195], v[218:219]
    v_pk_fma_f32 v[216:217], v[196:197], v[196:197], v[216:217]
    v_pk_fma_f32 v[218:219], v[198:199], v[198:199], v[218:219]
    v_pk_fma_f32 v[216:217], v[200:201], v[200:201], v[216:217]
    v_pk_add_f32 v[216:217], v[216:217], v[218:219]
    v_add_f32 v215, v216, v217
    s_nop 1
    v_add_f32_dpp v215, v215, v215 row_ror:8 row_mask:0xf bank_mask:0xf
    v_mov_b32 v216, v215
    s_nop 1
    v_permlane16_swap_b32 v215, v216
    v_add_f32 v215, v215, v216
    v_mov_b32 v216, v215
    s_nop 1
    v_permlane32_swap_b32 v215, v216
    v_add_f32 v215, v215, v216
    s_mov_b64 exec, 0xff
    ds_write_b64 v135, v[214:215] offset:256
    s_mov_b64 exec, -1
    s_waitcnt lgkmcnt(0)
    s_barrier
    ds_read_b128 v[220:223], v136 offset:256
    ds_read_b128 v[224:227], v136 offset:272
    buffer_store_dwordx4 v[204:207], v137, s[24:27], 0 offen sc1
    buffer_store_dwordx4 v[208:211], v138, s[24:27], 0 offen sc1
    v_mov_b32 v174, v212
    s_mov_b32 s45, 4194304
    v_mov_b32 v176, v22
    v_mov_b32 v177, v22
    v_mov_b32 v178, v22
    v_mov_b32 v179, v22
    s_waitcnt lgkmcnt(0)
    v_add_f32 v216, v220, v222
    v_add_f32 v217, v224, v226
    v_add_f32 v215, v221, v223
    v_add_f32 v216, v216, v217
    v_add_f32 v215, v215, v225
    v_mul_f32 v216, 0x3e800000, v216
    v_add_f32 v215, v215, v227
    v_sub_f32 v220, v220, v216
    v_sub_f32 v222, v222, v216
    v_sub_f32 v224, v224, v216
    v_sub_f32 v226, v226, v216
    v_mul_f32 v221, v220, v220
    v_fmac_f32 v221, v222, v222
    v_fmac_f32 v221, v224, v224
    v_fmac_f32 v221, v226, v226
    v_sub_f32 v217, v214, v216
    v_fmac_f32 v215, 0x43100000, v221
    v_mov_b32 v216, 0x3727c5ac
    v_fmac_f32 v216, 0x3ae38e39, v215
    v_rsq_f32 v215, v216
    s_nop 0
    v_mul_f32 v217, v217, v215
    v_pk_fma_f32 v[184:185], v[184:185], v[214:215], v[216:217] op_sel:[0,1,1]
    v_pk_fma_f32 v[188:189], v[188:189], v[214:215], v[216:217] op_sel:[0,1,1]
    v_pk_fma_f32 v[186:187], v[186:187], v[214:215], v[216:217] op_sel:[0,1,1]
    v_pk_fma_f32 v[190:191], v[190:191], v[214:215], v[216:217] op_sel:[0,1,1]
    v_cvt_pk_bf16_f32 v164, v184, v185
    v_cvt_pk_bf16_f32 v166, v188, v189
    v_cvt_pk_bf16_f32 v165, v186, v187
    v_cvt_pk_bf16_f32 v167, v190, v191
    v_min_u32 v164, -2, v164
    v_min_u32 v166, -2, v166
    buffer_store_dwordx4 v[164:167], v137, s[24:27], s45 offen sc1
    v_pk_fma_f32 v[200:201], v[200:201], v[214:215], v[216:217] op_sel:[0,1,1]
    v_pk_fma_f32 v[192:193], v[192:193], v[214:215], v[216:217] op_sel:[0,1,1]
    v_pk_fma_f32 v[194:195], v[194:195], v[214:215], v[216:217] op_sel:[0,1,1]
    v_pk_fma_f32 v[196:197], v[196:197], v[214:215], v[216:217] op_sel:[0,1,1]
    v_pk_fma_f32 v[198:199], v[198:199], v[214:215], v[216:217] op_sel:[0,1,1]
    v_cvt_pk_bf16_f32 v172, v200, v201
    v_cvt_pk_bf16_f32 v168, v192, v193
    v_cvt_pk_bf16_f32 v169, v194, v195
    v_permlane16_swap_b32 v172, v174
    v_cvt_pk_bf16_f32 v170, v196, v197
    v_cvt_pk_bf16_f32 v171, v198, v199
    buffer_store_dwordx4 v[168:171], v138, s[24:27], s45 offen sc1
    v_mov_b32_dpp v173, v172 row_shl:8 row_mask:0xf bank_mask:0xf
    v_mov_b32_dpp v175, v174 row_shl:8 row_mask:0xf bank_mask:0xf
    buffer_store_dwordx4 v[172:175], v139, s[24:27], 0 offen sc1
    s_mov_b32 s34, 5308416
    s_add_u32 m0, s42, 49152
    s_nop 0
    buffer_load_dwordx4 v2, s[16:19], s40 offen  lds
    s_add_u32 m0, s42, 53248
    s_nop 0
    buffer_load_dwordx4 v2, s[20:23], s40 offen  lds
    s_add_u32 s40, s40, 294912
    s_add_u32 m0, s42, 57344
    s_nop 0
    buffer_load_dwordx4 v2, s[16:19], s40 offen  lds
    s_add_u32 m0, s42, 61440
    s_nop 0
    buffer_load_dwordx4 v2, s[20:23], s40 offen  lds
    s_add_u32 s40, s40, 294912
    s_add_u32 m0, s42, 65536
    s_nop 0
    buffer_load_dwordx4 v2, s[16:19], s40 offen  lds
    s_add_u32 m0, s42, 69632
    s_nop 0
    buffer_load_dwordx4 v2, s[20:23], s40 offen  lds
    s_add_u32 s40, s40, 294912
    v_and_b32 v18, 31, v1
    v_lshlrev_b32 v18, 3, v18
    v_lshrrev_b32 v9, 5, v1
    v_lshl_add_u32 v18, v9, 9, v18
    v_add_u32 v31, 147456, v18
    v_add_u32 v18, 114688, v18
    v_bfe_u32 v3, v1, 1, 2
    v_bfe_u32 v9, v1, 4, 1
    v_lshl_add_u32 v3, v9, 2, v3
    v_bfe_u32 v9, v1, 3, 1
    v_lshl_add_u32 v3, v9, 3, v3
    v_bfe_u32 v9, v1, 5, 1
    v_lshl_add_u32 v3, v9, 4, v3
    v_mul_u32_u24 v3, 9216, v3
    v_and_b32 v9, 1, v1
    v_lshl_add_u32 v3, v9, 4, v3
    s_cmp_ge_u32 s3, 2
    s_cselect_b32 s32, s6, s4
    s_cselect_b32 s33, s7, s5
    s_mov_b32 s35, 0x00020000
    s_and_b32 s43, s3, 1
    s_mul_i32 s43, s43, 2654208
    s_lshl_b32 s45, s8, 2
    s_add_u32 s45, s45, s14
    s_lshl_b32 s46, s45, 5
    s_add_u32 s43, s43, s46
    s_mul_i32 s44, s3, 9216
    s_add_u32 s44, s44, 114688
    s_add_u32 s28, s10, 16777216
    s_addc_u32 s29, s11, 0
    s_mov_b32 s30, 18874368
    s_mov_b32 s31, 0x00020000
    s_lshl_b32 s46, s12, 2
    s_add_u32 s46, s46, s3
    s_mul_i32 s46, s46, 576
    s_add_u32 s45, s45, s46
    s_lshl_b32 s54, s45, 10
    s_add_u32 s55, s54, 294912
    s_lshl_b32 s47, s15, 2
    s_add_u32 s47, s46, s47
    s_lshl_b32 s50, s47, 10
    s_add_u32 s51, s50, 294912
    s_lshl_b32 s47, s9, 2
    s_add_u32 s47, s46, s47
    s_lshl_b32 s52, s47, 10
    s_add_u32 s53, s52, 294912
    s_and_b32 s12, s2, 3
    s_and_b32 s13, s2, 4
    s_lshl_b32 s13, s13, 1
    s_bfe_u32 s14, s2, 0x30003
    s_add_u32 s13, s13, s14
    s_lshr_b32 s14, s2, 6
    s_lshl_b32 s46, s12, 6
    s_lshr_b32 s47, s2, 3
    s_add_u32 s46, s46, s47
    s_and_b32 s47, s2, 4
    s_lshl_b32 s47, s47, 3
    s_add_u32 s46, s46, s47
    s_xor_b32 s47, s46, 32
    v_cmp_gt_u32 vcc, 162, v0
    s_mul_i32 s46, s46, 20736
    s_mul_i32 s47, s47, 20736
    v_lshlrev_b32 v19, 7, v0
    v_cndmask_b32 v19, v20, v19, vcc
    s_lshl_b32 s48, s13, 2
    s_add_u32 s48, s48, s14
    s_mul_i32 s48, s48, 114688
    s_mul_i32 s60, s12, 28672
    s_add_u32 s49, s60, s48
    v_lshrrev_b32 v29, 5, v1
    v_mul_u32_u24 v29, 290816, v29
    v_lshl_add_u32 v29, v1, 7, v29
    s_lshr_b32 s62, s2, 7
    s_mul_i32 s62, s62, 294912
    s_mul_i32 s63, s12, 73728
    s_add_u32 s62, s62, s63
    s_bfe_u32 s63, s2, 0x40003
    s_mul_i32 s63, s63, 4608
    s_add_u32 s62, s62, s63
    s_add_u32 s66, s62, 4608
    s_bfe_u32 s76, s2, 0x20003
    s_lshl_b32 s76, s76, 7
    s_lshr_b32 s77, s2, 5
    s_lshl_b32 s77, s77, 4
    s_add_u32 s76, s76, s77
    s_and_b32 s77, s2, 7
    s_lshl_b32 s77, s77, 9
    v_cmp_gt_u32 vcc, 2, v0
    s_add_u32 s78, s76, s77
    v_mul_u32_u24 v21, 81920, v0
    v_add_u32 v21, s78, v21
    v_cndmask_b32 v21, v20, v21, vcc
    s_bfe_u32 s78, s2, 0x20004
    s_lshl_b32 s78, s78, 7
    s_add_u32 s77, s77, s78
    v_and_b32 v30, 7, v1
    v_lshlrev_b32 v30, 4, v30
    v_add_u32 v30, s77, v30
    s_and_b32 s78, s2, 4
    s_lshl_b32 s78, s78, 9
    s_add_u32 s76, s76, s78
    s_add_u32 s76, s76, 4096
    v_and_b32 v23, 3, v1
    v_cmp_gt_u32 vcc, 32, v1
    v_lshlrev_b32 v23, 9, v23
    v_add_u32 v23, s76, v23
    v_cndmask_b32 v23, v23, v30, vcc
    s_add_u32 s56, s10, 37748736
    s_addc_u32 s57, s11, 0
    s_mov_b32 s58, 7340032
    s_mov_b32 s59, 0x00020000
    s_add_u32 s60, s49, s42
    s_cmp_eq_u32 s3, 0
    s_cbranch_scc1 K4_pg5
    s_cmp_eq_u32 s3, 1
    s_cbranch_scc1 K4_pg6
    s_cmp_eq_u32 s3, 2
    s_cbranch_scc1 K4_pg7
    s_cmp_eq_u32 s3, 3
    s_cbranch_scc1 K4_pg8
K4_vrA:
    s_mov_b32 s63, s41
    v_mov_b32 v96, v141
    v_or_b32 v124, s2, v0
    v_lshlrev_b32 v124, 20, v124
    v_add_u32 v124, 69632, v124
    buffer_load_dwordx4 a[0:3], v5, s[24:27], s41 offen offset:0 sc1
    buffer_load_dwordx4 a[4:7], v6, s[24:27], s41 offen offset:0 sc1
    buffer_load_dwordx4 a[8:11], v7, s[24:27], s41 offen offset:0 sc1
    buffer_load_dwordx4 a[12:15], v8, s[24:27], s41 offen offset:0 sc1
    buffer_load_dwordx4 a[16:19], v5, s[24:27], s41 offen offset:1024 sc1
    buffer_load_dwordx4 a[20:23], v6, s[24:27], s41 offen offset:1024 sc1
    buffer_load_dwordx4 a[24:27], v7, s[24:27], s41 offen offset:1024 sc1
    buffer_load_dwordx4 a[28:31], v8, s[24:27], s41 offen offset:1024 sc1
    s_waitcnt vmcnt(14)
    s_barrier
    buffer_store_dwordx4 v[176:179], v140, s[72:75], 0 offen sc1
    s_cmp_eq_u32 s3, 0
    s_cbranch_scc1 K4_pg9
    s_cmp_eq_u32 s3, 1
    s_cbranch_scc1 K4_pg10
    s_cmp_eq_u32 s3, 2
    s_cbranch_scc1 K4_pg11
K4_vrB:
    buffer_load_dwordx4 a[32:35], v5, s[24:27], s41 offen offset:2048 sc1
    buffer_load_dwordx4 a[36:39], v6, s[24:27], s41 offen offset:2048 sc1
    buffer_load_dwordx4 a[40:43], v7, s[24:27], s41 offen offset:2048 sc1
    buffer_load_dwordx4 a[44:47], v8, s[24:27], s41 offen offset:2048 sc1
    buffer_load_dwordx4 a[48:51], v5, s[24:27], s41 offen offset:3072 sc1
    buffer_load_dwordx4 a[52:55], v6, s[24:27], s41 offen offset:3072 sc1
    buffer_load_dwordx4 a[56:59], v7, s[24:27], s41 offen offset:3072 sc1
    buffer_load_dwordx4 a[60:63], v8, s[24:27], s41 offen offset:3072 sc1
    s_add_u32 s41, s41, 4096
    buffer_store_dword v22, v124, s[72:75], 0 offen
    ds_read_b64_tr_b16 v[32:33], v10 offset:0
    ds_read_b64_tr_b16 v[34:35], v10 offset:512
    ds_read_b64_tr_b16 v[36:37], v10 offset:4096
    ds_read_b64_tr_b16 v[38:39], v10 offset:4608
    ds_read_b64_tr_b16 v[40:41], v11 offset:0
    ds_read_b64_tr_b16 v[42:43], v11 offset:512
    ds_read_b64_tr_b16 v[44:45], v11 offset:4096
    ds_read_b64_tr_b16 v[46:47], v11 offset:4608
    ds_read_b64_tr_b16 v[48:49], v12 offset:0
    ds_read_b64_tr_b16 v[50:51], v12 offset:512
    s_waitcnt vmcnt(14)
    v_accvgpr_read_b32 v100, a0
    v_accvgpr_read_b32 v101, a2
    v_accvgpr_read_b32 v102, a4
    v_accvgpr_read_b32 v103, a6
    v_accvgpr_read_b32 v104, a8
    v_accvgpr_read_b32 v105, a10
    v_accvgpr_read_b32 v106, a12
    v_accvgpr_read_b32 v107, a14
    v_max3_u32 v100, v100, v101, v102
    v_max3_u32 v103, v103, v104, v105
    v_max3_u32 v100, v100, v103, v106
    v_max3_u32 v100, v100, v107, v107
    v_cmp_eq_u32 vcc, -1, v100
    s_cbranch_vccnz K4_slowb0
K4_okb0:
    s_waitcnt lgkmcnt(6)
    v_mfma_f32_16x16x32_bf16 v[128:131], v[32:35], a[0:3], 0
    ds_read_b64_tr_b16 v[52:53], v12 offset:4096
    v_mfma_f32_16x16x32_bf16 v[144:147], v[36:39], a[0:3], 0
    ds_read_b64_tr_b16 v[54:55], v12 offset:4608
    v_mfma_f32_16x16x32_bf16 v[148:151], v[36:39], a[4:7], 0
    buffer_load_dwordx4 a[64:67], v5, s[24:27], s41 offen offset:0 sc1
    v_mfma_f32_16x16x32_bf16 v[132:135], v[32:35], a[4:7], 0
    v_mfma_f32_16x16x32_bf16 v[136:139], v[32:35], a[8:11], 0
    ds_read_b64_tr_b16 v[56:57], v13 offset:0
    v_mfma_f32_16x16x32_bf16 v[152:155], v[36:39], a[8:11], 0
    ds_read_b64_tr_b16 v[58:59], v13 offset:512
    v_mfma_f32_16x16x32_bf16 v[156:159], v[36:39], a[12:15], 0
    buffer_load_dwordx4 a[68:71], v6, s[24:27], s41 offen offset:0 sc1
    v_mfma_f32_16x16x32_bf16 v[140:143], v[32:35], a[12:15], 0
    s_waitcnt lgkmcnt(6)
    v_mfma_f32_16x16x32_bf16 v[172:175], v[40:43], a[12:15], 0
    ds_read_b64_tr_b16 v[60:61], v13 offset:4096
    v_mfma_f32_16x16x32_bf16 v[188:191], v[44:47], a[12:15], 0
    ds_read_b64_tr_b16 v[62:63], v13 offset:4608
    v_mfma_f32_16x16x32_bf16 v[184:187], v[44:47], a[8:11], 0
    buffer_load_dwordx4 a[72:75], v7, s[24:27], s41 offen offset:0 sc1
    v_mfma_f32_16x16x32_bf16 v[168:171], v[40:43], a[8:11], 0
    v_mfma_f32_16x16x32_bf16 v[164:167], v[40:43], a[4:7], 0
    ds_read_b64_tr_b16 v[32:33], v10 offset:8192
    v_mfma_f32_16x16x32_bf16 v[180:183], v[44:47], a[4:7], 0
    ds_read_b64_tr_b16 v[34:35], v10 offset:8704
    v_mfma_f32_16x16x32_bf16 v[176:179], v[44:47], a[0:3], 0
    buffer_load_dwordx4 a[76:79], v8, s[24:27], s41 offen offset:0 sc1
    v_mfma_f32_16x16x32_bf16 v[160:163], v[40:43], a[0:3], 0
    s_waitcnt vmcnt(14)
    s_waitcnt lgkmcnt(6)
    v_mfma_f32_16x16x32_bf16 v[192:195], v[48:51], a[0:3], 0
    s_branch K4_ps3
K4_pg3:
    s_branch K4_vri
K4_ps3:
    ds_read_b64_tr_b16 v[36:37], v10 offset:12288
    v_accvgpr_read_b32 v100, a16
    v_mfma_f32_16x16x32_bf16 v[208:211], v[52:55], a[0:3], 0
    ds_read_b64_tr_b16 v[38:39], v10 offset:12800
    v_accvgpr_read_b32 v101, a18
    v_mfma_f32_16x16x32_bf16 v[212:215], v[52:55], a[4:7], 0
    buffer_load_dwordx4 a[80:83], v5, s[24:27], s41 offen offset:1024 sc1
    v_mfma_f32_16x16x32_bf16 v[196:199], v[48:51], a[4:7], 0
    v_accvgpr_read_b32 v102, a20
    v_accvgpr_read_b32 v103, a22
    v_mfma_f32_16x16x32_bf16 v[200:203], v[48:51], a[8:11], 0
    ds_read_b64_tr_b16 v[40:41], v11 offset:8192
    v_accvgpr_read_b32 v104, a24
    v_mfma_f32_16x16x32_bf16 v[216:219], v[52:55], a[8:11], 0
    ds_read_b64_tr_b16 v[42:43], v11 offset:8704
    v_accvgpr_read_b32 v105, a26
    v_mfma_f32_16x16x32_bf16 v[220:223], v[52:55], a[12:15], 0
    buffer_load_dwordx4 a[84:87], v6, s[24:27], s41 offen offset:1024 sc1
    v_mfma_f32_16x16x32_bf16 v[204:207], v[48:51], a[12:15], 0
    v_accvgpr_read_b32 v106, a28
    s_waitcnt lgkmcnt(6)
    v_mfma_f32_16x16x32_bf16 v[236:239], v[56:59], a[12:15], 0
    ds_read_b64_tr_b16 v[44:45], v11 offset:12288
    v_accvgpr_read_b32 v107, a30
    v_mfma_f32_16x16x32_bf16 v[252:255], v[60:63], a[12:15], 0
    ds_read_b64_tr_b16 v[46:47], v11 offset:12800
    v_max3_u32 v100, v100, v101, v102
    v_mfma_f32_16x16x32_bf16 v[248:251], v[60:63], a[8:11], 0
    buffer_load_dwordx4 a[88:91], v7, s[24:27], s41 offen offset:1024 sc1
    v_mfma_f32_16x16x32_bf16 v[232:235], v[56:59], a[8:11], 0
    v_max3_u32 v103, v103, v104, v105
    v_max3_u32 v100, v100, v103, v106
    v_mfma_f32_16x16x32_bf16 v[228:231], v[56:59], a[4:7], 0
    ds_read_b64_tr_b16 v[48:49], v12 offset:8192
    v_max3_u32 v100, v100, v107, v107
    v_mfma_f32_16x16x32_bf16 v[244:247], v[60:63], a[4:7], 0
    ds_read_b64_tr_b16 v[50:51], v12 offset:8704
    v_cmp_eq_u32 vcc, -1, v100
    v_mfma_f32_16x16x32_bf16 v[240:243], v[60:63], a[0:3], 0
    buffer_load_dwordx4 a[92:95], v8, s[24:27], s41 offen offset:1024 sc1
    v_mfma_f32_16x16x32_bf16 v[224:227], v[56:59], a[0:3], 0
    s_cbranch_vccnz K4_slowb1
K4_okb1:
    s_waitcnt lgkmcnt(6)
    v_mfma_f32_16x16x32_bf16 v[128:131], v[32:35], a[16:19], v[128:131]
    ds_read_b64_tr_b16 v[52:53], v12 offset:12288
    v_mfma_f32_16x16x32_bf16 v[144:147], v[36:39], a[16:19], v[144:147]
    ds_read_b64_tr_b16 v[54:55], v12 offset:12800
    s_add_u32 m0, s42, 73728
    v_mfma_f32_16x16x32_bf16 v[148:151], v[36:39], a[20:23], v[148:151]
    buffer_load_dwordx4 v2, s[16:19], s40 offen  lds
    v_mfma_f32_16x16x32_bf16 v[132:135], v[32:35], a[20:23], v[132:135]
    v_mfma_f32_16x16x32_bf16 v[136:139], v[32:35], a[24:27], v[136:139]
    ds_read_b64_tr_b16 v[56:57], v13 offset:8192
    v_mfma_f32_16x16x32_bf16 v[152:155], v[36:39], a[24:27], v[152:155]
    ds_read_b64_tr_b16 v[58:59], v13 offset:8704
    s_add_u32 m0, s42, 77824
    v_mfma_f32_16x16x32_bf16 v[156:159], v[36:39], a[28:31], v[156:159]
    buffer_load_dwordx4 v2, s[20:23], s40 offen  lds
    v_mfma_f32_16x16x32_bf16 v[140:143], v[32:35], a[28:31], v[140:143]
    s_add_u32 s40, s40, 294912
    s_waitcnt lgkmcnt(6)
    v_mfma_f32_16x16x32_bf16 v[172:175], v[40:43], a[28:31], v[172:175]
    ds_read_b64_tr_b16 v[60:61], v13 offset:12288
    v_mfma_f32_16x16x32_bf16 v[188:191], v[44:47], a[28:31], v[188:191]
    ds_read_b64_tr_b16 v[62:63], v13 offset:12800
    v_mfma_f32_16x16x32_bf16 v[184:187], v[44:47], a[24:27], v[184:187]
    buffer_load_dword v97, v96, s[72:75], 0 offen sc1
    v_mfma_f32_16x16x32_bf16 v[168:171], v[40:43], a[24:27], v[168:171]
    v_mfma_f32_16x16x32_bf16 v[164:167], v[40:43], a[20:23], v[164:167]
    ds_read_b64_tr_b16 v[32:33], v10 offset:16384
    v_mfma_f32_16x16x32_bf16 v[180:183], v[44:47], a[20:23], v[180:183]
    ds_read_b64_tr_b16 v[34:35], v10 offset:16896
    s_add_u32 m0, s42, 81920
    v_mfma_f32_16x16x32_bf16 v[176:179], v[44:47], a[16:19], v[176:179]
    buffer_load_dwordx4 v2, s[16:19], s40 offen  lds
    v_mfma_f32_16x16x32_bf16 v[160:163], v[40:43], a[16:19], v[160:163]
    s_waitcnt vmcnt(17)
    s_waitcnt lgkmcnt(6)
    v_mfma_f32_16x16x32_bf16 v[192:195], v[48:51], a[16:19], v[192:195]
    ds_read_b64_tr_b16 v[36:37], v10 offset:20480
    v_accvgpr_read_b32 v100, a32
    v_mfma_f32_16x16x32_bf16 v[208:211], v[52:55], a[16:19], v[208:211]
    ds_read_b64_tr_b16 v[38:39], v10 offset:20992
    s_add_u32 m0, s42, 86016
    v_mfma_f32_16x16x32_bf16 v[212:215], v[52:55], a[20:23], v[212:215]
    buffer_load_dwordx4 v2, s[20:23], s40 offen  lds
    v_mfma_f32_16x16x32_bf16 v[196:199], v[48:51], a[20:23], v[196:199]
    s_add_u32 s40, s40, 294912
    v_accvgpr_read_b32 v101, a34
    v_mfma_f32_16x16x32_bf16 v[200:203], v[48:51], a[24:27], v[200:203]
    ds_read_b64_tr_b16 v[40:41], v11 offset:16384
    v_accvgpr_read_b32 v102, a36
    v_mfma_f32_16x16x32_bf16 v[216:219], v[52:55], a[24:27], v[216:219]
    ds_read_b64_tr_b16 v[42:43], v11 offset:16896
    v_accvgpr_read_b32 v103, a38
    v_mfma_f32_16x16x32_bf16 v[220:223], v[52:55], a[28:31], v[220:223]
    v_accvgpr_read_b32 v104, a40
    v_accvgpr_read_b32 v105, a42
    v_mfma_f32_16x16x32_bf16 v[204:207], v[48:51], a[28:31], v[204:207]
    v_accvgpr_read_b32 v106, a44
    s_waitcnt lgkmcnt(6)
    v_mfma_f32_16x16x32_bf16 v[236:239], v[56:59], a[28:31], v[236:239]
    ds_read_b64_tr_b16 v[44:45], v11 offset:20480
    v_accvgpr_read_b32 v107, a46
    v_mfma_f32_16x16x32_bf16 v[252:255], v[60:63], a[28:31], v[252:255]
    ds_read_b64_tr_b16 v[46:47], v11 offset:20992
    v_max3_u32 v100, v100, v101, v102
    v_mfma_f32_16x16x32_bf16 v[248:251], v[60:63], a[24:27], v[248:251]
    v_max3_u32 v103, v103, v104, v105
    v_max3_u32 v100, v100, v103, v106
    v_mfma_f32_16x16x32_bf16 v[232:235], v[56:59], a[24:27], v[232:235]
    v_max3_u32 v100, v100, v107, v107
    v_cmp_eq_u32 vcc, -1, v100
    v_mfma_f32_16x16x32_bf16 v[228:231], v[56:59], a[20:23], v[228:231]
    ds_read_b64_tr_b16 v[48:49], v12 offset:16384
    s_cbranch_vccnz K4_slowb2
K4_okb2:
    v_mfma_f32_16x16x32_bf16 v[244:247], v[60:63], a[20:23], v[244:247]
    ds_read_b64_tr_b16 v[50:51], v12 offset:16896
    v_mfma_f32_16x16x32_bf16 v[240:243], v[60:63], a[16:19], v[240:243]
    v_mfma_f32_16x16x32_bf16 v[224:227], v[56:59], a[16:19], v[224:227]
    s_waitcnt lgkmcnt(6)
    v_mfma_f32_16x16x32_bf16 v[128:131], v[32:35], a[32:35], v[128:131]
    ds_read_b64_tr_b16 v[52:53], v12 offset:20480
    v_mfma_f32_16x16x32_bf16 v[144:147], v[36:39], a[32:35], v[144:147]
    ds_read_b64_tr_b16 v[54:55], v12 offset:20992
    s_add_u32 m0, s42, 90112
    v_mfma_f32_16x16x32_bf16 v[148:151], v[36:39], a[36:39], v[148:151]
    buffer_load_dwordx4 v2, s[16:19], s40 offen  lds
    v_mfma_f32_16x16x32_bf16 v[132:135], v[32:35], a[36:39], v[132:135]
    v_mfma_f32_16x16x32_bf16 v[136:139], v[32:35], a[40:43], v[136:139]
    ds_read_b64_tr_b16 v[56:57], v13 offset:16384
    v_mfma_f32_16x16x32_bf16 v[152:155], v[36:39], a[40:43], v[152:155]
    ds_read_b64_tr_b16 v[58:59], v13 offset:16896
    s_add_u32 m0, s42, 94208
    v_mfma_f32_16x16x32_bf16 v[156:159], v[36:39], a[44:47], v[156:159]
    buffer_load_dwordx4 v2, s[20:23], s40 offen  lds
    v_mfma_f32_16x16x32_bf16 v[140:143], v[32:35], a[44:47], v[140:143]
    s_add_u32 s40, s40, 294912
    s_waitcnt vmcnt(4)
    v_cmp_ne_u32 vcc, v22, v97
    s_cbranch_vccnz K4_slowf
K4_okf:
    s_waitcnt lgkmcnt(6)
    v_mfma_f32_16x16x32_bf16 v[172:175], v[40:43], a[44:47], v[172:175]
    ds_read_b64_tr_b16 v[60:61], v13 offset:20480
    v_mfma_f32_16x16x32_bf16 v[188:191], v[44:47], a[44:47], v[188:191]
    ds_read_b64_tr_b16 v[62:63], v13 offset:20992
    v_mfma_f32_16x16x32_bf16 v[184:187], v[44:47], a[40:43], v[184:187]
    buffer_load_dwordx4 a[96:99], v5, s[24:27], s41 offen offset:2048 sc1
    v_mfma_f32_16x16x32_bf16 v[168:171], v[40:43], a[40:43], v[168:171]
    s_barrier
    v_mfma_f32_16x16x32_bf16 v[164:167], v[40:43], a[36:39], v[164:167]
    ds_read_b64_tr_b16 v[32:33], v10 offset:24576
    v_mfma_f32_16x16x32_bf16 v[180:183], v[44:47], a[36:39], v[180:183]
    ds_read_b64_tr_b16 v[34:35], v10 offset:25088
    v_mfma_f32_16x16x32_bf16 v[176:179], v[44:47], a[32:35], v[176:179]
    buffer_load_dwordx4 a[100:103], v6, s[24:27], s41 offen offset:2048 sc1
    v_mfma_f32_16x16x32_bf16 v[160:163], v[40:43], a[32:35], v[160:163]
    s_waitcnt lgkmcnt(6)
    v_mfma_f32_16x16x32_bf16 v[192:195], v[48:51], a[32:35], v[192:195]
    ds_read_b64_tr_b16 v[36:37], v10 offset:28672
    v_accvgpr_read_b32 v100, a48
    v_mfma_f32_16x16x32_bf16 v[208:211], v[52:55], a[32:35], v[208:211]
    ds_read_b64_tr_b16 v[38:39], v10 offset:29184
    v_accvgpr_read_b32 v101, a50
    v_mfma_f32_16x16x32_bf16 v[212:215], v[52:55], a[36:39], v[212:215]
    buffer_load_dwordx4 a[104:107], v7, s[24:27], s41 offen offset:2048 sc1
    v_mfma_f32_16x16x32_bf16 v[196:199], v[48:51], a[36:39], v[196:199]
    v_accvgpr_read_b32 v102, a52
    v_accvgpr_read_b32 v103, a54
    v_mfma_f32_16x16x32_bf16 v[200:203], v[48:51], a[40:43], v[200:203]
    ds_read_b64_tr_b16 v[40:41], v11 offset:24576
    v_accvgpr_read_b32 v104, a56
    v_mfma_f32_16x16x32_bf16 v[216:219], v[52:55], a[40:43], v[216:219]
    ds_read_b64_tr_b16 v[42:43], v11 offset:25088
    v_accvgpr_read_b32 v105, a58
    v_mfma_f32_16x16x32_bf16 v[220:223], v[52:55], a[44:47], v[220:223]
    buffer_load_dwordx4 a[108:111], v8, s[24:27], s41 offen offset:2048 sc1
    v_mfma_f32_16x16x32_bf16 v[204:207], v[48:51], a[44:47], v[204:207]
    v_accvgpr_read_b32 v106, a60
    s_waitcnt lgkmcnt(6)
    v_mfma_f32_16x16x32_bf16 v[236:239], v[56:59], a[44:47], v[236:239]
    ds_read_b64_tr_b16 v[44:45], v11 offset:28672
    v_accvgpr_read_b32 v107, a62
    v_mfma_f32_16x16x32_bf16 v[252:255], v[60:63], a[44:47], v[252:255]
    ds_read_b64_tr_b16 v[46:47], v11 offset:29184
    v_max3_u32 v100, v100, v101, v102
    v_mfma_f32_16x16x32_bf16 v[248:251], v[60:63], a[40:43], v[248:251]
    buffer_load_dwordx4 a[112:115], v5, s[24:27], s41 offen offset:3072 sc1
    v_mfma_f32_16x16x32_bf16 v[232:235], v[56:59], a[40:43], v[232:235]
    v_max3_u32 v103, v103, v104, v105
    v_max3_u32 v100, v100, v103, v106
    v_mfma_f32_16x16x32_bf16 v[228:231], v[56:59], a[36:39], v[228:231]
    ds_read_b64_tr_b16 v[48:49], v12 offset:24576
    v_max3_u32 v100, v100, v107, v107
    v_mfma_f32_16x16x32_bf16 v[244:247], v[60:63], a[36:39], v[244:247]
    ds_read_b64_tr_b16 v[50:51], v12 offset:25088
    v_cmp_eq_u32 vcc, -1, v100
    v_mfma_f32_16x16x32_bf16 v[240:243], v[60:63], a[32:35], v[240:243]
    buffer_load_dwordx4 a[116:119], v6, s[24:27], s41 offen offset:3072 sc1
    v_mfma_f32_16x16x32_bf16 v[224:227], v[56:59], a[32:35], v[224:227]
    s_cbranch_vccnz K4_slowb3
K4_okb3:
    s_waitcnt lgkmcnt(6)
    v_mfma_f32_16x16x32_bf16 v[128:131], v[32:35], a[48:51], v[128:131]
    ds_read_b64_tr_b16 v[52:53], v12 offset:28672
    v_mfma_f32_16x16x32_bf16 v[144:147], v[36:39], a[48:51], v[144:147]
    ds_read_b64_tr_b16 v[54:55], v12 offset:29184
    v_mfma_f32_16x16x32_bf16 v[148:151], v[36:39], a[52:55], v[148:151]
    buffer_load_dwordx4 a[120:123], v7, s[24:27], s41 offen offset:3072 sc1
    v_mfma_f32_16x16x32_bf16 v[132:135], v[32:35], a[52:55], v[132:135]
    v_mfma_f32_16x16x32_bf16 v[136:139], v[32:35], a[56:59], v[136:139]
    ds_read_b64_tr_b16 v[56:57], v13 offset:24576
    v_mfma_f32_16x16x32_bf16 v[152:155], v[36:39], a[56:59], v[152:155]
    ds_read_b64_tr_b16 v[58:59], v13 offset:25088
    v_mfma_f32_16x16x32_bf16 v[156:159], v[36:39], a[60:63], v[156:159]
    buffer_load_dwordx4 a[124:127], v8, s[24:27], s41 offen offset:3072 sc1
    v_mfma_f32_16x16x32_bf16 v[140:143], v[32:35], a[60:63], v[140:143]
    s_add_u32 s41, s41, 4096
    s_waitcnt lgkmcnt(6)
    v_mfma_f32_16x16x32_bf16 v[172:175], v[40:43], a[60:63], v[172:175]
    ds_read_b64_tr_b16 v[60:61], v13 offset:28672
    v_mfma_f32_16x16x32_bf16 v[188:191], v[44:47], a[60:63], v[188:191]
    ds_read_b64_tr_b16 v[62:63], v13 offset:29184
    v_mfma_f32_16x16x32_bf16 v[184:187], v[44:47], a[56:59], v[184:187]
    buffer_load_dwordx4 a[128:131], v5, s[24:27], s41 offen offset:0 sc1
    v_mfma_f32_16x16x32_bf16 v[168:171], v[40:43], a[56:59], v[168:171]
    v_mfma_f32_16x16x32_bf16 v[164:167], v[40:43], a[52:55], v[164:167]
    ds_read_b64_tr_b16 v[32:33], v10 offset:32768
    v_mfma_f32_16x16x32_bf16 v[180:183], v[44:47], a[52:55], v[180:183]
    ds_read_b64_tr_b16 v[34:35], v10 offset:33280
    v_mfma_f32_16x16x32_bf16 v[176:179], v[44:47], a[48:51], v[176:179]
    buffer_load_dwordx4 a[132:135], v6, s[24:27], s41 offen offset:0 sc1
    v_mfma_f32_16x16x32_bf16 v[160:163], v[40:43], a[48:51], v[160:163]
    s_waitcnt lgkmcnt(6)
    v_mfma_f32_16x16x32_bf16 v[192:195], v[48:51], a[48:51], v[192:195]
    ds_read_b64_tr_b16 v[36:37], v10 offset:36864
    v_accvgpr_read_b32 v100, a64
    v_mfma_f32_16x16x32_bf16 v[208:211], v[52:55], a[48:51], v[208:211]
    ds_read_b64_tr_b16 v[38:39], v10 offset:37376
    v_accvgpr_read_b32 v101, a66
    v_mfma_f32_16x16x32_bf16 v[212:215], v[52:55], a[52:55], v[212:215]
    buffer_load_dwordx4 a[136:139], v7, s[24:27], s41 offen offset:0 sc1
    v_mfma_f32_16x16x32_bf16 v[196:199], v[48:51], a[52:55], v[196:199]
    v_accvgpr_read_b32 v102, a68
    v_accvgpr_read_b32 v103, a70
    v_mfma_f32_16x16x32_bf16 v[200:203], v[48:51], a[56:59], v[200:203]
    ds_read_b64_tr_b16 v[40:41], v11 offset:32768
    v_accvgpr_read_b32 v104, a72
    v_mfma_f32_16x16x32_bf16 v[216:219], v[52:55], a[56:59], v[216:219]
    ds_read_b64_tr_b16 v[42:43], v11 offset:33280
    v_accvgpr_read_b32 v105, a74
    v_mfma_f32_16x16x32_bf16 v[220:223], v[52:55], a[60:63], v[220:223]
    buffer_load_dwordx4 a[140:143], v8, s[24:27], s41 offen offset:0 sc1
    v_mfma_f32_16x16x32_bf16 v[204:207], v[48:51], a[60:63], v[204:207]
    v_accvgpr_read_b32 v106, a76
    s_waitcnt lgkmcnt(6)
    v_mfma_f32_16x16x32_bf16 v[236:239], v[56:59], a[60:63], v[236:239]
    ds_read_b64_tr_b16 v[44:45], v11 offset:36864
    v_accvgpr_read_b32 v107, a78
    v_mfma_f32_16x16x32_bf16 v[252:255], v[60:63], a[60:63], v[252:255]
    ds_read_b64_tr_b16 v[46:47], v11 offset:37376
    s_add_u32 m0, s42, 98304
    v_mfma_f32_16x16x32_bf16 v[248:251], v[60:63], a[56:59], v[248:251]
    buffer_load_dwordx4 v2, s[16:19], s40 offen  lds
    v_mfma_f32_16x16x32_bf16 v[232:235], v[56:59], a[56:59], v[232:235]
    v_max3_u32 v100, v100, v101, v102
    v_max3_u32 v103, v103, v104, v105
    v_mfma_f32_16x16x32_bf16 v[228:231], v[56:59], a[52:55], v[228:231]
    ds_read_b64_tr_b16 v[48:49], v12 offset:32768
    v_max3_u32 v100, v100, v103, v106
    v_mfma_f32_16x16x32_bf16 v[244:247], v[60:63], a[52:55], v[244:247]
    ds_read_b64_tr_b16 v[50:51], v12 offset:33280
    s_add_u32 m0, s42, 102400
    v_mfma_f32_16x16x32_bf16 v[240:243], v[60:63], a[48:51], v[240:243]
    buffer_load_dwordx4 v2, s[20:23], s40 offen  lds
    v_mfma_f32_16x16x32_bf16 v[224:227], v[56:59], a[48:51], v[224:227]
    s_add_u32 s40, s40, 294912
    v_max3_u32 v100, v100, v107, v107
    v_cmp_eq_u32 vcc, -1, v100
    s_cbranch_vccnz K4_slowb4
K4_okb4:
    s_waitcnt lgkmcnt(6)
    v_mfma_f32_16x16x32_bf16 v[128:131], v[32:35], a[64:67], v[128:131]
    ds_read_b64_tr_b16 v[52:53], v12 offset:36864
    v_mfma_f32_16x16x32_bf16 v[144:147], v[36:39], a[64:67], v[144:147]
    ds_read_b64_tr_b16 v[54:55], v12 offset:37376
    v_mfma_f32_16x16x32_bf16 v[148:151], v[36:39], a[68:71], v[148:151]
    buffer_load_dwordx4 a[144:147], v5, s[24:27], s41 offen offset:1024 sc1
    v_mfma_f32_16x16x32_bf16 v[132:135], v[32:35], a[68:71], v[132:135]
    v_mfma_f32_16x16x32_bf16 v[136:139], v[32:35], a[72:75], v[136:139]
    ds_read_b64_tr_b16 v[56:57], v13 offset:32768
    v_mfma_f32_16x16x32_bf16 v[152:155], v[36:39], a[72:75], v[152:155]
    ds_read_b64_tr_b16 v[58:59], v13 offset:33280
    v_mfma_f32_16x16x32_bf16 v[156:159], v[36:39], a[76:79], v[156:159]
    buffer_load_dwordx4 a[148:151], v6, s[24:27], s41 offen offset:1024 sc1
    v_mfma_f32_16x16x32_bf16 v[140:143], v[32:35], a[76:79], v[140:143]
    s_waitcnt lgkmcnt(6)
    v_mfma_f32_16x16x32_bf16 v[172:175], v[40:43], a[76:79], v[172:175]
    ds_read_b64_tr_b16 v[60:61], v13 offset:36864
    v_mfma_f32_16x16x32_bf16 v[188:191], v[44:47], a[76:79], v[188:191]
    ds_read_b64_tr_b16 v[62:63], v13 offset:37376
    v_mfma_f32_16x16x32_bf16 v[184:187], v[44:47], a[72:75], v[184:187]
    buffer_load_dwordx4 a[152:155], v7, s[24:27], s41 offen offset:1024 sc1
    v_mfma_f32_16x16x32_bf16 v[168:171], v[40:43], a[72:75], v[168:171]
    v_mfma_f32_16x16x32_bf16 v[164:167], v[40:43], a[68:71], v[164:167]
    ds_read_b64_tr_b16 v[32:33], v10 offset:40960
    v_mfma_f32_16x16x32_bf16 v[180:183], v[44:47], a[68:71], v[180:183]
    ds_read_b64_tr_b16 v[34:35], v10 offset:41472
    v_mfma_f32_16x16x32_bf16 v[176:179], v[44:47], a[64:67], v[176:179]
    buffer_load_dwordx4 a[156:159], v8, s[24:27], s41 offen offset:1024 sc1
    v_mfma_f32_16x16x32_bf16 v[160:163], v[40:43], a[64:67], v[160:163]
    s_waitcnt lgkmcnt(6)
    v_mfma_f32_16x16x32_bf16 v[192:195], v[48:51], a[64:67], v[192:195]
    ds_read_b64_tr_b16 v[36:37], v10 offset:45056
    v_accvgpr_read_b32 v100, a80
    v_mfma_f32_16x16x32_bf16 v[208:211], v[52:55], a[64:67], v[208:211]
    ds_read_b64_tr_b16 v[38:39], v10 offset:45568
    s_add_u32 m0, s42, 106496
    v_mfma_f32_16x16x32_bf16 v[212:215], v[52:55], a[68:71], v[212:215]
    buffer_load_dwordx4 v2, s[16:19], s40 offen  lds
    v_mfma_f32_16x16x32_bf16 v[196:199], v[48:51], a[68:71], v[196:199]
    v_accvgpr_read_b32 v101, a82
    v_accvgpr_read_b32 v102, a84
    v_mfma_f32_16x16x32_bf16 v[200:203], v[48:51], a[72:75], v[200:203]
    ds_read_b64_tr_b16 v[40:41], v11 offset:40960
    v_accvgpr_read_b32 v103, a86
    v_mfma_f32_16x16x32_bf16 v[216:219], v[52:55], a[72:75], v[216:219]
    ds_read_b64_tr_b16 v[42:43], v11 offset:41472
    s_add_u32 m0, s42, 110592
    v_mfma_f32_16x16x32_bf16 v[220:223], v[52:55], a[76:79], v[220:223]
    buffer_load_dwordx4 v2, s[20:23], s40 offen  lds
    v_mfma_f32_16x16x32_bf16 v[204:207], v[48:51], a[76:79], v[204:207]
    s_add_u32 s40, s40, 294912
    s_waitcnt lgkmcnt(6)
    v_mfma_f32_16x16x32_bf16 v[236:239], v[56:59], a[76:79], v[236:239]
    ds_read_b64_tr_b16 v[44:45], v11 offset:45056
    v_accvgpr_read_b32 v104, a88
    v_mfma_f32_16x16x32_bf16 v[252:255], v[60:63], a[76:79], v[252:255]
    ds_read_b64_tr_b16 v[46:47], v11 offset:45568
    v_accvgpr_read_b32 v105, a90
    v_mfma_f32_16x16x32_bf16 v[248:251], v[60:63], a[72:75], v[248:251]
    v_accvgpr_read_b32 v106, a92
    v_accvgpr_read_b32 v107, a94
    v_mfma_f32_16x16x32_bf16 v[232:235], v[56:59], a[72:75], v[232:235]
    v_max3_u32 v100, v100, v101, v102
    v_max3_u32 v103, v103, v104, v105
    v_mfma_f32_16x16x32_bf16 v[228:231], v[56:59], a[68:71], v[228:231]
    ds_read_b64_tr_b16 v[48:49], v12 offset:40960
    v_max3_u32 v100, v100, v103, v106
    v_mfma_f32_16x16x32_bf16 v[244:247], v[60:63], a[68:71], v[244:247]
    ds_read_b64_tr_b16 v[50:51], v12 offset:41472
    v_max3_u32 v100, v100, v107, v107
    v_mfma_f32_16x16x32_bf16 v[240:243], v[60:63], a[64:67], v[240:243]
    v_cmp_eq_u32 vcc, -1, v100
    s_cbranch_vccnz K4_slowb5
K4_okb5:
    v_mfma_f32_16x16x32_bf16 v[224:227], v[56:59], a[64:67], v[224:227]
    s_waitcnt lgkmcnt(6)
    v_mfma_f32_16x16x32_bf16 v[128:131], v[32:35], a[80:83], v[128:131]
    ds_read_b64_tr_b16 v[52:53], v12 offset:45056
    v_mfma_f32_16x16x32_bf16 v[144:147], v[36:39], a[80:83], v[144:147]
    ds_read_b64_tr_b16 v[54:55], v12 offset:45568
    v_mfma_f32_16x16x32_bf16 v[148:151], v[36:39], a[84:87], v[148:151]
    buffer_load_dwordx4 a[160:163], v5, s[24:27], s41 offen offset:2048 sc1
    v_mfma_f32_16x16x32_bf16 v[132:135], v[32:35], a[84:87], v[132:135]
    v_mfma_f32_16x16x32_bf16 v[136:139], v[32:35], a[88:91], v[136:139]
    ds_read_b64_tr_b16 v[56:57], v13 offset:40960
    v_mfma_f32_16x16x32_bf16 v[152:155], v[36:39], a[88:91], v[152:155]
    ds_read_b64_tr_b16 v[58:59], v13 offset:41472
    v_mfma_f32_16x16x32_bf16 v[156:159], v[36:39], a[92:95], v[156:159]
    buffer_load_dwordx4 a[164:167], v6, s[24:27], s41 offen offset:2048 sc1
    v_mfma_f32_16x16x32_bf16 v[140:143], v[32:35], a[92:95], v[140:143]
    s_waitcnt lgkmcnt(6)
    v_mfma_f32_16x16x32_bf16 v[172:175], v[40:43], a[92:95], v[172:175]
    ds_read_b64_tr_b16 v[60:61], v13 offset:45056
    v_mfma_f32_16x16x32_bf16 v[188:191], v[44:47], a[92:95], v[188:191]
    ds_read_b64_tr_b16 v[62:63], v13 offset:45568
    v_mfma_f32_16x16x32_bf16 v[184:187], v[44:47], a[88:91], v[184:187]
    buffer_load_dwordx4 a[168:171], v7, s[24:27], s41 offen offset:2048 sc1
    v_mfma_f32_16x16x32_bf16 v[168:171], v[40:43], a[88:91], v[168:171]
    v_mfma_f32_16x16x32_bf16 v[164:167], v[40:43], a[84:87], v[164:167]
    ds_read_b64_tr_b16 v[32:33], v10 offset:49152
    v_mfma_f32_16x16x32_bf16 v[180:183], v[44:47], a[84:87], v[180:183]
    ds_read_b64_tr_b16 v[34:35], v10 offset:49664
    v_mfma_f32_16x16x32_bf16 v[176:179], v[44:47], a[80:83], v[176:179]
    buffer_load_dwordx4 a[172:175], v8, s[24:27], s41 offen offset:2048 sc1
    v_mfma_f32_16x16x32_bf16 v[160:163], v[40:43], a[80:83], v[160:163]
    s_waitcnt lgkmcnt(6)
    v_mfma_f32_16x16x32_bf16 v[192:195], v[48:51], a[80:83], v[192:195]
    ds_read_b64_tr_b16 v[36:37], v10 offset:53248
    v_mfma_f32_16x16x32_bf16 v[208:211], v[52:55], a[80:83], v[208:211]
    ds_read_b64_tr_b16 v[38:39], v10 offset:53760
    s_add_u32 m0, s42, 0
    v_mfma_f32_16x16x32_bf16 v[212:215], v[52:55], a[84:87], v[212:215]
    buffer_load_dwordx4 v2, s[16:19], s40 offen  lds
    v_mfma_f32_16x16x32_bf16 v[196:199], v[48:51], a[84:87], v[196:199]
    v_mfma_f32_16x16x32_bf16 v[200:203], v[48:51], a[88:91], v[200:203]
    ds_read_b64_tr_b16 v[40:41], v11 offset:49152
    v_mfma_f32_16x16x32_bf16 v[216:219], v[52:55], a[88:91], v[216:219]
    ds_read_b64_tr_b16 v[42:43], v11 offset:49664
    s_add_u32 m0, s42, 4096
    v_mfma_f32_16x16x32_bf16 v[220:223], v[52:55], a[92:95], v[220:223]
    buffer_load_dwordx4 v2, s[20:23], s40 offen  lds
    v_mfma_f32_16x16x32_bf16 v[204:207], v[48:51], a[92:95], v[204:207]
    s_add_u32 s40, s40, 294912
    s_waitcnt lgkmcnt(6)
    v_mfma_f32_16x16x32_bf16 v[236:239], v[56:59], a[92:95], v[236:239]
    ds_read_b64_tr_b16 v[44:45], v11 offset:53248
    v_mfma_f32_16x16x32_bf16 v[252:255], v[60:63], a[92:95], v[252:255]
    ds_read_b64_tr_b16 v[46:47], v11 offset:53760
    s_add_u32 m0, s42, 8192
    v_mfma_f32_16x16x32_bf16 v[248:251], v[60:63], a[88:91], v[248:251]
    buffer_load_dwordx4 v2, s[16:19], s40 offen  lds
    v_mfma_f32_16x16x32_bf16 v[232:235], v[56:59], a[88:91], v[232:235]
    v_mfma_f32_16x16x32_bf16 v[228:231], v[56:59], a[84:87], v[228:231]
    ds_read_b64_tr_b16 v[48:49], v12 offset:49152
    v_mfma_f32_16x16x32_bf16 v[244:247], v[60:63], a[84:87], v[244:247]
    ds_read_b64_tr_b16 v[50:51], v12 offset:49664
    s_add_u32 m0, s42, 12288
    v_mfma_f32_16x16x32_bf16 v[240:243], v[60:63], a[80:83], v[240:243]
    buffer_load_dwordx4 v2, s[20:23], s40 offen  lds
    v_mfma_f32_16x16x32_bf16 v[224:227], v[56:59], a[80:83], v[224:227]
    s_add_u32 s40, s40, 294912
    s_waitcnt vmcnt(24)
    s_waitcnt lgkmcnt(6)
    v_mfma_f32_16x16x32_bf16 v[128:131], v[32:35], a[96:99], v[128:131]
    ds_read_b64_tr_b16 v[52:53], v12 offset:53248
    v_mfma_f32_16x16x32_bf16 v[144:147], v[36:39], a[96:99], v[144:147]
    ds_read_b64_tr_b16 v[54:55], v12 offset:53760
    v_mfma_f32_16x16x32_bf16 v[148:151], v[36:39], a[100:103], v[148:151]
    buffer_load_dwordx4 a[176:179], v5, s[24:27], s41 offen offset:3072 sc1
    v_mfma_f32_16x16x32_bf16 v[132:135], v[32:35], a[100:103], v[132:135]
    v_mfma_f32_16x16x32_bf16 v[136:139], v[32:35], a[104:107], v[136:139]
    ds_read_b64_tr_b16 v[56:57], v13 offset:49152
    v_mfma_f32_16x16x32_bf16 v[152:155], v[36:39], a[104:107], v[152:155]
    ds_read_b64_tr_b16 v[58:59], v13 offset:49664
    v_mfma_f32_16x16x32_bf16 v[156:159], v[36:39], a[108:111], v[156:159]
    buffer_load_dwordx4 a[180:183], v6, s[24:27], s41 offen offset:3072 sc1
    v_mfma_f32_16x16x32_bf16 v[140:143], v[32:35], a[108:111], v[140:143]
    s_waitcnt lgkmcnt(6)
    v_mfma_f32_16x16x32_bf16 v[172:175], v[40:43], a[108:111], v[172:175]
    ds_read_b64_tr_b16 v[60:61], v13 offset:53248
    v_mfma_f32_16x16x32_bf16 v[188:191], v[44:47], a[108:111], v[188:191]
    ds_read_b64_tr_b16 v[62:63], v13 offset:53760
    v_mfma_f32_16x16x32_bf16 v[184:187], v[44:47], a[104:107], v[184:187]
    buffer_load_dwordx4 a[184:187], v7, s[24:27], s41 offen offset:3072 sc1
    v_mfma_f32_16x16x32_bf16 v[168:171], v[40:43], a[104:107], v[168:171]
    v_mfma_f32_16x16x32_bf16 v[164:167], v[40:43], a[100:103], v[164:167]
    ds_read_b64_tr_b16 v[32:33], v10 offset:57344
    v_mfma_f32_16x16x32_bf16 v[180:183], v[44:47], a[100:103], v[180:183]
    ds_read_b64_tr_b16 v[34:35], v10 offset:57856
    v_mfma_f32_16x16x32_bf16 v[176:179], v[44:47], a[96:99], v[176:179]
    buffer_load_dwordx4 a[188:191], v8, s[24:27], s41 offen offset:3072 sc1
    v_mfma_f32_16x16x32_bf16 v[160:163], v[40:43], a[96:99], v[160:163]
    s_add_u32 s41, s41, 4096
    s_waitcnt lgkmcnt(6)
    v_mfma_f32_16x16x32_bf16 v[192:195], v[48:51], a[96:99], v[192:195]
    ds_read_b64_tr_b16 v[36:37], v10 offset:61440
    v_mfma_f32_16x16x32_bf16 v[208:211], v[52:55], a[96:99], v[208:211]
    ds_read_b64_tr_b16 v[38:39], v10 offset:61952
    v_mfma_f32_16x16x32_bf16 v[212:215], v[52:55], a[100:103], v[212:215]
    v_mfma_f32_16x16x32_bf16 v[196:199], v[48:51], a[100:103], v[196:199]
    v_mfma_f32_16x16x32_bf16 v[200:203], v[48:51], a[104:107], v[200:203]
    ds_read_b64_tr_b16 v[40:41], v11 offset:57344
    v_mfma_f32_16x16x32_bf16 v[216:219], v[52:55], a[104:107], v[216:219]
    ds_read_b64_tr_b16 v[42:43], v11 offset:57856
    v_mfma_f32_16x16x32_bf16 v[220:223], v[52:55], a[108:111], v[220:223]
    v_mfma_f32_16x16x32_bf16 v[204:207], v[48:51], a[108:111], v[204:207]
    s_waitcnt lgkmcnt(6)
    v_mfma_f32_16x16x32_bf16 v[236:239], v[56:59], a[108:111], v[236:239]
    ds_read_b64_tr_b16 v[44:45], v11 offset:61440
    v_mfma_f32_16x16x32_bf16 v[252:255], v[60:63], a[108:111], v[252:255]
    ds_read_b64_tr_b16 v[46:47], v11 offset:61952
    v_mfma_f32_16x16x32_bf16 v[248:251], v[60:63], a[104:107], v[248:251]
    v_mfma_f32_16x16x32_bf16 v[232:235], v[56:59], a[104:107], v[232:235]
    v_mfma_f32_16x16x32_bf16 v[228:231], v[56:59], a[100:103], v[228:231]
    ds_read_b64_tr_b16 v[48:49], v12 offset:57344
    v_mfma_f32_16x16x32_bf16 v[244:247], v[60:63], a[100:103], v[244:247]
    ds_read_b64_tr_b16 v[50:51], v12 offset:57856
    v_mfma_f32_16x16x32_bf16 v[240:243], v[60:63], a[96:99], v[240:243]
    v_mfma_f32_16x16x32_bf16 v[224:227], v[56:59], a[96:99], v[224:227]
    s_waitcnt vmcnt(24)
    s_waitcnt lgkmcnt(6)
    v_mfma_f32_16x16x32_bf16 v[128:131], v[32:35], a[112:115], v[128:131]
    ds_read_b64_tr_b16 v[52:53], v12 offset:61440
    v_mfma_f32_16x16x32_bf16 v[144:147], v[36:39], a[112:115], v[144:147]
    ds_read_b64_tr_b16 v[54:55], v12 offset:61952
    v_mfma_f32_16x16x32_bf16 v[148:151], v[36:39], a[116:119], v[148:151]
    buffer_load_dwordx4 a[192:195], v5, s[24:27], s41 offen offset:0 sc1
    v_mfma_f32_16x16x32_bf16 v[132:135], v[32:35], a[116:119], v[132:135]
    v_mfma_f32_16x16x32_bf16 v[136:139], v[32:35], a[120:123], v[136:139]
    ds_read_b64_tr_b16 v[56:57], v13 offset:57344
    v_mfma_f32_16x16x32_bf16 v[152:155], v[36:39], a[120:123], v[152:155]
    ds_read_b64_tr_b16 v[58:59], v13 offset:57856
    v_mfma_f32_16x16x32_bf16 v[156:159], v[36:39], a[124:127], v[156:159]
    buffer_load_dwordx4 a[196:199], v6, s[24:27], s41 offen offset:0 sc1
    v_mfma_f32_16x16x32_bf16 v[140:143], v[32:35], a[124:127], v[140:143]
    s_waitcnt lgkmcnt(6)
    v_mfma_f32_16x16x32_bf16 v[172:175], v[40:43], a[124:127], v[172:175]
    ds_read_b64_tr_b16 v[60:61], v13 offset:61440
    v_mfma_f32_16x16x32_bf16 v[188:191], v[44:47], a[124:127], v[188:191]
    ds_read_b64_tr_b16 v[62:63], v13 offset:61952
    v_mfma_f32_16x16x32_bf16 v[184:187], v[44:47], a[120:123], v[184:187]
    buffer_load_dwordx4 a[200:203], v7, s[24:27], s41 offen offset:0 sc1
    v_mfma_f32_16x16x32_bf16 v[168:171], v[40:43], a[120:123], v[168:171]
    s_barrier
    v_mfma_f32_16x16x32_bf16 v[164:167], v[40:43], a[116:119], v[164:167]
    ds_read_b64_tr_b16 v[32:33], v14 offset:0
    v_mfma_f32_16x16x32_bf16 v[180:183], v[44:47], a[116:119], v[180:183]
    ds_read_b64_tr_b16 v[34:35], v14 offset:512
    s_add_u32 m0, s42, 16384
    v_mfma_f32_16x16x32_bf16 v[176:179], v[44:47], a[112:115], v[176:179]
    buffer_load_dwordx4 v2, s[16:19], s40 offen  lds
    v_mfma_f32_16x16x32_bf16 v[160:163], v[40:43], a[112:115], v[160:163]
    s_waitcnt lgkmcnt(6)
    v_mfma_f32_16x16x32_bf16 v[192:195], v[48:51], a[112:115], v[192:195]
    ds_read_b64_tr_b16 v[36:37], v14 offset:4096
    v_mfma_f32_16x16x32_bf16 v[208:211], v[52:55], a[112:115], v[208:211]
    ds_read_b64_tr_b16 v[38:39], v14 offset:4608
    s_add_u32 m0, s42, 20480
    v_mfma_f32_16x16x32_bf16 v[212:215], v[52:55], a[116:119], v[212:215]
    buffer_load_dwordx4 v2, s[20:23], s40 offen  lds
    v_mfma_f32_16x16x32_bf16 v[196:199], v[48:51], a[116:119], v[196:199]
    s_add_u32 s40, s40, 294912
    v_mfma_f32_16x16x32_bf16 v[200:203], v[48:51], a[120:123], v[200:203]
    ds_read_b64_tr_b16 v[40:41], v15 offset:0
    v_mfma_f32_16x16x32_bf16 v[216:219], v[52:55], a[120:123], v[216:219]
    ds_read_b64_tr_b16 v[42:43], v15 offset:512
    s_add_u32 m0, s42, 24576
    v_mfma_f32_16x16x32_bf16 v[220:223], v[52:55], a[124:127], v[220:223]
    buffer_load_dwordx4 v2, s[16:19], s40 offen  lds
    v_mfma_f32_16x16x32_bf16 v[204:207], v[48:51], a[124:127], v[204:207]
    s_waitcnt lgkmcnt(6)
    v_mfma_f32_16x16x32_bf16 v[236:239], v[56:59], a[124:127], v[236:239]
    ds_read_b64_tr_b16 v[44:45], v15 offset:4096
    v_mfma_f32_16x16x32_bf16 v[252:255], v[60:63], a[124:127], v[252:255]
    ds_read_b64_tr_b16 v[46:47], v15 offset:4608
    s_add_u32 m0, s42, 28672
    v_mfma_f32_16x16x32_bf16 v[248:251], v[60:63], a[120:123], v[248:251]
    s_branch K4_ps4
K4_pg4:
    s_branch K4_vri
K4_ps4:
    buffer_load_dwordx4 v2, s[20:23], s40 offen  lds
    v_mfma_f32_16x16x32_bf16 v[232:235], v[56:59], a[120:123], v[232:235]
    s_mov_b32 s40, s61
    v_mfma_f32_16x16x32_bf16 v[228:231], v[56:59], a[116:119], v[228:231]
    ds_read_b64_tr_b16 v[48:49], v16 offset:0
    v_mfma_f32_16x16x32_bf16 v[244:247], v[60:63], a[116:119], v[244:247]
    ds_read_b64_tr_b16 v[50:51], v16 offset:512
    v_mfma_f32_16x16x32_bf16 v[240:243], v[60:63], a[112:115], v[240:243]
    buffer_load_dwordx4 a[204:207], v8, s[24:27], s41 offen offset:0 sc1
    v_mfma_f32_16x16x32_bf16 v[224:227], v[56:59], a[112:115], v[224:227]
    s_waitcnt vmcnt(28)
    s_waitcnt lgkmcnt(6)
    v_mfma_f32_16x16x32_bf16 v[128:131], v[32:35], a[128:131], v[128:131]
    ds_read_b64_tr_b16 v[52:53], v16 offset:4096
    v_mfma_f32_16x16x32_bf16 v[144:147], v[36:39], a[128:131], v[144:147]
    ds_read_b64_tr_b16 v[54:55], v16 offset:4608
    v_mfma_f32_16x16x32_bf16 v[148:151], v[36:39], a[132:135], v[148:151]
    buffer_load_dwordx4 a[208:211], v5, s[24:27], s41 offen offset:1024 sc1
    v_mfma_f32_16x16x32_bf16 v[132:135], v[32:35], a[132:135], v[132:135]
    v_mfma_f32_16x16x32_bf16 v[136:139], v[32:35], a[136:139], v[136:139]
    ds_read_b64_tr_b16 v[56:57], v17 offset:0
    v_mfma_f32_16x16x32_bf16 v[152:155], v[36:39], a[136:139], v[152:155]
    ds_read_b64_tr_b16 v[58:59], v17 offset:512
    v_mfma_f32_16x16x32_bf16 v[156:159], v[36:39], a[140:143], v[156:159]
    buffer_load_dwordx4 a[212:215], v6, s[24:27], s41 offen offset:1024 sc1
    v_mfma_f32_16x16x32_bf16 v[140:143], v[32:35], a[140:143], v[140:143]
    s_waitcnt lgkmcnt(6)
    v_mfma_f32_16x16x32_bf16 v[172:175], v[40:43], a[140:143], v[172:175]
    ds_read_b64_tr_b16 v[60:61], v17 offset:4096
    v_mfma_f32_16x16x32_bf16 v[188:191], v[44:47], a[140:143], v[188:191]
    ds_read_b64_tr_b16 v[62:63], v17 offset:4608
    v_mfma_f32_16x16x32_bf16 v[184:187], v[44:47], a[136:139], v[184:187]
    buffer_load_dwordx4 a[216:219], v7, s[24:27], s41 offen offset:1024 sc1
    v_mfma_f32_16x16x32_bf16 v[168:171], v[40:43], a[136:139], v[168:171]
    v_mfma_f32_16x16x32_bf16 v[164:167], v[40:43], a[132:135], v[164:167]
    ds_read_b64_tr_b16 v[32:33], v14 offset:8192
    v_mfma_f32_16x16x32_bf16 v[180:183], v[44:47], a[132:135], v[180:183]
    ds_read_b64_tr_b16 v[34:35], v14 offset:8704
    v_mfma_f32_16x16x32_bf16 v[176:179], v[44:47], a[128:131], v[176:179]
    buffer_load_dwordx4 a[220:223], v8, s[24:27], s41 offen offset:1024 sc1
    v_mfma_f32_16x16x32_bf16 v[160:163], v[40:43], a[128:131], v[160:163]
    s_waitcnt lgkmcnt(6)
    v_mfma_f32_16x16x32_bf16 v[192:195], v[48:51], a[128:131], v[192:195]
    ds_read_b64_tr_b16 v[36:37], v14 offset:12288
    v_mfma_f32_16x16x32_bf16 v[208:211], v[52:55], a[128:131], v[208:211]
    ds_read_b64_tr_b16 v[38:39], v14 offset:12800
    v_mfma_f32_16x16x32_bf16 v[212:215], v[52:55], a[132:135], v[212:215]
    v_mfma_f32_16x16x32_bf16 v[196:199], v[48:51], a[132:135], v[196:199]
    v_mfma_f32_16x16x32_bf16 v[200:203], v[48:51], a[136:139], v[200:203]
    ds_read_b64_tr_b16 v[40:41], v15 offset:8192
    v_mfma_f32_16x16x32_bf16 v[216:219], v[52:55], a[136:139], v[216:219]
    ds_read_b64_tr_b16 v[42:43], v15 offset:8704
    v_mfma_f32_16x16x32_bf16 v[220:223], v[52:55], a[140:143], v[220:223]
    v_mfma_f32_16x16x32_bf16 v[204:207], v[48:51], a[140:143], v[204:207]
    s_waitcnt lgkmcnt(6)
    v_mfma_f32_16x16x32_bf16 v[236:239], v[56:59], a[140:143], v[236:239]
    ds_read_b64_tr_b16 v[44:45], v15 offset:12288
    v_mfma_f32_16x16x32_bf16 v[252:255], v[60:63], a[140:143], v[252:255]
    ds_read_b64_tr_b16 v[46:47], v15 offset:12800
    v_mfma_f32_16x16x32_bf16 v[248:251], v[60:63], a[136:139], v[248:251]
    v_mfma_f32_16x16x32_bf16 v[232:235], v[56:59], a[136:139], v[232:235]
    v_mfma_f32_16x16x32_bf16 v[228:231], v[56:59], a[132:135], v[228:231]
    ds_read_b64_tr_b16 v[48:49], v16 offset:8192
    v_mfma_f32_16x16x32_bf16 v[244:247], v[60:63], a[132:135], v[244:247]
    ds_read_b64_tr_b16 v[50:51], v16 offset:8704
    v_mfma_f32_16x16x32_bf16 v[240:243], v[60:63], a[128:131], v[240:243]
    v_mfma_f32_16x16x32_bf16 v[224:227], v[56:59], a[128:131], v[224:227]
    s_waitcnt vmcnt(26)
    s_waitcnt lgkmcnt(6)
    v_mfma_f32_16x16x32_bf16 v[128:131], v[32:35], a[144:147], v[128:131]
    ds_read_b64_tr_b16 v[52:53], v16 offset:12288
    v_mfma_f32_16x16x32_bf16 v[144:147], v[36:39], a[144:147], v[144:147]
    ds_read_b64_tr_b16 v[54:55], v16 offset:12800
    v_mfma_f32_16x16x32_bf16 v[148:151], v[36:39], a[148:151], v[148:151]
    buffer_load_dwordx4 a[224:227], v5, s[24:27], s41 offen offset:2048 sc1
    v_mfma_f32_16x16x32_bf16 v[132:135], v[32:35], a[148:151], v[132:135]
    v_mfma_f32_16x16x32_bf16 v[136:139], v[32:35], a[152:155], v[136:139]
    ds_read_b64_tr_b16 v[56:57], v17 offset:8192
    v_mfma_f32_16x16x32_bf16 v[152:155], v[36:39], a[152:155], v[152:155]
    ds_read_b64_tr_b16 v[58:59], v17 offset:8704
    v_mfma_f32_16x16x32_bf16 v[156:159], v[36:39], a[156:159], v[156:159]
    buffer_load_dwordx4 a[228:231], v6, s[24:27], s41 offen offset:2048 sc1
    v_mfma_f32_16x16x32_bf16 v[140:143], v[32:35], a[156:159], v[140:143]
    s_waitcnt lgkmcnt(6)
    v_mfma_f32_16x16x32_bf16 v[172:175], v[40:43], a[156:159], v[172:175]
    ds_read_b64_tr_b16 v[60:61], v17 offset:12288
    v_mfma_f32_16x16x32_bf16 v[188:191], v[44:47], a[156:159], v[188:191]
    ds_read_b64_tr_b16 v[62:63], v17 offset:12800
    v_mfma_f32_16x16x32_bf16 v[184:187], v[44:47], a[152:155], v[184:187]
    buffer_load_dwordx4 a[232:235], v7, s[24:27], s41 offen offset:2048 sc1
    v_mfma_f32_16x16x32_bf16 v[168:171], v[40:43], a[152:155], v[168:171]
    v_mfma_f32_16x16x32_bf16 v[164:167], v[40:43], a[148:151], v[164:167]
    ds_read_b64_tr_b16 v[32:33], v14 offset:16384
    v_mfma_f32_16x16x32_bf16 v[180:183], v[44:47], a[148:151], v[180:183]
    ds_read_b64_tr_b16 v[34:35], v14 offset:16896
    v_mfma_f32_16x16x32_bf16 v[176:179], v[44:47], a[144:147], v[176:179]
    buffer_load_dwordx4 a[236:239], v8, s[24:27], s41 offen offset:2048 sc1
    v_mfma_f32_16x16x32_bf16 v[160:163], v[40:43], a[144:147], v[160:163]
    s_waitcnt lgkmcnt(6)
    v_mfma_f32_16x16x32_bf16 v[192:195], v[48:51], a[144:147], v[192:195]
    ds_read_b64_tr_b16 v[36:37], v14 offset:20480
    v_mfma_f32_16x16x32_bf16 v[208:211], v[52:55], a[144:147], v[208:211]
    ds_read_b64_tr_b16 v[38:39], v14 offset:20992
    s_add_u32 m0, s42, 32768
    v_mfma_f32_16x16x32_bf16 v[212:215], v[52:55], a[148:151], v[212:215]
    buffer_load_dwordx4 v2, s[16:19], s40 offen  lds
    v_mfma_f32_16x16x32_bf16 v[196:199], v[48:51], a[148:151], v[196:199]
    v_mfma_f32_16x16x32_bf16 v[200:203], v[48:51], a[152:155], v[200:203]
    ds_read_b64_tr_b16 v[40:41], v15 offset:16384
    v_mfma_f32_16x16x32_bf16 v[216:219], v[52:55], a[152:155], v[216:219]
    ds_read_b64_tr_b16 v[42:43], v15 offset:16896
    s_add_u32 m0, s42, 36864
    v_mfma_f32_16x16x32_bf16 v[220:223], v[52:55], a[156:159], v[220:223]
    buffer_load_dwordx4 v2, s[20:23], s40 offen  lds
    v_mfma_f32_16x16x32_bf16 v[204:207], v[48:51], a[156:159], v[204:207]
    s_add_u32 s40, s40, 294912
    s_waitcnt lgkmcnt(6)
    v_mfma_f32_16x16x32_bf16 v[236:239], v[56:59], a[156:159], v[236:239]
    ds_read_b64_tr_b16 v[44:45], v15 offset:20480
    v_mfma_f32_16x16x32_bf16 v[252:255], v[60:63], a[156:159], v[252:255]
    ds_read_b64_tr_b16 v[46:47], v15 offset:20992
    v_mfma_f32_16x16x32_bf16 v[248:251], v[60:63], a[152:155], v[248:251]
    buffer_load_dwordx4 a[240:243], v5, s[24:27], s41 offen offset:3072 sc1
    v_mfma_f32_16x16x32_bf16 v[232:235], v[56:59], a[152:155], v[232:235]
    v_mfma_f32_16x16x32_bf16 v[228:231], v[56:59], a[148:151], v[228:231]
    ds_read_b64_tr_b16 v[48:49], v16 offset:16384
    v_mfma_f32_16x16x32_bf16 v[244:247], v[60:63], a[148:151], v[244:247]
    ds_read_b64_tr_b16 v[50:51], v16 offset:16896
    v_mfma_f32_16x16x32_bf16 v[240:243], v[60:63], a[144:147], v[240:243]
    buffer_load_dwordx4 a[244:247], v6, s[24:27], s41 offen offset:3072 sc1
    v_mfma_f32_16x16x32_bf16 v[224:227], v[56:59], a[144:147], v[224:227]
    s_waitcnt vmcnt(28)
    s_waitcnt lgkmcnt(6)
    v_mfma_f32_16x16x32_bf16 v[128:131], v[32:35], a[160:163], v[128:131]
    ds_read_b64_tr_b16 v[52:53], v16 offset:20480
    v_mfma_f32_16x16x32_bf16 v[144:147], v[36:39], a[160:163], v[144:147]
    ds_read_b64_tr_b16 v[54:55], v16 offset:20992
    v_mfma_f32_16x16x32_bf16 v[148:151], v[36:39], a[164:167], v[148:151]
    buffer_load_dwordx4 a[248:251], v7, s[24:27], s41 offen offset:3072 sc1
    v_mfma_f32_16x16x32_bf16 v[132:135], v[32:35], a[164:167], v[132:135]
    v_mfma_f32_16x16x32_bf16 v[136:139], v[32:35], a[168:171], v[136:139]
    ds_read_b64_tr_b16 v[56:57], v17 offset:16384
    v_mfma_f32_16x16x32_bf16 v[152:155], v[36:39], a[168:171], v[152:155]
    ds_read_b64_tr_b16 v[58:59], v17 offset:16896
    v_mfma_f32_16x16x32_bf16 v[156:159], v[36:39], a[172:175], v[156:159]
    buffer_load_dwordx4 a[252:255], v8, s[24:27], s41 offen offset:3072 sc1
    v_mfma_f32_16x16x32_bf16 v[140:143], v[32:35], a[172:175], v[140:143]
    s_add_u32 s41, s41, 4096
    s_waitcnt lgkmcnt(6)
    v_mfma_f32_16x16x32_bf16 v[172:175], v[40:43], a[172:175], v[172:175]
    ds_read_b64_tr_b16 v[60:61], v17 offset:20480
    v_mfma_f32_16x16x32_bf16 v[188:191], v[44:47], a[172:175], v[188:191]
    ds_read_b64_tr_b16 v[62:63], v17 offset:20992
    s_add_u32 m0, s42, 40960
    v_mfma_f32_16x16x32_bf16 v[184:187], v[44:47], a[168:171], v[184:187]
    buffer_load_dwordx4 v2, s[16:19], s40 offen  lds
    v_mfma_f32_16x16x32_bf16 v[168:171], v[40:43], a[168:171], v[168:171]
    v_mfma_f32_16x16x32_bf16 v[164:167], v[40:43], a[164:167], v[164:167]
    ds_read_b64_tr_b16 v[32:33], v14 offset:24576
    v_mfma_f32_16x16x32_bf16 v[180:183], v[44:47], a[164:167], v[180:183]
    ds_read_b64_tr_b16 v[34:35], v14 offset:25088
    s_add_u32 m0, s42, 45056
    v_mfma_f32_16x16x32_bf16 v[176:179], v[44:47], a[160:163], v[176:179]
    buffer_load_dwordx4 v2, s[20:23], s40 offen  lds
    v_mfma_f32_16x16x32_bf16 v[160:163], v[40:43], a[160:163], v[160:163]
    s_add_u32 s40, s40, 294912
    s_waitcnt lgkmcnt(6)
    v_mfma_f32_16x16x32_bf16 v[192:195], v[48:51], a[160:163], v[192:195]
    ds_read_b64_tr_b16 v[36:37], v14 offset:28672
    v_mfma_f32_16x16x32_bf16 v[208:211], v[52:55], a[160:163], v[208:211]
    ds_read_b64_tr_b16 v[38:39], v14 offset:29184
    v_mfma_f32_16x16x32_bf16 v[212:215], v[52:55], a[164:167], v[212:215]
    buffer_load_dwordx4 v[64:67], v5, s[24:27], s41 offen offset:0 sc1
    v_mfma_f32_16x16x32_bf16 v[196:199], v[48:51], a[164:167], v[196:199]
    v_mfma_f32_16x16x32_bf16 v[200:203], v[48:51], a[168:171], v[200:203]
    ds_read_b64_tr_b16 v[40:41], v15 offset:24576
    v_mfma_f32_16x16x32_bf16 v[216:219], v[52:55], a[168:171], v[216:219]
    ds_read_b64_tr_b16 v[42:43], v15 offset:25088
    v_mfma_f32_16x16x32_bf16 v[220:223], v[52:55], a[172:175], v[220:223]
    buffer_load_dwordx4 v[68:71], v6, s[24:27], s41 offen offset:0 sc1
    v_mfma_f32_16x16x32_bf16 v[204:207], v[48:51], a[172:175], v[204:207]
    s_waitcnt lgkmcnt(6)
    v_mfma_f32_16x16x32_bf16 v[236:239], v[56:59], a[172:175], v[236:239]
    ds_read_b64_tr_b16 v[44:45], v15 offset:28672
    v_mfma_f32_16x16x32_bf16 v[252:255], v[60:63], a[172:175], v[252:255]
    ds_read_b64_tr_b16 v[46:47], v15 offset:29184
    v_mfma_f32_16x16x32_bf16 v[248:251], v[60:63], a[168:171], v[248:251]
    buffer_load_dwordx4 v[72:75], v7, s[24:27], s41 offen offset:0 sc1
    v_mfma_f32_16x16x32_bf16 v[232:235], v[56:59], a[168:171], v[232:235]
    v_mfma_f32_16x16x32_bf16 v[228:231], v[56:59], a[164:167], v[228:231]
    ds_read_b64_tr_b16 v[48:49], v16 offset:24576
    v_mfma_f32_16x16x32_bf16 v[244:247], v[60:63], a[164:167], v[244:247]
    ds_read_b64_tr_b16 v[50:51], v16 offset:25088
    v_mfma_f32_16x16x32_bf16 v[240:243], v[60:63], a[160:163], v[240:243]
    buffer_load_dwordx4 v[76:79], v8, s[24:27], s41 offen offset:0 sc1
    v_mfma_f32_16x16x32_bf16 v[224:227], v[56:59], a[160:163], v[224:227]
    s_waitcnt vmcnt(28)
    s_waitcnt lgkmcnt(6)
    v_mfma_f32_16x16x32_bf16 v[128:131], v[32:35], a[176:179], v[128:131]
    ds_read_b64_tr_b16 v[52:53], v16 offset:28672
    v_mfma_f32_16x16x32_bf16 v[144:147], v[36:39], a[176:179], v[144:147]
    ds_read_b64_tr_b16 v[54:55], v16 offset:29184
    s_add_u32 m0, s42, 49152
    v_mfma_f32_16x16x32_bf16 v[148:151], v[36:39], a[180:183], v[148:151]
    buffer_load_dwordx4 v2, s[16:19], s40 offen  lds
    v_mfma_f32_16x16x32_bf16 v[132:135], v[32:35], a[180:183], v[132:135]
    v_mfma_f32_16x16x32_bf16 v[136:139], v[32:35], a[184:187], v[136:139]
    ds_read_b64_tr_b16 v[56:57], v17 offset:24576
    v_mfma_f32_16x16x32_bf16 v[152:155], v[36:39], a[184:187], v[152:155]
    ds_read_b64_tr_b16 v[58:59], v17 offset:25088
    s_add_u32 m0, s42, 53248
    v_mfma_f32_16x16x32_bf16 v[156:159], v[36:39], a[188:191], v[156:159]
    buffer_load_dwordx4 v2, s[20:23], s40 offen  lds
    v_mfma_f32_16x16x32_bf16 v[140:143], v[32:35], a[188:191], v[140:143]
    s_add_u32 s40, s40, 294912
    s_waitcnt lgkmcnt(6)
    v_mfma_f32_16x16x32_bf16 v[172:175], v[40:43], a[188:191], v[172:175]
    ds_read_b64_tr_b16 v[60:61], v17 offset:28672
    v_mfma_f32_16x16x32_bf16 v[188:191], v[44:47], a[188:191], v[188:191]
    ds_read_b64_tr_b16 v[62:63], v17 offset:29184
    v_mfma_f32_16x16x32_bf16 v[184:187], v[44:47], a[184:187], v[184:187]
    buffer_load_dwordx4 v[80:83], v5, s[24:27], s41 offen offset:1024 sc1
    v_mfma_f32_16x16x32_bf16 v[168:171], v[40:43], a[184:187], v[168:171]
    s_barrier
    v_mfma_f32_16x16x32_bf16 v[164:167], v[40:43], a[180:183], v[164:167]
    ds_read_b64_tr_b16 v[32:33], v14 offset:32768
    v_mfma_f32_16x16x32_bf16 v[180:183], v[44:47], a[180:183], v[180:183]
    ds_read_b64_tr_b16 v[34:35], v14 offset:33280
    v_mfma_f32_16x16x32_bf16 v[176:179], v[44:47], a[176:179], v[176:179]
    buffer_load_dwordx4 v[84:87], v6, s[24:27], s41 offen offset:1024 sc1
    v_mfma_f32_16x16x32_bf16 v[160:163], v[40:43], a[176:179], v[160:163]
    s_waitcnt lgkmcnt(6)
    v_mfma_f32_16x16x32_bf16 v[192:195], v[48:51], a[176:179], v[192:195]
    ds_read_b64_tr_b16 v[36:37], v14 offset:36864
    v_mfma_f32_16x16x32_bf16 v[208:211], v[52:55], a[176:179], v[208:211]
    ds_read_b64_tr_b16 v[38:39], v14 offset:37376
    v_mfma_f32_16x16x32_bf16 v[212:215], v[52:55], a[180:183], v[212:215]
    buffer_load_dwordx4 v[88:91], v7, s[24:27], s41 offen offset:1024 sc1
    v_mfma_f32_16x16x32_bf16 v[196:199], v[48:51], a[180:183], v[196:199]
    v_mfma_f32_16x16x32_bf16 v[200:203], v[48:51], a[184:187], v[200:203]
    ds_read_b64_tr_b16 v[40:41], v15 offset:32768
    v_mfma_f32_16x16x32_bf16 v[216:219], v[52:55], a[184:187], v[216:219]
    ds_read_b64_tr_b16 v[42:43], v15 offset:33280
    v_mfma_f32_16x16x32_bf16 v[220:223], v[52:55], a[188:191], v[220:223]
    buffer_load_dwordx4 v[92:95], v8, s[24:27], s41 offen offset:1024 sc1
    v_mfma_f32_16x16x32_bf16 v[204:207], v[48:51], a[188:191], v[204:207]
    s_waitcnt lgkmcnt(6)
    v_mfma_f32_16x16x32_bf16 v[236:239], v[56:59], a[188:191], v[236:239]
    ds_read_b64_tr_b16 v[44:45], v15 offset:36864
    v_mfma_f32_16x16x32_bf16 v[252:255], v[60:63], a[188:191], v[252:255]
    ds_read_b64_tr_b16 v[46:47], v15 offset:37376
    s_add_u32 m0, s42, 57344
    v_mfma_f32_16x16x32_bf16 v[248:251], v[60:63], a[184:187], v[248:251]
    buffer_load_dwordx4 v2, s[16:19], s40 offen  lds
    v_mfma_f32_16x16x32_bf16 v[232:235], v[56:59], a[184:187], v[232:235]
    v_mfma_f32_16x16x32_bf16 v[228:231], v[56:59], a[180:183], v[228:231]
    ds_read_b64_tr_b16 v[48:49], v16 offset:32768
    v_mfma_f32_16x16x32_bf16 v[244:247], v[60:63], a[180:183], v[244:247]
    ds_read_b64_tr_b16 v[50:51], v16 offset:33280
    s_add_u32 m0, s42, 61440
    v_mfma_f32_16x16x32_bf16 v[240:243], v[60:63], a[176:179], v[240:243]
    buffer_load_dwordx4 v2, s[20:23], s40 offen  lds
    v_mfma_f32_16x16x32_bf16 v[224:227], v[56:59], a[176:179], v[224:227]
    s_add_u32 s40, s40, 294912
    s_waitcnt vmcnt(28)
    s_waitcnt lgkmcnt(6)
    v_mfma_f32_16x16x32_bf16 v[128:131], v[32:35], a[192:195], v[128:131]
    ds_read_b64_tr_b16 v[52:53], v16 offset:36864
    v_mfma_f32_16x16x32_bf16 v[144:147], v[36:39], a[192:195], v[144:147]
    ds_read_b64_tr_b16 v[54:55], v16 offset:37376
    v_mfma_f32_16x16x32_bf16 v[148:151], v[36:39], a[196:199], v[148:151]
    v_mfma_f32_16x16x32_bf16 v[132:135], v[32:35], a[196:199], v[132:135]
    v_mfma_f32_16x16x32_bf16 v[136:139], v[32:35], a[200:203], v[136:139]
    ds_read_b64_tr_b16 v[56:57], v17 offset:32768
    v_mfma_f32_16x16x32_bf16 v[152:155], v[36:39], a[200:203], v[152:155]
    ds_read_b64_tr_b16 v[58:59], v17 offset:33280
    v_mfma_f32_16x16x32_bf16 v[156:159], v[36:39], a[204:207], v[156:159]
    buffer_store_dwordx4 v[24:27], v4, s[56:59], s60 offen sc1
    v_mfma_f32_16x16x32_bf16 v[140:143], v[32:35], a[204:207], v[140:143]
    s_add_u32 s60, s60, 4096
    s_waitcnt lgkmcnt(6)
    v_mfma_f32_16x16x32_bf16 v[172:175], v[40:43], a[204:207], v[172:175]
    ds_read_b64_tr_b16 v[60:61], v17 offset:36864
    v_mfma_f32_16x16x32_bf16 v[188:191], v[44:47], a[204:207], v[188:191]
    ds_read_b64_tr_b16 v[62:63], v17 offset:37376
    v_mfma_f32_16x16x32_bf16 v[184:187], v[44:47], a[200:203], v[184:187]
    v_mfma_f32_16x16x32_bf16 v[168:171], v[40:43], a[200:203], v[168:171]
    v_mfma_f32_16x16x32_bf16 v[164:167], v[40:43], a[196:199], v[164:167]
    ds_read_b64_tr_b16 v[32:33], v14 offset:40960
    v_mfma_f32_16x16x32_bf16 v[180:183], v[44:47], a[196:199], v[180:183]
    ds_read_b64_tr_b16 v[34:35], v14 offset:41472
    v_mfma_f32_16x16x32_bf16 v[176:179], v[44:47], a[192:195], v[176:179]
    v_mfma_f32_16x16x32_bf16 v[160:163], v[40:43], a[192:195], v[160:163]
    s_waitcnt lgkmcnt(6)
    v_mfma_f32_16x16x32_bf16 v[192:195], v[48:51], a[192:195], v[192:195]
    ds_read_b64_tr_b16 v[36:37], v14 offset:45056
    v_mfma_f32_16x16x32_bf16 v[208:211], v[52:55], a[192:195], v[208:211]
    ds_read_b64_tr_b16 v[38:39], v14 offset:45568
    v_mfma_f32_16x16x32_bf16 v[212:215], v[52:55], a[196:199], v[212:215]
    v_mfma_f32_16x16x32_bf16 v[196:199], v[48:51], a[196:199], v[196:199]
    v_mfma_f32_16x16x32_bf16 v[200:203], v[48:51], a[200:203], v[200:203]
    ds_read_b64_tr_b16 v[40:41], v15 offset:40960
    v_mfma_f32_16x16x32_bf16 v[216:219], v[52:55], a[200:203], v[216:219]
    ds_read_b64_tr_b16 v[42:43], v15 offset:41472
    v_mfma_f32_16x16x32_bf16 v[220:223], v[52:55], a[204:207], v[220:223]
    v_mfma_f32_16x16x32_bf16 v[204:207], v[48:51], a[204:207], v[204:207]
    s_waitcnt lgkmcnt(6)
    v_mfma_f32_16x16x32_bf16 v[236:239], v[56:59], a[204:207], v[236:239]
    ds_read_b64_tr_b16 v[44:45], v15 offset:45056
    v_mfma_f32_16x16x32_bf16 v[252:255], v[60:63], a[204:207], v[252:255]
    ds_read_b64_tr_b16 v[46:47], v15 offset:45568
    v_mfma_f32_16x16x32_bf16 v[248:251], v[60:63], a[200:203], v[248:251]
    buffer_store_dwordx4 v[24:27], v4, s[56:59], s60 offen sc1
    v_mfma_f32_16x16x32_bf16 v[232:235], v[56:59], a[200:203], v[232:235]
    s_add_u32 s60, s60, 4096
    v_mfma_f32_16x16x32_bf16 v[228:231], v[56:59], a[196:199], v[228:231]
    ds_read_b64_tr_b16 v[48:49], v16 offset:40960
    v_mfma_f32_16x16x32_bf16 v[244:247], v[60:63], a[196:199], v[244:247]
    ds_read_b64_tr_b16 v[50:51], v16 offset:41472
    v_mfma_f32_16x16x32_bf16 v[240:243], v[60:63], a[192:195], v[240:243]
    v_mfma_f32_16x16x32_bf16 v[224:227], v[56:59], a[192:195], v[224:227]
    s_waitcnt vmcnt(26)
    s_waitcnt lgkmcnt(6)
    v_mfma_f32_16x16x32_bf16 v[128:131], v[32:35], a[208:211], v[128:131]
    ds_read_b64_tr_b16 v[52:53], v16 offset:45056
    v_mfma_f32_16x16x32_bf16 v[144:147], v[36:39], a[208:211], v[144:147]
    ds_read_b64_tr_b16 v[54:55], v16 offset:45568
    s_add_u32 m0, s42, 65536
    v_mfma_f32_16x16x32_bf16 v[148:151], v[36:39], a[212:215], v[148:151]
    buffer_load_dwordx4 v2, s[16:19], s40 offen  lds
    v_mfma_f32_16x16x32_bf16 v[132:135], v[32:35], a[212:215], v[132:135]
    v_mfma_f32_16x16x32_bf16 v[136:139], v[32:35], a[216:219], v[136:139]
    ds_read_b64_tr_b16 v[56:57], v17 offset:40960
    v_mfma_f32_16x16x32_bf16 v[152:155], v[36:39], a[216:219], v[152:155]
    ds_read_b64_tr_b16 v[58:59], v17 offset:41472
    s_add_u32 m0, s42, 69632
    v_mfma_f32_16x16x32_bf16 v[156:159], v[36:39], a[220:223], v[156:159]
    buffer_load_dwordx4 v2, s[20:23], s40 offen  lds
    v_mfma_f32_16x16x32_bf16 v[140:143], v[32:35], a[220:223], v[140:143]
    s_add_u32 s40, s40, 294912
    s_waitcnt lgkmcnt(6)
    v_mfma_f32_16x16x32_bf16 v[172:175], v[40:43], a[220:223], v[172:175]
    ds_read_b64_tr_b16 v[60:61], v17 offset:45056
    v_mfma_f32_16x16x32_bf16 v[188:191], v[44:47], a[220:223], v[188:191]
    ds_read_b64_tr_b16 v[62:63], v17 offset:45568
    v_mfma_f32_16x16x32_bf16 v[184:187], v[44:47], a[216:219], v[184:187]
    v_mfma_f32_16x16x32_bf16 v[168:171], v[40:43], a[216:219], v[168:171]
    s_barrier
    v_mfma_f32_16x16x32_bf16 v[164:167], v[40:43], a[212:215], v[164:167]
    ds_read_b64_tr_b16 v[32:33], v10 offset:0
    v_mfma_f32_16x16x32_bf16 v[180:183], v[44:47], a[212:215], v[180:183]
    ds_read_b64_tr_b16 v[34:35], v10 offset:512
    v_mfma_f32_16x16x32_bf16 v[176:179], v[44:47], a[208:211], v[176:179]
    buffer_store_dwordx4 v[24:27], v4, s[56:59], s60 offen sc1
    v_mfma_f32_16x16x32_bf16 v[160:163], v[40:43], a[208:211], v[160:163]
    s_add_u32 s60, s60, 4096
    s_waitcnt lgkmcnt(6)
    v_mfma_f32_16x16x32_bf16 v[192:195], v[48:51], a[208:211], v[192:195]
    ds_read_b64_tr_b16 v[36:37], v10 offset:4096
    v_mfma_f32_16x16x32_bf16 v[208:211], v[52:55], a[208:211], v[208:211]
    ds_read_b64_tr_b16 v[38:39], v10 offset:4608
    v_mfma_f32_16x16x32_bf16 v[212:215], v[52:55], a[212:215], v[212:215]
    v_mfma_f32_16x16x32_bf16 v[196:199], v[48:51], a[212:215], v[196:199]
    v_mfma_f32_16x16x32_bf16 v[200:203], v[48:51], a[216:219], v[200:203]
    ds_read_b64_tr_b16 v[40:41], v10 offset:8192
    v_mfma_f32_16x16x32_bf16 v[216:219], v[52:55], a[216:219], v[216:219]
    ds_read_b64_tr_b16 v[42:43], v10 offset:8704
    v_mfma_f32_16x16x32_bf16 v[220:223], v[52:55], a[220:223], v[220:223]
    v_mfma_f32_16x16x32_bf16 v[204:207], v[48:51], a[220:223], v[204:207]
    s_waitcnt lgkmcnt(6)
    v_mfma_f32_16x16x32_bf16 v[236:239], v[56:59], a[220:223], v[236:239]
    ds_read_b64_tr_b16 v[44:45], v10 offset:12288
    v_mfma_f32_16x16x32_bf16 v[252:255], v[60:63], a[220:223], v[252:255]
    ds_read_b64_tr_b16 v[46:47], v10 offset:12800
    v_mfma_f32_16x16x32_bf16 v[248:251], v[60:63], a[216:219], v[248:251]
    v_mfma_f32_16x16x32_bf16 v[232:235], v[56:59], a[216:219], v[232:235]
    v_mfma_f32_16x16x32_bf16 v[228:231], v[56:59], a[212:215], v[228:231]
    ds_read_b64_tr_b16 v[48:49], v10 offset:16384
    v_mfma_f32_16x16x32_bf16 v[244:247], v[60:63], a[212:215], v[244:247]
    ds_read_b64_tr_b16 v[50:51], v10 offset:16896
    v_mfma_f32_16x16x32_bf16 v[240:243], v[60:63], a[208:211], v[240:243]
    v_mfma_f32_16x16x32_bf16 v[224:227], v[56:59], a[208:211], v[224:227]
    s_waitcnt vmcnt(25)
    s_waitcnt lgkmcnt(6)
    v_mfma_f32_16x16x32_bf16 v[128:131], v[32:35], a[224:227], v[128:131]
    ds_read_b64_tr_b16 v[52:53], v10 offset:20480
    v_mfma_f32_16x16x32_bf16 v[144:147], v[36:39], a[224:227], v[144:147]
    ds_read_b64_tr_b16 v[54:55], v10 offset:20992
    s_add_u32 m0, s42, 73728
    v_mfma_f32_16x16x32_bf16 v[148:151], v[36:39], a[228:231], v[148:151]
    buffer_load_dwordx4 v2, s[16:19], s40 offen  lds
    v_mfma_f32_16x16x32_bf16 v[132:135], v[32:35], a[228:231], v[132:135]
    v_mfma_f32_16x16x32_bf16 v[136:139], v[32:35], a[232:235], v[136:139]
    ds_read_b64_tr_b16 v[56:57], v10 offset:24576
    v_mfma_f32_16x16x32_bf16 v[152:155], v[36:39], a[232:235], v[152:155]
    ds_read_b64_tr_b16 v[58:59], v10 offset:25088
    s_add_u32 m0, s42, 77824
    v_mfma_f32_16x16x32_bf16 v[156:159], v[36:39], a[236:239], v[156:159]
    buffer_load_dwordx4 v2, s[20:23], s40 offen  lds
    v_mfma_f32_16x16x32_bf16 v[140:143], v[32:35], a[236:239], v[140:143]
    s_add_u32 s40, s40, 294912
    s_waitcnt vmcnt(21)
    s_waitcnt lgkmcnt(6)
    v_mfma_f32_16x16x32_bf16 v[140:143], v[40:43], a[252:255], v[140:143]
    ds_read_b64_tr_b16 v[60:61], v10 offset:28672
    v_mfma_f32_16x16x32_bf16 v[156:159], v[44:47], a[252:255], v[156:159]
    ds_read_b64_tr_b16 v[62:63], v10 offset:29184
    v_mfma_f32_16x16x32_bf16 v[152:155], v[44:47], a[248:251], v[152:155]
    buffer_store_dwordx4 v[24:27], v4, s[56:59], s60 offen sc1
    v_mfma_f32_16x16x32_bf16 v[136:139], v[40:43], a[248:251], v[136:139]
    s_add_u32 s60, s60, 4096
    v_mfma_f32_16x16x32_bf16 v[132:135], v[40:43], a[244:247], v[132:135]
    ds_read_b64_tr_b16 v[32:33], v11 offset:0
    v_mfma_f32_16x16x32_bf16 v[148:151], v[44:47], a[244:247], v[148:151]
    ds_read_b64_tr_b16 v[34:35], v11 offset:512
    v_mfma_f32_16x16x32_bf16 v[144:147], v[44:47], a[240:243], v[144:147]
    v_mfma_f32_16x16x32_bf16 v[128:131], v[40:43], a[240:243], v[128:131]
    s_waitcnt vmcnt(16)
    s_waitcnt lgkmcnt(6)
    v_mfma_f32_16x16x32_bf16 v[128:131], v[48:51], v[64:67], v[128:131]
    ds_read_b64_tr_b16 v[36:37], v11 offset:4096
    v_mfma_f32_16x16x32_bf16 v[144:147], v[52:55], v[64:67], v[144:147]
    ds_read_b64_tr_b16 v[38:39], v11 offset:4608
    v_mfma_f32_16x16x32_bf16 v[148:151], v[52:55], v[68:71], v[148:151]
    v_mfma_f32_16x16x32_bf16 v[132:135], v[48:51], v[68:71], v[132:135]
    v_mfma_f32_16x16x32_bf16 v[136:139], v[48:51], v[72:75], v[136:139]
    ds_read_b64_tr_b16 v[40:41], v11 offset:8192
    v_mfma_f32_16x16x32_bf16 v[152:155], v[52:55], v[72:75], v[152:155]
    ds_read_b64_tr_b16 v[42:43], v11 offset:8704
    v_mfma_f32_16x16x32_bf16 v[156:159], v[52:55], v[76:79], v[156:159]
    buffer_store_dwordx4 v[24:27], v4, s[56:59], s60 offen sc1
    v_mfma_f32_16x16x32_bf16 v[140:143], v[48:51], v[76:79], v[140:143]
    s_add_u32 s60, s60, 4096
    s_waitcnt vmcnt(11)
    s_waitcnt lgkmcnt(6)
    v_mfma_f32_16x16x32_bf16 v[140:143], v[56:59], v[92:95], v[140:143]
    ds_read_b64_tr_b16 v[44:45], v11 offset:12288
    v_mfma_f32_16x16x32_bf16 v[156:159], v[60:63], v[92:95], v[156:159]
    ds_read_b64_tr_b16 v[46:47], v11 offset:12800
    v_mfma_f32_16x16x32_bf16 v[152:155], v[60:63], v[88:91], v[152:155]
    v_mfma_f32_16x16x32_bf16 v[136:139], v[56:59], v[88:91], v[136:139]
    v_mfma_f32_16x16x32_bf16 v[132:135], v[56:59], v[84:87], v[132:135]
    ds_read_b64_tr_b16 v[48:49], v11 offset:16384
    v_mfma_f32_16x16x32_bf16 v[148:151], v[60:63], v[84:87], v[148:151]
    ds_read_b64_tr_b16 v[50:51], v11 offset:16896
    v_mfma_f32_16x16x32_bf16 v[144:147], v[60:63], v[80:83], v[144:147]
    v_mfma_f32_16x16x32_bf16 v[128:131], v[56:59], v[80:83], v[128:131]
    s_waitcnt lgkmcnt(6)
    v_mfma_f32_16x16x32_bf16 v[160:163], v[32:35], a[224:227], v[160:163]
    ds_read_b64_tr_b16 v[52:53], v11 offset:20480
    v_mfma_f32_16x16x32_bf16 v[176:179], v[36:39], a[224:227], v[176:179]
    ds_read_b64_tr_b16 v[54:55], v11 offset:20992
    s_add_u32 m0, s42, 81920
    v_mfma_f32_16x16x32_bf16 v[180:183], v[36:39], a[228:231], v[180:183]
    buffer_load_dwordx4 v2, s[16:19], s40 offen  lds
    v_mfma_f32_16x16x32_bf16 v[164:167], v[32:35], a[228:231], v[164:167]
    v_max_f32 v128, 0, v128
    v_max_f32 v129, 0, v129
    v_mfma_f32_16x16x32_bf16 v[168:171], v[32:35], a[232:235], v[168:171]
    ds_read_b64_tr_b16 v[56:57], v11 offset:24576
    v_max_f32 v130, 0, v130
    v_mfma_f32_16x16x32_bf16 v[184:187], v[36:39], a[232:235], v[184:187]
    ds_read_b64_tr_b16 v[58:59], v11 offset:25088
    s_add_u32 m0, s42, 86016
    v_mfma_f32_16x16x32_bf16 v[188:191], v[36:39], a[236:239], v[188:191]
    buffer_load_dwordx4 v2, s[20:23], s40 offen  lds
    v_mfma_f32_16x16x32_bf16 v[172:175], v[32:35], a[236:239], v[172:175]
    s_add_u32 s40, s40, 294912
    s_waitcnt lgkmcnt(6)
    v_mfma_f32_16x16x32_bf16 v[172:175], v[40:43], a[252:255], v[172:175]
    ds_read_b64_tr_b16 v[60:61], v11 offset:28672
    v_max_f32 v131, 0, v131
    v_mfma_f32_16x16x32_bf16 v[188:191], v[44:47], a[252:255], v[188:191]
    ds_read_b64_tr_b16 v[62:63], v11 offset:29184
    v_mul_f32 v128, v128, v144
    v_mfma_f32_16x16x32_bf16 v[184:187], v[44:47], a[248:251], v[184:187]
    buffer_store_dwordx4 v[24:27], v4, s[56:59], s60 offen sc1
    v_mfma_f32_16x16x32_bf16 v[168:171], v[40:43], a[248:251], v[168:171]
    s_add_u32 s60, s60, 4096
    v_mul_f32 v129, v129, v145
    v_mfma_f32_16x16x32_bf16 v[164:167], v[40:43], a[244:247], v[164:167]
    ds_read_b64_tr_b16 v[32:33], v12 offset:0
    v_mul_f32 v130, v130, v146
    v_mfma_f32_16x16x32_bf16 v[180:183], v[44:47], a[244:247], v[180:183]
    ds_read_b64_tr_b16 v[34:35], v12 offset:512
    v_mul_f32 v131, v131, v147
    v_mfma_f32_16x16x32_bf16 v[176:179], v[44:47], a[240:243], v[176:179]
    v_cvt_pk_bf16_f32 v96, v128, v129
    v_cvt_pk_bf16_f32 v97, v130, v131
    v_mfma_f32_16x16x32_bf16 v[160:163], v[40:43], a[240:243], v[160:163]
    v_max_f32 v132, 0, v132
    s_waitcnt lgkmcnt(6)
    v_mfma_f32_16x16x32_bf16 v[160:163], v[48:51], v[64:67], v[160:163]
    ds_read_b64_tr_b16 v[36:37], v12 offset:4096
    v_max_f32 v133, 0, v133
    v_mfma_f32_16x16x32_bf16 v[176:179], v[52:55], v[64:67], v[176:179]
    ds_read_b64_tr_b16 v[38:39], v12 offset:4608
    v_max_f32 v134, 0, v134
    v_mfma_f32_16x16x32_bf16 v[180:183], v[52:55], v[68:71], v[180:183]
    v_max_f32 v135, 0, v135
    v_mul_f32 v132, v132, v148
    v_mfma_f32_16x16x32_bf16 v[164:167], v[48:51], v[68:71], v[164:167]
    v_mul_f32 v133, v133, v149
    v_mul_f32 v134, v134, v150
    v_mfma_f32_16x16x32_bf16 v[168:171], v[48:51], v[72:75], v[168:171]
    ds_read_b64_tr_b16 v[40:41], v12 offset:8192
    v_mul_f32 v135, v135, v151
    v_mfma_f32_16x16x32_bf16 v[184:187], v[52:55], v[72:75], v[184:187]
    ds_read_b64_tr_b16 v[42:43], v12 offset:8704
    v_cvt_pk_bf16_f32 v98, v132, v133
    v_mfma_f32_16x16x32_bf16 v[188:191], v[52:55], v[76:79], v[188:191]
    v_cvt_pk_bf16_f32 v99, v134, v135
    v_mfma_f32_16x16x32_bf16 v[172:175], v[48:51], v[76:79], v[172:175]
    s_waitcnt lgkmcnt(6)
    v_mfma_f32_16x16x32_bf16 v[172:175], v[56:59], v[92:95], v[172:175]
    ds_read_b64_tr_b16 v[44:45], v12 offset:12288
    v_permlane16_swap_b32 v96, v98
    v_mfma_f32_16x16x32_bf16 v[188:191], v[60:63], v[92:95], v[188:191]
    ds_read_b64_tr_b16 v[46:47], v12 offset:12800
    v_permlane16_swap_b32 v97, v99
    v_mfma_f32_16x16x32_bf16 v[184:187], v[60:63], v[88:91], v[184:187]
    buffer_store_dwordx4 v[96:99], v4, s[28:31], s50 offen offset:0 sc1
    v_mfma_f32_16x16x32_bf16 v[168:171], v[56:59], v[88:91], v[168:171]
    v_max_f32 v136, 0, v136
    v_max_f32 v137, 0, v137
    v_mfma_f32_16x16x32_bf16 v[164:167], v[56:59], v[84:87], v[164:167]
    ds_read_b64_tr_b16 v[48:49], v12 offset:16384
    v_max_f32 v138, 0, v138
    v_mfma_f32_16x16x32_bf16 v[180:183], v[60:63], v[84:87], v[180:183]
    ds_read_b64_tr_b16 v[50:51], v12 offset:16896
    v_max_f32 v139, 0, v139
    v_mfma_f32_16x16x32_bf16 v[176:179], v[60:63], v[80:83], v[176:179]
    buffer_store_dwordx4 v[24:27], v4, s[56:59], s60 offen sc1
    v_mfma_f32_16x16x32_bf16 v[160:163], v[56:59], v[80:83], v[160:163]
    s_add_u32 s60, s60, 4096
    s_waitcnt lgkmcnt(6)
    v_mfma_f32_16x16x32_bf16 v[192:195], v[32:35], a[224:227], v[192:195]
    ds_read_b64_tr_b16 v[52:53], v12 offset:20480
    v_mul_f32 v136, v136, v152
    v_mfma_f32_16x16x32_bf16 v[208:211], v[36:39], a[224:227], v[208:211]
    ds_read_b64_tr_b16 v[54:55], v12 offset:20992
    s_add_u32 m0, s42, 90112
    v_mfma_f32_16x16x32_bf16 v[212:215], v[36:39], a[228:231], v[212:215]
    buffer_load_dwordx4 v2, s[16:19], s40 offen  lds
    v_mfma_f32_16x16x32_bf16 v[196:199], v[32:35], a[228:231], v[196:199]
    s_branch K4_ps5
K4_pg5:
    s_branch K4_vrA
K4_ps5:
    v_mul_f32 v137, v137, v153
    v_mul_f32 v138, v138, v154
    v_mfma_f32_16x16x32_bf16 v[200:203], v[32:35], a[232:235], v[200:203]
    ds_read_b64_tr_b16 v[56:57], v12 offset:24576
    v_mul_f32 v139, v139, v155
    v_mfma_f32_16x16x32_bf16 v[216:219], v[36:39], a[232:235], v[216:219]
    ds_read_b64_tr_b16 v[58:59], v12 offset:25088
    s_add_u32 m0, s42, 94208
    v_mfma_f32_16x16x32_bf16 v[220:223], v[36:39], a[236:239], v[220:223]
    buffer_load_dwordx4 v2, s[20:23], s40 offen  lds
    v_mfma_f32_16x16x32_bf16 v[204:207], v[32:35], a[236:239], v[204:207]
    s_add_u32 s40, s40, 294912
    s_waitcnt lgkmcnt(6)
    v_mfma_f32_16x16x32_bf16 v[204:207], v[40:43], a[252:255], v[204:207]
    ds_read_b64_tr_b16 v[60:61], v12 offset:28672
    v_cvt_pk_bf16_f32 v100, v136, v137
    v_mfma_f32_16x16x32_bf16 v[220:223], v[44:47], a[252:255], v[220:223]
    ds_read_b64_tr_b16 v[62:63], v12 offset:29184
    v_cvt_pk_bf16_f32 v101, v138, v139
    v_mfma_f32_16x16x32_bf16 v[216:219], v[44:47], a[248:251], v[216:219]
    v_max_f32 v140, 0, v140
    v_max_f32 v141, 0, v141
    v_mfma_f32_16x16x32_bf16 v[200:203], v[40:43], a[248:251], v[200:203]
    v_max_f32 v142, 0, v142
    v_max_f32 v143, 0, v143
    v_mfma_f32_16x16x32_bf16 v[196:199], v[40:43], a[244:247], v[196:199]
    ds_read_b64_tr_b16 v[32:33], v13 offset:0
    v_mul_f32 v140, v140, v156
    v_mfma_f32_16x16x32_bf16 v[212:215], v[44:47], a[244:247], v[212:215]
    ds_read_b64_tr_b16 v[34:35], v13 offset:512
    v_mul_f32 v141, v141, v157
    v_mfma_f32_16x16x32_bf16 v[208:211], v[44:47], a[240:243], v[208:211]
    v_mul_f32 v142, v142, v158
    v_mul_f32 v143, v143, v159
    v_mfma_f32_16x16x32_bf16 v[192:195], v[40:43], a[240:243], v[192:195]
    v_cvt_pk_bf16_f32 v102, v140, v141
    s_waitcnt lgkmcnt(6)
    v_mfma_f32_16x16x32_bf16 v[192:195], v[48:51], v[64:67], v[192:195]
    ds_read_b64_tr_b16 v[36:37], v13 offset:4096
    v_cvt_pk_bf16_f32 v103, v142, v143
    v_mfma_f32_16x16x32_bf16 v[208:211], v[52:55], v[64:67], v[208:211]
    ds_read_b64_tr_b16 v[38:39], v13 offset:4608
    v_mfma_f32_16x16x32_bf16 v[212:215], v[52:55], v[68:71], v[212:215]
    v_mfma_f32_16x16x32_bf16 v[196:199], v[48:51], v[68:71], v[196:199]
    v_permlane16_swap_b32 v100, v102
    v_permlane16_swap_b32 v101, v103
    v_mfma_f32_16x16x32_bf16 v[200:203], v[48:51], v[72:75], v[200:203]
    ds_read_b64_tr_b16 v[40:41], v13 offset:8192
    v_max_f32 v160, 0, v160
    v_mfma_f32_16x16x32_bf16 v[216:219], v[52:55], v[72:75], v[216:219]
    ds_read_b64_tr_b16 v[42:43], v13 offset:8704
    v_max_f32 v161, 0, v161
    v_mfma_f32_16x16x32_bf16 v[220:223], v[52:55], v[76:79], v[220:223]
    buffer_store_dwordx4 v[100:103], v4, s[28:31], s51 offen offset:0 sc1
    v_mfma_f32_16x16x32_bf16 v[204:207], v[48:51], v[76:79], v[204:207]
    v_max_f32 v162, 0, v162
    s_waitcnt lgkmcnt(6)
    v_mfma_f32_16x16x32_bf16 v[204:207], v[56:59], v[92:95], v[204:207]
    ds_read_b64_tr_b16 v[44:45], v13 offset:12288
    v_max_f32 v163, 0, v163
    v_mfma_f32_16x16x32_bf16 v[220:223], v[60:63], v[92:95], v[220:223]
    ds_read_b64_tr_b16 v[46:47], v13 offset:12800
    v_mul_f32 v160, v160, v176
    v_mfma_f32_16x16x32_bf16 v[216:219], v[60:63], v[88:91], v[216:219]
    v_mul_f32 v161, v161, v177
    v_mul_f32 v162, v162, v178
    v_mfma_f32_16x16x32_bf16 v[200:203], v[56:59], v[88:91], v[200:203]
    v_mul_f32 v163, v163, v179
    v_cvt_pk_bf16_f32 v104, v160, v161
    v_mfma_f32_16x16x32_bf16 v[196:199], v[56:59], v[84:87], v[196:199]
    ds_read_b64_tr_b16 v[48:49], v13 offset:16384
    v_cvt_pk_bf16_f32 v105, v162, v163
    v_mfma_f32_16x16x32_bf16 v[212:215], v[60:63], v[84:87], v[212:215]
    ds_read_b64_tr_b16 v[50:51], v13 offset:16896
    v_max_f32 v164, 0, v164
    v_mfma_f32_16x16x32_bf16 v[208:211], v[60:63], v[80:83], v[208:211]
    v_max_f32 v165, 0, v165
    v_max_f32 v166, 0, v166
    v_mfma_f32_16x16x32_bf16 v[192:195], v[56:59], v[80:83], v[192:195]
    v_max_f32 v167, 0, v167
    s_waitcnt lgkmcnt(6)
    v_mfma_f32_16x16x32_bf16 v[224:227], v[32:35], a[224:227], v[224:227]
    ds_read_b64_tr_b16 v[52:53], v13 offset:20480
    v_mul_f32 v164, v164, v180
    v_mfma_f32_16x16x32_bf16 v[240:243], v[36:39], a[224:227], v[240:243]
    ds_read_b64_tr_b16 v[54:55], v13 offset:20992
    s_add_u32 m0, s42, 98304
    v_mfma_f32_16x16x32_bf16 v[244:247], v[36:39], a[228:231], v[244:247]
    buffer_load_dwordx4 v2, s[16:19], s40 offen  lds
    v_mfma_f32_16x16x32_bf16 v[228:231], v[32:35], a[228:231], v[228:231]
    v_mul_f32 v165, v165, v181
    v_mul_f32 v166, v166, v182
    v_mfma_f32_16x16x32_bf16 v[232:235], v[32:35], a[232:235], v[232:235]
    ds_read_b64_tr_b16 v[56:57], v13 offset:24576
    v_mul_f32 v167, v167, v183
    v_mfma_f32_16x16x32_bf16 v[248:251], v[36:39], a[232:235], v[248:251]
    ds_read_b64_tr_b16 v[58:59], v13 offset:25088
    s_add_u32 m0, s42, 102400
    v_mfma_f32_16x16x32_bf16 v[252:255], v[36:39], a[236:239], v[252:255]
    buffer_load_dwordx4 v2, s[20:23], s40 offen  lds
    v_mfma_f32_16x16x32_bf16 v[236:239], v[32:35], a[236:239], v[236:239]
    s_add_u32 s40, s40, 294912
    s_waitcnt lgkmcnt(6)
    v_mfma_f32_16x16x32_bf16 v[236:239], v[40:43], a[252:255], v[236:239]
    ds_read_b64_tr_b16 v[60:61], v13 offset:28672
    v_cvt_pk_bf16_f32 v106, v164, v165
    v_mfma_f32_16x16x32_bf16 v[252:255], v[44:47], a[252:255], v[252:255]
    ds_read_b64_tr_b16 v[62:63], v13 offset:29184
    v_cvt_pk_bf16_f32 v107, v166, v167
    v_mfma_f32_16x16x32_bf16 v[248:251], v[44:47], a[248:251], v[248:251]
    v_mfma_f32_16x16x32_bf16 v[232:235], v[40:43], a[248:251], v[232:235]
    s_waitcnt vmcnt(19)
    s_barrier
    v_mfma_f32_16x16x32_bf16 v[228:231], v[40:43], a[244:247], v[228:231]
    ds_read_b64_tr_b16 v[32:33], v10 offset:32768
    v_permlane16_swap_b32 v104, v106
    v_mfma_f32_16x16x32_bf16 v[244:247], v[44:47], a[244:247], v[244:247]
    ds_read_b64_tr_b16 v[34:35], v10 offset:33280
    v_permlane16_swap_b32 v105, v107
    v_mfma_f32_16x16x32_bf16 v[240:243], v[44:47], a[240:243], v[240:243]
    buffer_store_dwordx4 v[104:107], v4, s[28:31], s50 offen offset:1024 sc1
    v_mfma_f32_16x16x32_bf16 v[224:227], v[40:43], a[240:243], v[224:227]
    v_max_f32 v168, 0, v168
    s_waitcnt lgkmcnt(6)
    v_mfma_f32_16x16x32_bf16 v[224:227], v[48:51], v[64:67], v[224:227]
    ds_read_b64_tr_b16 v[36:37], v10 offset:36864
    v_max_f32 v169, 0, v169
    v_mfma_f32_16x16x32_bf16 v[240:243], v[52:55], v[64:67], v[240:243]
    ds_read_b64_tr_b16 v[38:39], v10 offset:37376
    v_max_f32 v170, 0, v170
    v_mfma_f32_16x16x32_bf16 v[244:247], v[52:55], v[68:71], v[244:247]
    v_max_f32 v171, 0, v171
    v_mul_f32 v168, v168, v184
    v_mfma_f32_16x16x32_bf16 v[228:231], v[48:51], v[68:71], v[228:231]
    v_mul_f32 v169, v169, v185
    v_mul_f32 v170, v170, v186
    v_mfma_f32_16x16x32_bf16 v[232:235], v[48:51], v[72:75], v[232:235]
    ds_read_b64_tr_b16 v[40:41], v10 offset:40960
    v_mul_f32 v171, v171, v187
    v_mfma_f32_16x16x32_bf16 v[248:251], v[52:55], v[72:75], v[248:251]
    ds_read_b64_tr_b16 v[42:43], v10 offset:41472
    v_cvt_pk_bf16_f32 v108, v168, v169
    v_mfma_f32_16x16x32_bf16 v[252:255], v[52:55], v[76:79], v[252:255]
    v_cvt_pk_bf16_f32 v109, v170, v171
    v_max_f32 v172, 0, v172
    v_mfma_f32_16x16x32_bf16 v[236:239], v[48:51], v[76:79], v[236:239]
    v_max_f32 v173, 0, v173
    s_waitcnt lgkmcnt(6)
    v_mfma_f32_16x16x32_bf16 v[236:239], v[56:59], v[92:95], v[236:239]
    ds_read_b64_tr_b16 v[44:45], v10 offset:45056
    v_max_f32 v174, 0, v174
    v_mfma_f32_16x16x32_bf16 v[252:255], v[60:63], v[92:95], v[252:255]
    ds_read_b64_tr_b16 v[46:47], v10 offset:45568
    v_max_f32 v175, 0, v175
    v_mfma_f32_16x16x32_bf16 v[248:251], v[60:63], v[88:91], v[248:251]
    v_mul_f32 v172, v172, v188
    v_mul_f32 v173, v173, v189
    v_mfma_f32_16x16x32_bf16 v[232:235], v[56:59], v[88:91], v[232:235]
    v_mul_f32 v174, v174, v190
    v_mul_f32 v175, v175, v191
    v_mfma_f32_16x16x32_bf16 v[228:231], v[56:59], v[84:87], v[228:231]
    ds_read_b64_tr_b16 v[48:49], v10 offset:49152
    v_cvt_pk_bf16_f32 v110, v172, v173
    v_mfma_f32_16x16x32_bf16 v[244:247], v[60:63], v[84:87], v[244:247]
    ds_read_b64_tr_b16 v[50:51], v10 offset:49664
    v_cvt_pk_bf16_f32 v111, v174, v175
    v_mfma_f32_16x16x32_bf16 v[240:243], v[60:63], v[80:83], v[240:243]
    v_mfma_f32_16x16x32_bf16 v[224:227], v[56:59], v[80:83], v[224:227]
    s_waitcnt lgkmcnt(6)
    v_mfma_f32_16x16x32_bf16 v[128:131], v[32:35], a[0:3], 0
    ds_read_b64_tr_b16 v[52:53], v10 offset:53248
    v_permlane16_swap_b32 v108, v110
    v_mfma_f32_16x16x32_bf16 v[144:147], v[36:39], a[0:3], 0
    ds_read_b64_tr_b16 v[54:55], v10 offset:53760
    s_add_u32 m0, s42, 106496
    v_mfma_f32_16x16x32_bf16 v[148:151], v[36:39], a[4:7], 0
    buffer_load_dwordx4 v2, s[16:19], s40 offen  lds
    v_mfma_f32_16x16x32_bf16 v[132:135], v[32:35], a[4:7], 0
    v_permlane16_swap_b32 v109, v111
    v_max_f32 v192, 0, v192
    v_mfma_f32_16x16x32_bf16 v[136:139], v[32:35], a[8:11], 0
    ds_read_b64_tr_b16 v[56:57], v10 offset:57344
    v_max_f32 v193, 0, v193
    v_mfma_f32_16x16x32_bf16 v[152:155], v[36:39], a[8:11], 0
    ds_read_b64_tr_b16 v[58:59], v10 offset:57856
    s_add_u32 m0, s42, 110592
    v_mfma_f32_16x16x32_bf16 v[156:159], v[36:39], a[12:15], 0
    buffer_load_dwordx4 v2, s[20:23], s40 offen  lds
    v_mfma_f32_16x16x32_bf16 v[140:143], v[32:35], a[12:15], 0
    s_add_u32 s40, s40, 294912
    s_waitcnt lgkmcnt(6)
    v_mfma_f32_16x16x32_bf16 v[140:143], v[40:43], a[28:31], v[140:143]
    ds_read_b64_tr_b16 v[60:61], v10 offset:61440
    v_max_f32 v194, 0, v194
    v_mfma_f32_16x16x32_bf16 v[156:159], v[44:47], a[28:31], v[156:159]
    ds_read_b64_tr_b16 v[62:63], v10 offset:61952
    v_max_f32 v195, 0, v195
    v_mfma_f32_16x16x32_bf16 v[152:155], v[44:47], a[24:27], v[152:155]
    buffer_store_dwordx4 v[108:111], v4, s[28:31], s51 offen offset:1024 sc1
    v_mfma_f32_16x16x32_bf16 v[136:139], v[40:43], a[24:27], v[136:139]
    v_mul_f32 v192, v192, v208
    v_mul_f32 v193, v193, v209
    v_mfma_f32_16x16x32_bf16 v[132:135], v[40:43], a[20:23], v[132:135]
    ds_read_b64_tr_b16 v[32:33], v11 offset:32768
    v_mul_f32 v194, v194, v210
    v_mfma_f32_16x16x32_bf16 v[148:151], v[44:47], a[20:23], v[148:151]
    ds_read_b64_tr_b16 v[34:35], v11 offset:33280
    v_mul_f32 v195, v195, v211
    v_mfma_f32_16x16x32_bf16 v[144:147], v[44:47], a[16:19], v[144:147]
    v_cvt_pk_bf16_f32 v112, v192, v193
    v_cvt_pk_bf16_f32 v113, v194, v195
    v_mfma_f32_16x16x32_bf16 v[128:131], v[40:43], a[16:19], v[128:131]
    v_max_f32 v196, 0, v196
    s_waitcnt lgkmcnt(6)
    v_mfma_f32_16x16x32_bf16 v[128:131], v[48:51], a[32:35], v[128:131]
    ds_read_b64_tr_b16 v[36:37], v11 offset:36864
    v_max_f32 v197, 0, v197
    v_mfma_f32_16x16x32_bf16 v[144:147], v[52:55], a[32:35], v[144:147]
    ds_read_b64_tr_b16 v[38:39], v11 offset:37376
    v_max_f32 v198, 0, v198
    v_mfma_f32_16x16x32_bf16 v[148:151], v[52:55], a[36:39], v[148:151]
    v_max_f32 v199, 0, v199
    v_mul_f32 v196, v196, v212
    v_mfma_f32_16x16x32_bf16 v[132:135], v[48:51], a[36:39], v[132:135]
    v_mul_f32 v197, v197, v213
    v_mul_f32 v198, v198, v214
    v_mfma_f32_16x16x32_bf16 v[136:139], v[48:51], a[40:43], v[136:139]
    ds_read_b64_tr_b16 v[40:41], v11 offset:40960
    v_mul_f32 v199, v199, v215
    v_mfma_f32_16x16x32_bf16 v[152:155], v[52:55], a[40:43], v[152:155]
    ds_read_b64_tr_b16 v[42:43], v11 offset:41472
    v_cvt_pk_bf16_f32 v114, v196, v197
    v_mfma_f32_16x16x32_bf16 v[156:159], v[52:55], a[44:47], v[156:159]
    v_cvt_pk_bf16_f32 v115, v198, v199
    v_mfma_f32_16x16x32_bf16 v[140:143], v[48:51], a[44:47], v[140:143]
    s_waitcnt lgkmcnt(6)
    v_mfma_f32_16x16x32_bf16 v[140:143], v[56:59], a[60:63], v[140:143]
    ds_read_b64_tr_b16 v[44:45], v11 offset:45056
    v_permlane16_swap_b32 v112, v114
    v_mfma_f32_16x16x32_bf16 v[156:159], v[60:63], a[60:63], v[156:159]
    ds_read_b64_tr_b16 v[46:47], v11 offset:45568
    v_permlane16_swap_b32 v113, v115
    v_mfma_f32_16x16x32_bf16 v[152:155], v[60:63], a[56:59], v[152:155]
    v_max_f32 v200, 0, v200
    v_max_f32 v201, 0, v201
    v_mfma_f32_16x16x32_bf16 v[136:139], v[56:59], a[56:59], v[136:139]
    v_max_f32 v202, 0, v202
    v_max_f32 v203, 0, v203
    v_mfma_f32_16x16x32_bf16 v[132:135], v[56:59], a[52:55], v[132:135]
    ds_read_b64_tr_b16 v[48:49], v11 offset:49152
    v_mul_f32 v200, v200, v216
    v_mfma_f32_16x16x32_bf16 v[148:151], v[60:63], a[52:55], v[148:151]
    ds_read_b64_tr_b16 v[50:51], v11 offset:49664
    v_mul_f32 v201, v201, v217
    v_mfma_f32_16x16x32_bf16 v[144:147], v[60:63], a[48:51], v[144:147]
    buffer_store_dwordx4 v[112:115], v4, s[28:31], s50 offen offset:2048 sc1
    v_mfma_f32_16x16x32_bf16 v[128:131], v[56:59], a[48:51], v[128:131]
    v_mul_f32 v202, v202, v218
    s_waitcnt lgkmcnt(6)
    v_mfma_f32_16x16x32_bf16 v[160:163], v[32:35], a[0:3], 0
    ds_read_b64_tr_b16 v[52:53], v11 offset:53248
    v_mul_f32 v203, v203, v219
    v_mfma_f32_16x16x32_bf16 v[176:179], v[36:39], a[0:3], 0
    ds_read_b64_tr_b16 v[54:55], v11 offset:53760
    s_add_u32 m0, s42, 0
    v_mfma_f32_16x16x32_bf16 v[180:183], v[36:39], a[4:7], 0
    buffer_load_dwordx4 v2, s[16:19], s40 offen  lds
    v_mfma_f32_16x16x32_bf16 v[164:167], v[32:35], a[4:7], 0
    v_cvt_pk_bf16_f32 v116, v200, v201
    v_cvt_pk_bf16_f32 v117, v202, v203
    v_mfma_f32_16x16x32_bf16 v[168:171], v[32:35], a[8:11], 0
    ds_read_b64_tr_b16 v[56:57], v11 offset:57344
    v_max_f32 v204, 0, v204
    v_mfma_f32_16x16x32_bf16 v[184:187], v[36:39], a[8:11], 0
    ds_read_b64_tr_b16 v[58:59], v11 offset:57856
    s_add_u32 m0, s42, 4096
    v_mfma_f32_16x16x32_bf16 v[188:191], v[36:39], a[12:15], 0
    buffer_load_dwordx4 v2, s[20:23], s40 offen  lds
    v_mfma_f32_16x16x32_bf16 v[172:175], v[32:35], a[12:15], 0
    s_add_u32 s40, s40, 294912
    s_waitcnt lgkmcnt(6)
    v_mfma_f32_16x16x32_bf16 v[172:175], v[40:43], a[28:31], v[172:175]
    ds_read_b64_tr_b16 v[60:61], v11 offset:61440
    v_max_f32 v205, 0, v205
    v_mfma_f32_16x16x32_bf16 v[188:191], v[44:47], a[28:31], v[188:191]
    ds_read_b64_tr_b16 v[62:63], v11 offset:61952
    v_max_f32 v206, 0, v206
    v_mfma_f32_16x16x32_bf16 v[184:187], v[44:47], a[24:27], v[184:187]
    v_max_f32 v207, 0, v207
    v_mul_f32 v204, v204, v220
    v_mfma_f32_16x16x32_bf16 v[168:171], v[40:43], a[24:27], v[168:171]
    v_mul_f32 v205, v205, v221
    v_mul_f32 v206, v206, v222
    v_mfma_f32_16x16x32_bf16 v[164:167], v[40:43], a[20:23], v[164:167]
    ds_read_b64_tr_b16 v[32:33], v12 offset:32768
    v_mul_f32 v207, v207, v223
    v_mfma_f32_16x16x32_bf16 v[180:183], v[44:47], a[20:23], v[180:183]
    ds_read_b64_tr_b16 v[34:35], v12 offset:33280
    v_cvt_pk_bf16_f32 v118, v204, v205
    v_mfma_f32_16x16x32_bf16 v[176:179], v[44:47], a[16:19], v[176:179]
    v_cvt_pk_bf16_f32 v119, v206, v207
    v_mfma_f32_16x16x32_bf16 v[160:163], v[40:43], a[16:19], v[160:163]
    s_waitcnt lgkmcnt(6)
    v_mfma_f32_16x16x32_bf16 v[160:163], v[48:51], a[32:35], v[160:163]
    ds_read_b64_tr_b16 v[36:37], v12 offset:36864
    v_permlane16_swap_b32 v116, v118
    v_mfma_f32_16x16x32_bf16 v[176:179], v[52:55], a[32:35], v[176:179]
    ds_read_b64_tr_b16 v[38:39], v12 offset:37376
    v_permlane16_swap_b32 v117, v119
    v_mfma_f32_16x16x32_bf16 v[180:183], v[52:55], a[36:39], v[180:183]
    buffer_store_dwordx4 v[116:119], v4, s[28:31], s51 offen offset:2048 sc1
    v_mfma_f32_16x16x32_bf16 v[164:167], v[48:51], a[36:39], v[164:167]
    v_max_f32 v224, 0, v224
    v_max_f32 v225, 0, v225
    v_mfma_f32_16x16x32_bf16 v[168:171], v[48:51], a[40:43], v[168:171]
    ds_read_b64_tr_b16 v[40:41], v12 offset:40960
    v_max_f32 v226, 0, v226
    v_mfma_f32_16x16x32_bf16 v[184:187], v[52:55], a[40:43], v[184:187]
    ds_read_b64_tr_b16 v[42:43], v12 offset:41472
    v_max_f32 v227, 0, v227
    v_mfma_f32_16x16x32_bf16 v[188:191], v[52:55], a[44:47], v[188:191]
    v_mul_f32 v224, v224, v240
    v_mul_f32 v225, v225, v241
    v_mfma_f32_16x16x32_bf16 v[172:175], v[48:51], a[44:47], v[172:175]
    v_mul_f32 v226, v226, v242
    s_waitcnt lgkmcnt(6)
    v_mfma_f32_16x16x32_bf16 v[172:175], v[56:59], a[60:63], v[172:175]
    ds_read_b64_tr_b16 v[44:45], v12 offset:45056
    v_mul_f32 v227, v227, v243
    v_mfma_f32_16x16x32_bf16 v[188:191], v[60:63], a[60:63], v[188:191]
    ds_read_b64_tr_b16 v[46:47], v12 offset:45568
    v_cvt_pk_bf16_f32 v120, v224, v225
    v_mfma_f32_16x16x32_bf16 v[184:187], v[60:63], a[56:59], v[184:187]
    v_cvt_pk_bf16_f32 v121, v226, v227
    v_max_f32 v228, 0, v228
    v_mfma_f32_16x16x32_bf16 v[168:171], v[56:59], a[56:59], v[168:171]
    v_max_f32 v229, 0, v229
    v_max_f32 v230, 0, v230
    v_mfma_f32_16x16x32_bf16 v[164:167], v[56:59], a[52:55], v[164:167]
    ds_read_b64_tr_b16 v[48:49], v12 offset:49152
    v_max_f32 v231, 0, v231
    v_mfma_f32_16x16x32_bf16 v[180:183], v[60:63], a[52:55], v[180:183]
    ds_read_b64_tr_b16 v[50:51], v12 offset:49664
    v_mul_f32 v228, v228, v244
    v_mfma_f32_16x16x32_bf16 v[176:179], v[60:63], a[48:51], v[176:179]
    v_mul_f32 v229, v229, v245
    v_mul_f32 v230, v230, v246
    v_mfma_f32_16x16x32_bf16 v[160:163], v[56:59], a[48:51], v[160:163]
    v_mul_f32 v231, v231, v247
    s_waitcnt lgkmcnt(6)
    v_mfma_f32_16x16x32_bf16 v[192:195], v[32:35], a[0:3], 0
    ds_read_b64_tr_b16 v[52:53], v12 offset:53248
    v_cvt_pk_bf16_f32 v122, v228, v229
    v_mfma_f32_16x16x32_bf16 v[208:211], v[36:39], a[0:3], 0
    ds_read_b64_tr_b16 v[54:55], v12 offset:53760
    v_cvt_pk_bf16_f32 v123, v230, v231
    v_mfma_f32_16x16x32_bf16 v[212:215], v[36:39], a[4:7], 0
    v_mfma_f32_16x16x32_bf16 v[196:199], v[32:35], a[4:7], 0
    v_mfma_f32_16x16x32_bf16 v[200:203], v[32:35], a[8:11], 0
    ds_read_b64_tr_b16 v[56:57], v12 offset:57344
    v_permlane16_swap_b32 v120, v122
    v_mfma_f32_16x16x32_bf16 v[216:219], v[36:39], a[8:11], 0
    ds_read_b64_tr_b16 v[58:59], v12 offset:57856
    v_permlane16_swap_b32 v121, v123
    v_mfma_f32_16x16x32_bf16 v[220:223], v[36:39], a[12:15], 0
    buffer_store_dwordx4 v[120:123], v4, s[28:31], s50 offen offset:3072 sc1
    v_mfma_f32_16x16x32_bf16 v[204:207], v[32:35], a[12:15], 0
    v_max_f32 v232, 0, v232
    s_waitcnt lgkmcnt(6)
    v_mfma_f32_16x16x32_bf16 v[204:207], v[40:43], a[28:31], v[204:207]
    ds_read_b64_tr_b16 v[60:61], v12 offset:61440
    v_max_f32 v233, 0, v233
    v_mfma_f32_16x16x32_bf16 v[220:223], v[44:47], a[28:31], v[220:223]
    ds_read_b64_tr_b16 v[62:63], v12 offset:61952
    v_max_f32 v234, 0, v234
    v_mfma_f32_16x16x32_bf16 v[216:219], v[44:47], a[24:27], v[216:219]
    v_max_f32 v235, 0, v235
    v_mul_f32 v232, v232, v248
    v_mfma_f32_16x16x32_bf16 v[200:203], v[40:43], a[24:27], v[200:203]
    v_mul_f32 v233, v233, v249
    v_mul_f32 v234, v234, v250
    v_mfma_f32_16x16x32_bf16 v[196:199], v[40:43], a[20:23], v[196:199]
    ds_read_b64_tr_b16 v[32:33], v13 offset:32768
    v_mul_f32 v235, v235, v251
    v_mfma_f32_16x16x32_bf16 v[212:215], v[44:47], a[20:23], v[212:215]
    ds_read_b64_tr_b16 v[34:35], v13 offset:33280
    v_cvt_pk_bf16_f32 v124, v232, v233
    v_mfma_f32_16x16x32_bf16 v[208:211], v[44:47], a[16:19], v[208:211]
    v_cvt_pk_bf16_f32 v125, v234, v235
    v_max_f32 v236, 0, v236
    v_mfma_f32_16x16x32_bf16 v[192:195], v[40:43], a[16:19], v[192:195]
    v_max_f32 v237, 0, v237
    s_waitcnt lgkmcnt(6)
    v_mfma_f32_16x16x32_bf16 v[192:195], v[48:51], a[32:35], v[192:195]
    ds_read_b64_tr_b16 v[36:37], v13 offset:36864
    v_max_f32 v238, 0, v238
    v_mfma_f32_16x16x32_bf16 v[208:211], v[52:55], a[32:35], v[208:211]
    ds_read_b64_tr_b16 v[38:39], v13 offset:37376
    v_max_f32 v239, 0, v239
    v_mfma_f32_16x16x32_bf16 v[212:215], v[52:55], a[36:39], v[212:215]
    v_mul_f32 v236, v236, v252
    v_mul_f32 v237, v237, v253
    v_mfma_f32_16x16x32_bf16 v[196:199], v[48:51], a[36:39], v[196:199]
    v_mul_f32 v238, v238, v254
    v_mul_f32 v239, v239, v255
    v_mfma_f32_16x16x32_bf16 v[200:203], v[48:51], a[40:43], v[200:203]
    ds_read_b64_tr_b16 v[40:41], v13 offset:40960
    v_cvt_pk_bf16_f32 v126, v236, v237
    v_mfma_f32_16x16x32_bf16 v[216:219], v[52:55], a[40:43], v[216:219]
    ds_read_b64_tr_b16 v[42:43], v13 offset:41472
    v_cvt_pk_bf16_f32 v127, v238, v239
    v_mfma_f32_16x16x32_bf16 v[220:223], v[52:55], a[44:47], v[220:223]
    v_mfma_f32_16x16x32_bf16 v[204:207], v[48:51], a[44:47], v[204:207]
    s_waitcnt lgkmcnt(6)
    v_mfma_f32_16x16x32_bf16 v[204:207], v[56:59], a[60:63], v[204:207]
    ds_read_b64_tr_b16 v[44:45], v13 offset:45056
    v_permlane16_swap_b32 v124, v126
    v_mfma_f32_16x16x32_bf16 v[220:223], v[60:63], a[60:63], v[220:223]
    ds_read_b64_tr_b16 v[46:47], v13 offset:45568
    v_permlane16_swap_b32 v125, v127
    v_mfma_f32_16x16x32_bf16 v[216:219], v[60:63], a[56:59], v[216:219]
    buffer_store_dwordx4 v[124:127], v4, s[28:31], s51 offen offset:3072 sc1
    v_mfma_f32_16x16x32_bf16 v[200:203], v[56:59], a[56:59], v[200:203]
    v_mfma_f32_16x16x32_bf16 v[196:199], v[56:59], a[52:55], v[196:199]
    ds_read_b64_tr_b16 v[48:49], v13 offset:49152
    v_mfma_f32_16x16x32_bf16 v[212:215], v[60:63], a[52:55], v[212:215]
    ds_read_b64_tr_b16 v[50:51], v13 offset:49664
    v_mfma_f32_16x16x32_bf16 v[208:211], v[60:63], a[48:51], v[208:211]
    v_mfma_f32_16x16x32_bf16 v[192:195], v[56:59], a[48:51], v[192:195]
    s_waitcnt lgkmcnt(6)
    v_mfma_f32_16x16x32_bf16 v[224:227], v[32:35], a[0:3], 0
    ds_read_b64_tr_b16 v[52:53], v13 offset:53248
    v_mfma_f32_16x16x32_bf16 v[240:243], v[36:39], a[0:3], 0
    ds_read_b64_tr_b16 v[54:55], v13 offset:53760
    s_add_u32 m0, s44, 0
    v_mfma_f32_16x16x32_bf16 v[244:247], v[36:39], a[4:7], 0
    buffer_load_dwordx4 v3, s[32:35], s43 offen  lds
    v_mfma_f32_16x16x32_bf16 v[228:231], v[32:35], a[4:7], 0
    s_add_u32 s43, s43, 294912
    v_mfma_f32_16x16x32_bf16 v[232:235], v[32:35], a[8:11], 0
    ds_read_b64_tr_b16 v[56:57], v13 offset:57344
    v_mfma_f32_16x16x32_bf16 v[248:251], v[36:39], a[8:11], 0
    ds_read_b64_tr_b16 v[58:59], v13 offset:57856
    v_mfma_f32_16x16x32_bf16 v[252:255], v[36:39], a[12:15], 0
    v_mfma_f32_16x16x32_bf16 v[236:239], v[32:35], a[12:15], 0
    s_waitcnt lgkmcnt(6)
    v_mfma_f32_16x16x32_bf16 v[236:239], v[40:43], a[28:31], v[236:239]
    ds_read_b64_tr_b16 v[60:61], v13 offset:61440
    v_mfma_f32_16x16x32_bf16 v[252:255], v[44:47], a[28:31], v[252:255]
    ds_read_b64_tr_b16 v[62:63], v13 offset:61952
    v_mfma_f32_16x16x32_bf16 v[248:251], v[44:47], a[24:27], v[248:251]
    v_mfma_f32_16x16x32_bf16 v[232:235], v[40:43], a[24:27], v[232:235]
    s_waitcnt vmcnt(23)
    s_barrier
    v_mfma_f32_16x16x32_bf16 v[228:231], v[40:43], a[20:23], v[228:231]
    ds_read_b64_tr_b16 v[32:33], v14 offset:0
    v_mfma_f32_16x16x32_bf16 v[244:247], v[44:47], a[20:23], v[244:247]
    ds_read_b64_tr_b16 v[34:35], v14 offset:512
    s_add_u32 m0, s42, 8192
    v_mfma_f32_16x16x32_bf16 v[240:243], v[44:47], a[16:19], v[240:243]
    buffer_load_dwordx4 v2, s[16:19], s40 offen  lds
    v_mfma_f32_16x16x32_bf16 v[224:227], v[40:43], a[16:19], v[224:227]
    s_waitcnt lgkmcnt(6)
    v_mfma_f32_16x16x32_bf16 v[224:227], v[48:51], a[32:35], v[224:227]
    ds_read_b64_tr_b16 v[36:37], v14 offset:4096
    v_mfma_f32_16x16x32_bf16 v[240:243], v[52:55], a[32:35], v[240:243]
    ds_read_b64_tr_b16 v[38:39], v14 offset:4608
    s_add_u32 m0, s42, 12288
    v_mfma_f32_16x16x32_bf16 v[244:247], v[52:55], a[36:39], v[244:247]
    buffer_load_dwordx4 v2, s[20:23], s40 offen  lds
    v_mfma_f32_16x16x32_bf16 v[228:231], v[48:51], a[36:39], v[228:231]
    s_add_u32 s40, s40, 294912
    v_mfma_f32_16x16x32_bf16 v[232:235], v[48:51], a[40:43], v[232:235]
    ds_read_b64_tr_b16 v[40:41], v15 offset:0
    v_mfma_f32_16x16x32_bf16 v[248:251], v[52:55], a[40:43], v[248:251]
    ds_read_b64_tr_b16 v[42:43], v15 offset:512
    s_add_u32 m0, s42, 16384
    v_mfma_f32_16x16x32_bf16 v[252:255], v[52:55], a[44:47], v[252:255]
    buffer_load_dwordx4 v2, s[16:19], s40 offen  lds
    v_mfma_f32_16x16x32_bf16 v[236:239], v[48:51], a[44:47], v[236:239]
    s_waitcnt lgkmcnt(6)
    v_mfma_f32_16x16x32_bf16 v[236:239], v[56:59], a[60:63], v[236:239]
    ds_read_b64_tr_b16 v[44:45], v15 offset:4096
    v_mfma_f32_16x16x32_bf16 v[252:255], v[60:63], a[60:63], v[252:255]
    ds_read_b64_tr_b16 v[46:47], v15 offset:4608
    s_add_u32 m0, s42, 20480
    v_mfma_f32_16x16x32_bf16 v[248:251], v[60:63], a[56:59], v[248:251]
    buffer_load_dwordx4 v2, s[20:23], s40 offen  lds
    v_mfma_f32_16x16x32_bf16 v[232:235], v[56:59], a[56:59], v[232:235]
    s_add_u32 s40, s40, 294912
    v_mfma_f32_16x16x32_bf16 v[228:231], v[56:59], a[52:55], v[228:231]
    ds_read_b64_tr_b16 v[48:49], v16 offset:0
    v_mfma_f32_16x16x32_bf16 v[244:247], v[60:63], a[52:55], v[244:247]
    ds_read_b64_tr_b16 v[50:51], v16 offset:512
    s_add_u32 m0, s42, 24576
    v_mfma_f32_16x16x32_bf16 v[240:243], v[60:63], a[48:51], v[240:243]
    buffer_load_dwordx4 v2, s[16:19], s40 offen  lds
    v_mfma_f32_16x16x32_bf16 v[224:227], v[56:59], a[48:51], v[224:227]
    s_waitcnt lgkmcnt(6)
    v_mfma_f32_16x16x32_bf16 v[128:131], v[32:35], a[64:67], v[128:131]
    ds_read_b64_tr_b16 v[52:53], v16 offset:4096
    v_mfma_f32_16x16x32_bf16 v[144:147], v[36:39], a[64:67], v[144:147]
    ds_read_b64_tr_b16 v[54:55], v16 offset:4608
    s_add_u32 m0, s42, 28672
    v_mfma_f32_16x16x32_bf16 v[148:151], v[36:39], a[68:71], v[148:151]
    buffer_load_dwordx4 v2, s[20:23], s40 offen  lds
    v_mfma_f32_16x16x32_bf16 v[132:135], v[32:35], a[68:71], v[132:135]
    s_add_u32 s40, s40, 294912
    v_mfma_f32_16x16x32_bf16 v[136:139], v[32:35], a[72:75], v[136:139]
    ds_read_b64_tr_b16 v[56:57], v17 offset:0
    v_mfma_f32_16x16x32_bf16 v[152:155], v[36:39], a[72:75], v[152:155]
    ds_read_b64_tr_b16 v[58:59], v17 offset:512
    s_add_u32 m0, s42, 32768
    v_mfma_f32_16x16x32_bf16 v[156:159], v[36:39], a[76:79], v[156:159]
    buffer_load_dwordx4 v2, s[16:19], s40 offen  lds
    v_mfma_f32_16x16x32_bf16 v[140:143], v[32:35], a[76:79], v[140:143]
    s_waitcnt lgkmcnt(6)
    v_mfma_f32_16x16x32_bf16 v[172:175], v[40:43], a[76:79], v[172:175]
    ds_read_b64_tr_b16 v[60:61], v17 offset:4096
    v_mfma_f32_16x16x32_bf16 v[188:191], v[44:47], a[76:79], v[188:191]
    ds_read_b64_tr_b16 v[62:63], v17 offset:4608
    s_add_u32 m0, s42, 36864
    v_mfma_f32_16x16x32_bf16 v[184:187], v[44:47], a[72:75], v[184:187]
    buffer_load_dwordx4 v2, s[20:23], s40 offen  lds
    v_mfma_f32_16x16x32_bf16 v[168:171], v[40:43], a[72:75], v[168:171]
    s_add_u32 s40, s40, 294912
    v_mfma_f32_16x16x32_bf16 v[164:167], v[40:43], a[68:71], v[164:167]
    ds_read_b64_tr_b16 v[32:33], v14 offset:8192
    v_mfma_f32_16x16x32_bf16 v[180:183], v[44:47], a[68:71], v[180:183]
    ds_read_b64_tr_b16 v[34:35], v14 offset:8704
    s_add_u32 m0, s44, 1024
    v_mfma_f32_16x16x32_bf16 v[176:179], v[44:47], a[64:67], v[176:179]
    buffer_load_dwordx4 v3, s[32:35], s43 offen  lds
    v_mfma_f32_16x16x32_bf16 v[160:163], v[40:43], a[64:67], v[160:163]
    s_add_u32 s43, s43, 294912
    s_waitcnt lgkmcnt(6)
    v_mfma_f32_16x16x32_bf16 v[192:195], v[48:51], a[64:67], v[192:195]
    ds_read_b64_tr_b16 v[36:37], v14 offset:12288
    v_mfma_f32_16x16x32_bf16 v[208:211], v[52:55], a[64:67], v[208:211]
    ds_read_b64_tr_b16 v[38:39], v14 offset:12800
    v_mfma_f32_16x16x32_bf16 v[212:215], v[52:55], a[68:71], v[212:215]
    v_mfma_f32_16x16x32_bf16 v[196:199], v[48:51], a[68:71], v[196:199]
    v_mfma_f32_16x16x32_bf16 v[200:203], v[48:51], a[72:75], v[200:203]
    ds_read_b64_tr_b16 v[40:41], v15 offset:8192
    v_mfma_f32_16x16x32_bf16 v[216:219], v[52:55], a[72:75], v[216:219]
    ds_read_b64_tr_b16 v[42:43], v15 offset:8704
    v_mfma_f32_16x16x32_bf16 v[220:223], v[52:55], a[76:79], v[220:223]
    v_mfma_f32_16x16x32_bf16 v[204:207], v[48:51], a[76:79], v[204:207]
    s_waitcnt lgkmcnt(6)
    v_mfma_f32_16x16x32_bf16 v[236:239], v[56:59], a[76:79], v[236:239]
    ds_read_b64_tr_b16 v[44:45], v15 offset:12288
    v_mfma_f32_16x16x32_bf16 v[252:255], v[60:63], a[76:79], v[252:255]
    ds_read_b64_tr_b16 v[46:47], v15 offset:12800
    v_mfma_f32_16x16x32_bf16 v[248:251], v[60:63], a[72:75], v[248:251]
    v_mfma_f32_16x16x32_bf16 v[232:235], v[56:59], a[72:75], v[232:235]
    v_mfma_f32_16x16x32_bf16 v[228:231], v[56:59], a[68:71], v[228:231]
    ds_read_b64_tr_b16 v[48:49], v16 offset:8192
    v_mfma_f32_16x16x32_bf16 v[244:247], v[60:63], a[68:71], v[244:247]
    ds_read_b64_tr_b16 v[50:51], v16 offset:8704
    v_mfma_f32_16x16x32_bf16 v[240:243], v[60:63], a[64:67], v[240:243]
    v_mfma_f32_16x16x32_bf16 v[224:227], v[56:59], a[64:67], v[224:227]
    s_waitcnt lgkmcnt(6)
    v_mfma_f32_16x16x32_bf16 v[128:131], v[32:35], a[80:83], v[128:131]
    ds_read_b64_tr_b16 v[52:53], v16 offset:12288
    v_mfma_f32_16x16x32_bf16 v[144:147], v[36:39], a[80:83], v[144:147]
    ds_read_b64_tr_b16 v[54:55], v16 offset:12800
    v_mfma_f32_16x16x32_bf16 v[148:151], v[36:39], a[84:87], v[148:151]
    v_mfma_f32_16x16x32_bf16 v[132:135], v[32:35], a[84:87], v[132:135]
    v_mfma_f32_16x16x32_bf16 v[136:139], v[32:35], a[88:91], v[136:139]
    ds_read_b64_tr_b16 v[56:57], v17 offset:8192
    v_mfma_f32_16x16x32_bf16 v[152:155], v[36:39], a[88:91], v[152:155]
    ds_read_b64_tr_b16 v[58:59], v17 offset:8704
    v_mfma_f32_16x16x32_bf16 v[156:159], v[36:39], a[92:95], v[156:159]
    v_mfma_f32_16x16x32_bf16 v[140:143], v[32:35], a[92:95], v[140:143]
    s_waitcnt lgkmcnt(6)
    v_mfma_f32_16x16x32_bf16 v[172:175], v[40:43], a[92:95], v[172:175]
    ds_read_b64_tr_b16 v[60:61], v17 offset:12288
    v_mfma_f32_16x16x32_bf16 v[188:191], v[44:47], a[92:95], v[188:191]
    ds_read_b64_tr_b16 v[62:63], v17 offset:12800
    s_add_u32 m0, s44, 2048
    v_mfma_f32_16x16x32_bf16 v[184:187], v[44:47], a[88:91], v[184:187]
    buffer_load_dwordx4 v3, s[32:35], s43 offen  lds
    v_mfma_f32_16x16x32_bf16 v[168:171], v[40:43], a[88:91], v[168:171]
    s_add_u32 s43, s43, 294912
    s_waitcnt vmcnt(24)
    s_barrier
    v_mfma_f32_16x16x32_bf16 v[164:167], v[40:43], a[84:87], v[164:167]
    ds_read_b64_tr_b16 v[32:33], v14 offset:16384
    v_mfma_f32_16x16x32_bf16 v[180:183], v[44:47], a[84:87], v[180:183]
    ds_read_b64_tr_b16 v[34:35], v14 offset:16896
    s_add_u32 m0, s42, 40960
    v_mfma_f32_16x16x32_bf16 v[176:179], v[44:47], a[80:83], v[176:179]
    s_branch K4_ps6
K4_pg6:
    s_branch K4_vrA
K4_ps6:
    buffer_load_dwordx4 v2, s[16:19], s40 offen  lds
    v_mfma_f32_16x16x32_bf16 v[160:163], v[40:43], a[80:83], v[160:163]
    s_waitcnt lgkmcnt(6)
    v_mfma_f32_16x16x32_bf16 v[192:195], v[48:51], a[80:83], v[192:195]
    ds_read_b64_tr_b16 v[36:37], v14 offset:20480
    v_mfma_f32_16x16x32_bf16 v[208:211], v[52:55], a[80:83], v[208:211]
    ds_read_b64_tr_b16 v[38:39], v14 offset:20992
    s_add_u32 m0, s42, 45056
    v_mfma_f32_16x16x32_bf16 v[212:215], v[52:55], a[84:87], v[212:215]
    buffer_load_dwordx4 v2, s[20:23], s40 offen  lds
    v_mfma_f32_16x16x32_bf16 v[196:199], v[48:51], a[84:87], v[196:199]
    s_add_u32 s40, s40, 294912
    v_mfma_f32_16x16x32_bf16 v[200:203], v[48:51], a[88:91], v[200:203]
    ds_read_b64_tr_b16 v[40:41], v15 offset:16384
    v_mfma_f32_16x16x32_bf16 v[216:219], v[52:55], a[88:91], v[216:219]
    ds_read_b64_tr_b16 v[42:43], v15 offset:16896
    s_add_u32 m0, s42, 49152
    v_mfma_f32_16x16x32_bf16 v[220:223], v[52:55], a[92:95], v[220:223]
    buffer_load_dwordx4 v2, s[16:19], s40 offen  lds
    v_mfma_f32_16x16x32_bf16 v[204:207], v[48:51], a[92:95], v[204:207]
    s_waitcnt lgkmcnt(6)
    v_mfma_f32_16x16x32_bf16 v[236:239], v[56:59], a[92:95], v[236:239]
    ds_read_b64_tr_b16 v[44:45], v15 offset:20480
    v_mfma_f32_16x16x32_bf16 v[252:255], v[60:63], a[92:95], v[252:255]
    ds_read_b64_tr_b16 v[46:47], v15 offset:20992
    s_add_u32 m0, s42, 53248
    v_mfma_f32_16x16x32_bf16 v[248:251], v[60:63], a[88:91], v[248:251]
    buffer_load_dwordx4 v2, s[20:23], s40 offen  lds
    v_mfma_f32_16x16x32_bf16 v[232:235], v[56:59], a[88:91], v[232:235]
    s_add_u32 s40, s40, 294912
    v_mfma_f32_16x16x32_bf16 v[228:231], v[56:59], a[84:87], v[228:231]
    ds_read_b64_tr_b16 v[48:49], v16 offset:16384
    v_mfma_f32_16x16x32_bf16 v[244:247], v[60:63], a[84:87], v[244:247]
    ds_read_b64_tr_b16 v[50:51], v16 offset:16896
    s_add_u32 m0, s42, 57344
    v_mfma_f32_16x16x32_bf16 v[240:243], v[60:63], a[80:83], v[240:243]
    buffer_load_dwordx4 v2, s[16:19], s40 offen  lds
    v_mfma_f32_16x16x32_bf16 v[224:227], v[56:59], a[80:83], v[224:227]
    s_waitcnt lgkmcnt(6)
    v_mfma_f32_16x16x32_bf16 v[128:131], v[32:35], a[96:99], v[128:131]
    ds_read_b64_tr_b16 v[52:53], v16 offset:20480
    v_mfma_f32_16x16x32_bf16 v[144:147], v[36:39], a[96:99], v[144:147]
    ds_read_b64_tr_b16 v[54:55], v16 offset:20992
    s_add_u32 m0, s42, 61440
    v_mfma_f32_16x16x32_bf16 v[148:151], v[36:39], a[100:103], v[148:151]
    buffer_load_dwordx4 v2, s[20:23], s40 offen  lds
    v_mfma_f32_16x16x32_bf16 v[132:135], v[32:35], a[100:103], v[132:135]
    s_mov_b32 s40, s61
    v_mfma_f32_16x16x32_bf16 v[136:139], v[32:35], a[104:107], v[136:139]
    ds_read_b64_tr_b16 v[56:57], v17 offset:16384
    v_mfma_f32_16x16x32_bf16 v[152:155], v[36:39], a[104:107], v[152:155]
    ds_read_b64_tr_b16 v[58:59], v17 offset:16896
    v_mfma_f32_16x16x32_bf16 v[156:159], v[36:39], a[108:111], v[156:159]
    v_mfma_f32_16x16x32_bf16 v[140:143], v[32:35], a[108:111], v[140:143]
    s_waitcnt lgkmcnt(6)
    v_mfma_f32_16x16x32_bf16 v[172:175], v[40:43], a[108:111], v[172:175]
    ds_read_b64_tr_b16 v[60:61], v17 offset:20480
    v_mfma_f32_16x16x32_bf16 v[188:191], v[44:47], a[108:111], v[188:191]
    ds_read_b64_tr_b16 v[62:63], v17 offset:20992
    v_mfma_f32_16x16x32_bf16 v[184:187], v[44:47], a[104:107], v[184:187]
    v_mfma_f32_16x16x32_bf16 v[168:171], v[40:43], a[104:107], v[168:171]
    v_mfma_f32_16x16x32_bf16 v[164:167], v[40:43], a[100:103], v[164:167]
    ds_read_b64_tr_b16 v[32:33], v14 offset:24576
    v_mfma_f32_16x16x32_bf16 v[180:183], v[44:47], a[100:103], v[180:183]
    ds_read_b64_tr_b16 v[34:35], v14 offset:25088
    s_add_u32 m0, s44, 3072
    v_mfma_f32_16x16x32_bf16 v[176:179], v[44:47], a[96:99], v[176:179]
    buffer_load_dwordx4 v3, s[32:35], s43 offen  lds
    v_mfma_f32_16x16x32_bf16 v[160:163], v[40:43], a[96:99], v[160:163]
    s_add_u32 s43, s43, 294912
    s_waitcnt lgkmcnt(6)
    v_mfma_f32_16x16x32_bf16 v[192:195], v[48:51], a[96:99], v[192:195]
    ds_read_b64_tr_b16 v[36:37], v14 offset:28672
    v_mfma_f32_16x16x32_bf16 v[208:211], v[52:55], a[96:99], v[208:211]
    ds_read_b64_tr_b16 v[38:39], v14 offset:29184
    v_mfma_f32_16x16x32_bf16 v[212:215], v[52:55], a[100:103], v[212:215]
    v_mfma_f32_16x16x32_bf16 v[196:199], v[48:51], a[100:103], v[196:199]
    v_mfma_f32_16x16x32_bf16 v[200:203], v[48:51], a[104:107], v[200:203]
    ds_read_b64_tr_b16 v[40:41], v15 offset:24576
    v_mfma_f32_16x16x32_bf16 v[216:219], v[52:55], a[104:107], v[216:219]
    ds_read_b64_tr_b16 v[42:43], v15 offset:25088
    v_mfma_f32_16x16x32_bf16 v[220:223], v[52:55], a[108:111], v[220:223]
    v_mfma_f32_16x16x32_bf16 v[204:207], v[48:51], a[108:111], v[204:207]
    s_waitcnt lgkmcnt(6)
    v_mfma_f32_16x16x32_bf16 v[236:239], v[56:59], a[108:111], v[236:239]
    ds_read_b64_tr_b16 v[44:45], v15 offset:28672
    v_mfma_f32_16x16x32_bf16 v[252:255], v[60:63], a[108:111], v[252:255]
    ds_read_b64_tr_b16 v[46:47], v15 offset:29184
    v_mfma_f32_16x16x32_bf16 v[248:251], v[60:63], a[104:107], v[248:251]
    v_mfma_f32_16x16x32_bf16 v[232:235], v[56:59], a[104:107], v[232:235]
    v_mfma_f32_16x16x32_bf16 v[228:231], v[56:59], a[100:103], v[228:231]
    ds_read_b64_tr_b16 v[48:49], v16 offset:24576
    v_mfma_f32_16x16x32_bf16 v[244:247], v[60:63], a[100:103], v[244:247]
    ds_read_b64_tr_b16 v[50:51], v16 offset:25088
    v_mfma_f32_16x16x32_bf16 v[240:243], v[60:63], a[96:99], v[240:243]
    v_mfma_f32_16x16x32_bf16 v[224:227], v[56:59], a[96:99], v[224:227]
    s_waitcnt lgkmcnt(6)
    v_mfma_f32_16x16x32_bf16 v[128:131], v[32:35], a[112:115], v[128:131]
    ds_read_b64_tr_b16 v[52:53], v16 offset:28672
    v_mfma_f32_16x16x32_bf16 v[144:147], v[36:39], a[112:115], v[144:147]
    ds_read_b64_tr_b16 v[54:55], v16 offset:29184
    v_mfma_f32_16x16x32_bf16 v[148:151], v[36:39], a[116:119], v[148:151]
    v_mfma_f32_16x16x32_bf16 v[132:135], v[32:35], a[116:119], v[132:135]
    v_mfma_f32_16x16x32_bf16 v[136:139], v[32:35], a[120:123], v[136:139]
    ds_read_b64_tr_b16 v[56:57], v17 offset:24576
    v_mfma_f32_16x16x32_bf16 v[152:155], v[36:39], a[120:123], v[152:155]
    ds_read_b64_tr_b16 v[58:59], v17 offset:25088
    v_mfma_f32_16x16x32_bf16 v[156:159], v[36:39], a[124:127], v[156:159]
    buffer_load_dword v20, v19, s[64:67], s62 offen
    v_mfma_f32_16x16x32_bf16 v[140:143], v[32:35], a[124:127], v[140:143]
    s_waitcnt lgkmcnt(6)
    v_mfma_f32_16x16x32_bf16 v[172:175], v[40:43], a[124:127], v[172:175]
    ds_read_b64_tr_b16 v[60:61], v17 offset:28672
    v_mfma_f32_16x16x32_bf16 v[188:191], v[44:47], a[124:127], v[188:191]
    ds_read_b64_tr_b16 v[62:63], v17 offset:29184
    v_mfma_f32_16x16x32_bf16 v[184:187], v[44:47], a[120:123], v[184:187]
    v_mfma_f32_16x16x32_bf16 v[168:171], v[40:43], a[120:123], v[168:171]
    s_waitcnt vmcnt(26)
    s_barrier
    v_mfma_f32_16x16x32_bf16 v[164:167], v[40:43], a[116:119], v[164:167]
    ds_read_b64_tr_b16 v[32:33], v14 offset:32768
    v_mfma_f32_16x16x32_bf16 v[180:183], v[44:47], a[116:119], v[180:183]
    ds_read_b64_tr_b16 v[34:35], v14 offset:33280
    v_mfma_f32_16x16x32_bf16 v[176:179], v[44:47], a[112:115], v[176:179]
    v_mfma_f32_16x16x32_bf16 v[160:163], v[40:43], a[112:115], v[160:163]
    s_waitcnt lgkmcnt(6)
    v_mfma_f32_16x16x32_bf16 v[192:195], v[48:51], a[112:115], v[192:195]
    ds_read_b64_tr_b16 v[36:37], v14 offset:36864
    s_mul_i32 s40, s12, 1327104
    v_mfma_f32_16x16x32_bf16 v[208:211], v[52:55], a[112:115], v[208:211]
    ds_read_b64_tr_b16 v[38:39], v14 offset:37376
    s_add_u32 m0, s44, 4096
    v_mfma_f32_16x16x32_bf16 v[212:215], v[52:55], a[116:119], v[212:215]
    buffer_load_dwordx4 v3, s[32:35], s43 offen  lds
    v_mfma_f32_16x16x32_bf16 v[196:199], v[48:51], a[116:119], v[196:199]
    s_add_u32 s43, s43, 294912
    s_add_u32 s16, s68, s40
    s_addc_u32 s17, s69, 0
    v_mfma_f32_16x16x32_bf16 v[200:203], v[48:51], a[120:123], v[200:203]
    ds_read_b64_tr_b16 v[40:41], v15 offset:32768
    s_sub_u32 s18, 5308416, s40
    v_mfma_f32_16x16x32_bf16 v[216:219], v[52:55], a[120:123], v[216:219]
    ds_read_b64_tr_b16 v[42:43], v15 offset:33280
    s_add_u32 s20, s16, 663552
    s_addc_u32 s21, s17, 0
    v_mfma_f32_16x16x32_bf16 v[220:223], v[52:55], a[124:127], v[220:223]
    s_sub_u32 s22, s18, 663552
    s_mov_b32 s66, 589824
    v_mfma_f32_16x16x32_bf16 v[204:207], v[48:51], a[124:127], v[204:207]
    s_bfe_u32 s4, s2, 0x20004
    s_waitcnt lgkmcnt(6)
    v_mfma_f32_16x16x32_bf16 v[236:239], v[56:59], a[124:127], v[236:239]
    ds_read_b64_tr_b16 v[44:45], v15 offset:36864
    s_mul_i32 s4, s4, 8192
    v_mfma_f32_16x16x32_bf16 v[252:255], v[60:63], a[124:127], v[252:255]
    ds_read_b64_tr_b16 v[46:47], v15 offset:37376
    s_mov_b32 s41, s4
    v_mfma_f32_16x16x32_bf16 v[248:251], v[60:63], a[120:123], v[248:251]
    buffer_load_dword v20, v19, s[36:39], s46 offen
    v_mfma_f32_16x16x32_bf16 v[232:235], v[56:59], a[120:123], v[232:235]
    s_add_u32 s4, s41, 0
    s_cmp_ge_u32 s4, 36864
    s_cselect_b32 s61, 36864, 0
    v_mfma_f32_16x16x32_bf16 v[228:231], v[56:59], a[116:119], v[228:231]
    ds_read_b64_tr_b16 v[48:49], v16 offset:32768
    s_sub_u32 s4, s4, s61
    v_mfma_f32_16x16x32_bf16 v[244:247], v[60:63], a[116:119], v[244:247]
    ds_read_b64_tr_b16 v[50:51], v16 offset:33280
    s_add_u32 s5, s41, 4096
    v_mfma_f32_16x16x32_bf16 v[240:243], v[60:63], a[112:115], v[240:243]
    s_cmp_ge_u32 s5, 36864
    s_cselect_b32 s61, 36864, 0
    s_sub_u32 s5, s5, s61
    v_mfma_f32_16x16x32_bf16 v[224:227], v[56:59], a[112:115], v[224:227]
    s_add_u32 s6, s41, 8192
    s_waitcnt lgkmcnt(6)
    v_mfma_f32_16x16x32_bf16 v[128:131], v[32:35], a[128:131], v[128:131]
    ds_read_b64_tr_b16 v[52:53], v16 offset:36864
    s_cmp_ge_u32 s6, 36864
    s_cselect_b32 s61, 36864, 0
    v_mfma_f32_16x16x32_bf16 v[144:147], v[36:39], a[128:131], v[144:147]
    ds_read_b64_tr_b16 v[54:55], v16 offset:37376
    s_sub_u32 s6, s6, s61
    v_mfma_f32_16x16x32_bf16 v[148:151], v[36:39], a[132:135], v[148:151]
    s_add_u32 s7, s41, 12288
    s_cmp_ge_u32 s7, 36864
    s_cselect_b32 s61, 36864, 0
    v_mfma_f32_16x16x32_bf16 v[132:135], v[32:35], a[132:135], v[132:135]
    s_sub_u32 s7, s7, s61
    s_add_u32 s61, s14, 4
    v_mfma_f32_16x16x32_bf16 v[136:139], v[32:35], a[136:139], v[136:139]
    ds_read_b64_tr_b16 v[56:57], v17 offset:32768
    s_and_b32 s61, s61, 3
    v_mfma_f32_16x16x32_bf16 v[152:155], v[36:39], a[136:139], v[152:155]
    ds_read_b64_tr_b16 v[58:59], v17 offset:33280
    s_lshl_b32 s61, s61, 12
    v_mfma_f32_16x16x32_bf16 v[156:159], v[36:39], a[140:143], v[156:159]
    s_add_u32 s61, s61, s41
    s_add_u32 s8, s61, 16384
    v_mfma_f32_16x16x32_bf16 v[140:143], v[32:35], a[140:143], v[140:143]
    s_cmp_ge_u32 s8, 36864
    s_cselect_b32 s61, 36864, 0
    s_waitcnt lgkmcnt(6)
    v_mfma_f32_16x16x32_bf16 v[172:175], v[40:43], a[140:143], v[172:175]
    ds_read_b64_tr_b16 v[60:61], v17 offset:36864
    s_sub_u32 s8, s8, s61
    v_mfma_f32_16x16x32_bf16 v[188:191], v[44:47], a[140:143], v[188:191]
    ds_read_b64_tr_b16 v[62:63], v17 offset:37376
    s_add_u32 s61, s14, 5
    v_mfma_f32_16x16x32_bf16 v[184:187], v[44:47], a[136:139], v[184:187]
    s_and_b32 s61, s61, 3
    s_lshl_b32 s61, s61, 12
    v_mfma_f32_16x16x32_bf16 v[168:171], v[40:43], a[136:139], v[168:171]
    s_add_u32 s61, s61, s41
    s_add_u32 s9, s61, 16384
    v_mfma_f32_16x16x32_bf16 v[164:167], v[40:43], a[132:135], v[164:167]
    ds_read_b64_tr_b16 v[32:33], v14 offset:40960
    s_cmp_ge_u32 s9, 36864
    s_cselect_b32 s61, 36864, 0
    v_mfma_f32_16x16x32_bf16 v[180:183], v[44:47], a[132:135], v[180:183]
    ds_read_b64_tr_b16 v[34:35], v14 offset:41472
    s_sub_u32 s9, s9, s61
    v_mfma_f32_16x16x32_bf16 v[176:179], v[44:47], a[128:131], v[176:179]
    s_add_u32 s61, s14, 6
    s_and_b32 s61, s61, 3
    v_mfma_f32_16x16x32_bf16 v[160:163], v[40:43], a[128:131], v[160:163]
    s_lshl_b32 s61, s61, 12
    s_waitcnt lgkmcnt(6)
    v_mfma_f32_16x16x32_bf16 v[192:195], v[48:51], a[128:131], v[192:195]
    ds_read_b64_tr_b16 v[36:37], v14 offset:45056
    s_add_u32 s61, s61, s41
    v_mfma_f32_16x16x32_bf16 v[208:211], v[52:55], a[128:131], v[208:211]
    ds_read_b64_tr_b16 v[38:39], v14 offset:45568
    s_add_u32 s76, s61, 16384
    v_mfma_f32_16x16x32_bf16 v[212:215], v[52:55], a[132:135], v[212:215]
    s_cmp_ge_u32 s76, 36864
    s_cselect_b32 s61, 36864, 0
    s_sub_u32 s76, s76, s61
    v_mfma_f32_16x16x32_bf16 v[196:199], v[48:51], a[132:135], v[196:199]
    s_add_u32 s61, s14, 7
    s_and_b32 s61, s61, 3
    v_mfma_f32_16x16x32_bf16 v[200:203], v[48:51], a[136:139], v[200:203]
    ds_read_b64_tr_b16 v[40:41], v15 offset:40960
    s_lshl_b32 s61, s61, 12
    v_mfma_f32_16x16x32_bf16 v[216:219], v[52:55], a[136:139], v[216:219]
    ds_read_b64_tr_b16 v[42:43], v15 offset:41472
    s_add_u32 m0, s44, 5120
    v_mfma_f32_16x16x32_bf16 v[220:223], v[52:55], a[140:143], v[220:223]
    buffer_load_dwordx4 v3, s[32:35], s43 offen  lds
    v_mfma_f32_16x16x32_bf16 v[204:207], v[48:51], a[140:143], v[204:207]
    s_add_u32 s43, s43, 294912
    s_waitcnt lgkmcnt(6)
    v_mfma_f32_16x16x32_bf16 v[236:239], v[56:59], a[140:143], v[236:239]
    ds_read_b64_tr_b16 v[44:45], v15 offset:45056
    s_add_u32 s61, s61, s41
    v_mfma_f32_16x16x32_bf16 v[252:255], v[60:63], a[140:143], v[252:255]
    ds_read_b64_tr_b16 v[46:47], v15 offset:45568
    s_add_u32 s77, s61, 16384
    v_mfma_f32_16x16x32_bf16 v[248:251], v[60:63], a[136:139], v[248:251]
    s_cmp_ge_u32 s77, 36864
    s_cselect_b32 s61, 36864, 0
    s_sub_u32 s77, s77, s61
    v_mfma_f32_16x16x32_bf16 v[232:235], v[56:59], a[136:139], v[232:235]
    s_add_u32 s78, s41, 32768
    s_cmp_ge_u32 s78, 36864
    s_cselect_b32 s61, 36864, 0
    v_mfma_f32_16x16x32_bf16 v[228:231], v[56:59], a[132:135], v[228:231]
    ds_read_b64_tr_b16 v[48:49], v16 offset:40960
    s_sub_u32 s78, s78, s61
    v_mfma_f32_16x16x32_bf16 v[244:247], v[60:63], a[132:135], v[244:247]
    ds_read_b64_tr_b16 v[50:51], v16 offset:41472
    v_lshrrev_b32 v5, 2, v0
    v_mfma_f32_16x16x32_bf16 v[240:243], v[60:63], a[128:131], v[240:243]
    v_mul_u32_u24 v5, 1152, v5
    v_bfe_u32 v6, v0, 5, 1
    v_mfma_f32_16x16x32_bf16 v[224:227], v[56:59], a[128:131], v[224:227]
    v_lshlrev_b32 v6, 1, v6
    s_waitcnt lgkmcnt(6)
    v_mfma_f32_16x16x32_bf16 v[128:131], v[32:35], a[144:147], v[128:131]
    ds_read_b64_tr_b16 v[52:53], v16 offset:45056
    v_and_b32 v7, 3, v0
    v_mfma_f32_16x16x32_bf16 v[144:147], v[36:39], a[144:147], v[144:147]
    ds_read_b64_tr_b16 v[54:55], v16 offset:45568
    v_xor_b32 v6, v6, v7
    v_mfma_f32_16x16x32_bf16 v[148:151], v[36:39], a[148:151], v[148:151]
    v_lshl_add_u32 v9, v6, 4, v5
    s_lshl_b32 s15, s14, 8
    v_mfma_f32_16x16x32_bf16 v[132:135], v[32:35], a[148:151], v[132:135]
    s_xor_b32 s41, s12, 0
    s_lshl_b32 s41, s41, 6
    v_mfma_f32_16x16x32_bf16 v[136:139], v[32:35], a[152:155], v[136:139]
    ds_read_b64_tr_b16 v[56:57], v17 offset:40960
    s_add_u32 s41, s41, s15
    v_mfma_f32_16x16x32_bf16 v[152:155], v[36:39], a[152:155], v[152:155]
    ds_read_b64_tr_b16 v[58:59], v17 offset:41472
    v_add_u32 v5, s41, v9
    v_mfma_f32_16x16x32_bf16 v[156:159], v[36:39], a[156:159], v[156:159]
    s_xor_b32 s41, s12, 1
    s_lshl_b32 s41, s41, 6
    v_mfma_f32_16x16x32_bf16 v[140:143], v[32:35], a[156:159], v[140:143]
    s_add_u32 s41, s41, s15
    s_waitcnt lgkmcnt(6)
    v_mfma_f32_16x16x32_bf16 v[172:175], v[40:43], a[156:159], v[172:175]
    ds_read_b64_tr_b16 v[60:61], v17 offset:45056
    v_add_u32 v6, s41, v9
    v_mfma_f32_16x16x32_bf16 v[188:191], v[44:47], a[156:159], v[188:191]
    ds_read_b64_tr_b16 v[62:63], v17 offset:45568
    s_xor_b32 s41, s12, 2
    v_mfma_f32_16x16x32_bf16 v[184:187], v[44:47], a[152:155], v[184:187]
    s_waitcnt vmcnt(22)
    v_mfma_f32_16x16x32_bf16 v[168:171], v[40:43], a[152:155], v[168:171]
    s_lshl_b32 s41, s41, 6
    s_add_u32 s41, s41, s15
    s_waitcnt vmcnt(19)
    s_barrier
    v_mfma_f32_16x16x32_bf16 v[164:167], v[40:43], a[148:151], v[164:167]
    ds_read_b64_tr_b16 v[32:33], v10 offset:0
    v_add_u32 v7, s41, v9
    v_mfma_f32_16x16x32_bf16 v[180:183], v[44:47], a[148:151], v[180:183]
    ds_read_b64_tr_b16 v[34:35], v10 offset:512
    s_xor_b32 s41, s12, 3
    v_mfma_f32_16x16x32_bf16 v[176:179], v[44:47], a[144:147], v[176:179]
    buffer_store_dword v22, v21, s[72:75], 0 offen sc1
    v_mfma_f32_16x16x32_bf16 v[160:163], v[40:43], a[144:147], v[160:163]
    s_lshl_b32 s41, s41, 6
    s_waitcnt lgkmcnt(6)
    v_mfma_f32_16x16x32_bf16 v[192:195], v[48:51], a[144:147], v[192:195]
    ds_read_b64_tr_b16 v[36:37], v10 offset:4096
    s_add_u32 s41, s41, s15
    v_mfma_f32_16x16x32_bf16 v[208:211], v[52:55], a[144:147], v[208:211]
    ds_read_b64_tr_b16 v[38:39], v10 offset:4608
    v_add_u32 v8, s41, v9
    v_mfma_f32_16x16x32_bf16 v[212:215], v[52:55], a[148:151], v[212:215]
    s_lshr_b32 s41, s14, 1
    s_mul_i32 s41, s41, 72
    v_mfma_f32_16x16x32_bf16 v[196:199], v[48:51], a[148:151], v[196:199]
    s_mul_i32 s61, s12, 18
    s_add_u32 s41, s41, s61
    v_mfma_f32_16x16x32_bf16 v[200:203], v[48:51], a[152:155], v[200:203]
    ds_read_b64_tr_b16 v[40:41], v11 offset:0
    s_lshr_b32 s61, s3, 1
    v_mfma_f32_16x16x32_bf16 v[216:219], v[52:55], a[152:155], v[216:219]
    ds_read_b64_tr_b16 v[42:43], v11 offset:512
    s_mul_i32 s61, s61, 9
    v_mfma_f32_16x16x32_bf16 v[220:223], v[52:55], a[156:159], v[220:223]
    s_add_u32 s41, s41, s61
    s_lshl_b32 s41, s41, 2
    v_mfma_f32_16x16x32_bf16 v[204:207], v[48:51], a[156:159], v[204:207]
    s_and_b32 s61, s14, 1
    s_waitcnt lgkmcnt(6)
    v_mfma_f32_16x16x32_bf16 v[236:239], v[56:59], a[156:159], v[236:239]
    ds_read_b64_tr_b16 v[44:45], v11 offset:4096
    s_lshl_b32 s61, s61, 1
    v_mfma_f32_16x16x32_bf16 v[252:255], v[60:63], a[156:159], v[252:255]
    ds_read_b64_tr_b16 v[46:47], v11 offset:4608
    s_add_u32 m0, s44, 6144
    v_mfma_f32_16x16x32_bf16 v[248:251], v[60:63], a[152:155], v[248:251]
    buffer_load_dwordx4 v3, s[32:35], s43 offen  lds
    v_mfma_f32_16x16x32_bf16 v[232:235], v[56:59], a[152:155], v[232:235]
    s_add_u32 s43, s43, 294912
    s_add_u32 s41, s41, s61
    v_mfma_f32_16x16x32_bf16 v[228:231], v[56:59], a[148:151], v[228:231]
    ds_read_b64_tr_b16 v[48:49], v12 offset:0
    s_and_b32 s61, s3, 1
    v_mfma_f32_16x16x32_bf16 v[244:247], v[60:63], a[148:151], v[244:247]
    ds_read_b64_tr_b16 v[50:51], v12 offset:512
    s_add_u32 s41, s41, s61
    v_mfma_f32_16x16x32_bf16 v[240:243], v[60:63], a[144:147], v[240:243]
    s_lshl_b32 s41, s41, 10
    v_add_u32 v9, s41, v4
    v_mfma_f32_16x16x32_bf16 v[224:227], v[56:59], a[144:147], v[224:227]
    s_waitcnt lgkmcnt(6)
    v_mfma_f32_16x16x32_bf16 v[128:131], v[32:35], a[160:163], v[128:131]
    ds_read_b64_tr_b16 v[52:53], v12 offset:4096
    v_mfma_f32_16x16x32_bf16 v[144:147], v[36:39], a[160:163], v[144:147]
    ds_read_b64_tr_b16 v[54:55], v12 offset:4608
    v_mfma_f32_16x16x32_bf16 v[148:151], v[36:39], a[164:167], v[148:151]
    v_mfma_f32_16x16x32_bf16 v[132:135], v[32:35], a[164:167], v[132:135]
    v_mfma_f32_16x16x32_bf16 v[136:139], v[32:35], a[168:171], v[136:139]
    ds_read_b64_tr_b16 v[56:57], v13 offset:0
    v_mfma_f32_16x16x32_bf16 v[152:155], v[36:39], a[168:171], v[152:155]
    ds_read_b64_tr_b16 v[58:59], v13 offset:512
    v_mfma_f32_16x16x32_bf16 v[156:159], v[36:39], a[172:175], v[156:159]
    v_mfma_f32_16x16x32_bf16 v[140:143], v[32:35], a[172:175], v[140:143]
    s_waitcnt lgkmcnt(6)
    v_mfma_f32_16x16x32_bf16 v[172:175], v[40:43], a[172:175], v[172:175]
    ds_read_b64_tr_b16 v[60:61], v13 offset:4096
    v_mfma_f32_16x16x32_bf16 v[188:191], v[44:47], a[172:175], v[188:191]
    ds_read_b64_tr_b16 v[62:63], v13 offset:4608
    v_mfma_f32_16x16x32_bf16 v[184:187], v[44:47], a[168:171], v[184:187]
    v_mfma_f32_16x16x32_bf16 v[168:171], v[40:43], a[168:171], v[168:171]
    v_mfma_f32_16x16x32_bf16 v[164:167], v[40:43], a[164:167], v[164:167]
    ds_read_b64_tr_b16 v[32:33], v10 offset:8192
    v_mfma_f32_16x16x32_bf16 v[180:183], v[44:47], a[164:167], v[180:183]
    ds_read_b64_tr_b16 v[34:35], v10 offset:8704
    v_mfma_f32_16x16x32_bf16 v[176:179], v[44:47], a[160:163], v[176:179]
    v_mfma_f32_16x16x32_bf16 v[160:163], v[40:43], a[160:163], v[160:163]
    s_waitcnt lgkmcnt(6)
    v_mfma_f32_16x16x32_bf16 v[192:195], v[48:51], a[160:163], v[192:195]
    ds_read_b64_tr_b16 v[36:37], v10 offset:12288
    v_mfma_f32_16x16x32_bf16 v[208:211], v[52:55], a[160:163], v[208:211]
    ds_read_b64_tr_b16 v[38:39], v10 offset:12800
    v_mfma_f32_16x16x32_bf16 v[212:215], v[52:55], a[164:167], v[212:215]
    v_mfma_f32_16x16x32_bf16 v[196:199], v[48:51], a[164:167], v[196:199]
    v_mfma_f32_16x16x32_bf16 v[200:203], v[48:51], a[168:171], v[200:203]
    ds_read_b64_tr_b16 v[40:41], v11 offset:8192
    v_mfma_f32_16x16x32_bf16 v[216:219], v[52:55], a[168:171], v[216:219]
    ds_read_b64_tr_b16 v[42:43], v11 offset:8704
    v_mfma_f32_16x16x32_bf16 v[220:223], v[52:55], a[172:175], v[220:223]
    v_mfma_f32_16x16x32_bf16 v[204:207], v[48:51], a[172:175], v[204:207]
    s_waitcnt lgkmcnt(6)
    v_mfma_f32_16x16x32_bf16 v[236:239], v[56:59], a[172:175], v[236:239]
    ds_read_b64_tr_b16 v[44:45], v11 offset:12288
    v_mfma_f32_16x16x32_bf16 v[252:255], v[60:63], a[172:175], v[252:255]
    ds_read_b64_tr_b16 v[46:47], v11 offset:12800
    v_mfma_f32_16x16x32_bf16 v[248:251], v[60:63], a[168:171], v[248:251]
    v_mfma_f32_16x16x32_bf16 v[232:235], v[56:59], a[168:171], v[232:235]
    v_mfma_f32_16x16x32_bf16 v[228:231], v[56:59], a[164:167], v[228:231]
    ds_read_b64_tr_b16 v[48:49], v12 offset:8192
    v_mfma_f32_16x16x32_bf16 v[244:247], v[60:63], a[164:167], v[244:247]
    ds_read_b64_tr_b16 v[50:51], v12 offset:8704
    s_add_u32 m0, s44, 7168
    v_mfma_f32_16x16x32_bf16 v[240:243], v[60:63], a[160:163], v[240:243]
    buffer_load_dwordx4 v3, s[32:35], s43 offen  lds
    v_mfma_f32_16x16x32_bf16 v[224:227], v[56:59], a[160:163], v[224:227]
    s_add_u32 s43, s43, 294912
    s_waitcnt lgkmcnt(6)
    v_mfma_f32_16x16x32_bf16 v[128:131], v[32:35], a[176:179], v[128:131]
    ds_read_b64_tr_b16 v[52:53], v12 offset:12288
    v_mfma_f32_16x16x32_bf16 v[144:147], v[36:39], a[176:179], v[144:147]
    ds_read_b64_tr_b16 v[54:55], v12 offset:12800
    s_add_u32 m0, s42, 151552
    v_mfma_f32_16x16x32_bf16 v[148:151], v[36:39], a[180:183], v[148:151]
    buffer_load_dwordx4 v9, s[64:67], s4 offen lds
    v_mfma_f32_16x16x32_bf16 v[132:135], v[32:35], a[180:183], v[132:135]
    s_mul_i32 s40, s4, 18
    v_mfma_f32_16x16x32_bf16 v[136:139], v[32:35], a[184:187], v[136:139]
    ds_read_b64_tr_b16 v[56:57], v13 offset:8192
    v_mfma_f32_16x16x32_bf16 v[152:155], v[36:39], a[184:187], v[152:155]
    ds_read_b64_tr_b16 v[58:59], v13 offset:8704
    s_add_u32 m0, s42, 65536
    v_mfma_f32_16x16x32_bf16 v[156:159], v[36:39], a[188:191], v[156:159]
    buffer_load_dwordx4 v5, s[16:19], s40 offen lds
    v_mfma_f32_16x16x32_bf16 v[140:143], v[32:35], a[188:191], v[140:143]
    s_waitcnt lgkmcnt(6)
    v_mfma_f32_16x16x32_bf16 v[172:175], v[40:43], a[188:191], v[172:175]
    ds_read_b64_tr_b16 v[60:61], v13 offset:12288
    v_mfma_f32_16x16x32_bf16 v[188:191], v[44:47], a[188:191], v[188:191]
    ds_read_b64_tr_b16 v[62:63], v13 offset:12800
    s_add_u32 m0, s42, 69632
    v_mfma_f32_16x16x32_bf16 v[184:187], v[44:47], a[184:187], v[184:187]
    buffer_load_dwordx4 v6, s[16:19], s40 offen lds
    v_mfma_f32_16x16x32_bf16 v[168:171], v[40:43], a[184:187], v[168:171]
    s_waitcnt vmcnt(21)
    s_barrier
    v_mfma_f32_16x16x32_bf16 v[164:167], v[40:43], a[180:183], v[164:167]
    ds_read_b64_tr_b16 v[32:33], v10 offset:16384
    v_mfma_f32_16x16x32_bf16 v[180:183], v[44:47], a[180:183], v[180:183]
    ds_read_b64_tr_b16 v[34:35], v10 offset:16896
    s_add_u32 m0, s42, 73728
    v_mfma_f32_16x16x32_bf16 v[176:179], v[44:47], a[176:179], v[176:179]
    buffer_load_dwordx4 v7, s[16:19], s40 offen lds
    v_mfma_f32_16x16x32_bf16 v[160:163], v[40:43], a[176:179], v[160:163]
    s_waitcnt lgkmcnt(6)
    v_mfma_f32_16x16x32_bf16 v[192:195], v[48:51], a[176:179], v[192:195]
    ds_read_b64_tr_b16 v[36:37], v10 offset:20480
    v_mfma_f32_16x16x32_bf16 v[208:211], v[52:55], a[176:179], v[208:211]
    ds_read_b64_tr_b16 v[38:39], v10 offset:20992
    s_add_u32 m0, s42, 77824
    v_mfma_f32_16x16x32_bf16 v[212:215], v[52:55], a[180:183], v[212:215]
    buffer_load_dwordx4 v8, s[16:19], s40 offen lds
    v_mfma_f32_16x16x32_bf16 v[196:199], v[48:51], a[180:183], v[196:199]
    v_mfma_f32_16x16x32_bf16 v[200:203], v[48:51], a[184:187], v[200:203]
    ds_read_b64_tr_b16 v[40:41], v10 offset:24576
    v_mfma_f32_16x16x32_bf16 v[216:219], v[52:55], a[184:187], v[216:219]
    ds_read_b64_tr_b16 v[42:43], v10 offset:25088
    v_mfma_f32_16x16x32_bf16 v[220:223], v[52:55], a[188:191], v[220:223]
    v_mfma_f32_16x16x32_bf16 v[204:207], v[48:51], a[188:191], v[204:207]
    s_waitcnt lgkmcnt(6)
    v_mfma_f32_16x16x32_bf16 v[236:239], v[56:59], a[188:191], v[236:239]
    ds_read_b64_tr_b16 v[44:45], v10 offset:28672
    v_mfma_f32_16x16x32_bf16 v[252:255], v[60:63], a[188:191], v[252:255]
    ds_read_b64_tr_b16 v[46:47], v10 offset:29184
    v_mfma_f32_16x16x32_bf16 v[248:251], v[60:63], a[184:187], v[248:251]
    v_mfma_f32_16x16x32_bf16 v[232:235], v[56:59], a[184:187], v[232:235]
    s_waitcnt vmcnt(17)
    s_barrier
    v_mfma_f32_16x16x32_bf16 v[228:231], v[56:59], a[180:183], v[228:231]
    ds_read_b64_tr_b16 v[48:49], v10 offset:32768
    v_mfma_f32_16x16x32_bf16 v[244:247], v[60:63], a[180:183], v[244:247]
    ds_read_b64_tr_b16 v[50:51], v10 offset:33280
    v_mfma_f32_16x16x32_bf16 v[240:243], v[60:63], a[176:179], v[240:243]
    v_mfma_f32_16x16x32_bf16 v[224:227], v[56:59], a[176:179], v[224:227]
    s_waitcnt lgkmcnt(6)
    v_mfma_f32_16x16x32_bf16 v[128:131], v[32:35], a[192:195], v[128:131]
    ds_read_b64_tr_b16 v[52:53], v10 offset:36864
    v_mfma_f32_16x16x32_bf16 v[144:147], v[36:39], a[192:195], v[144:147]
    ds_read_b64_tr_b16 v[54:55], v10 offset:37376
    s_add_u32 m0, s44, 8192
    v_mfma_f32_16x16x32_bf16 v[148:151], v[36:39], a[196:199], v[148:151]
    buffer_load_dwordx4 v3, s[32:35], s43 offen  lds
    v_mfma_f32_16x16x32_bf16 v[132:135], v[32:35], a[196:199], v[132:135]
    s_add_u32 s43, s43, 294912
    v_mfma_f32_16x16x32_bf16 v[136:139], v[32:35], a[200:203], v[136:139]
    ds_read_b64_tr_b16 v[56:57], v10 offset:40960
    v_mfma_f32_16x16x32_bf16 v[152:155], v[36:39], a[200:203], v[152:155]
    ds_read_b64_tr_b16 v[58:59], v10 offset:41472
    v_mfma_f32_16x16x32_bf16 v[156:159], v[36:39], a[204:207], v[156:159]
    v_mfma_f32_16x16x32_bf16 v[140:143], v[32:35], a[204:207], v[140:143]
    s_waitcnt lgkmcnt(6)
    v_mfma_f32_16x16x32_bf16 v[140:143], v[40:43], a[220:223], v[140:143]
    ds_read_b64_tr_b16 v[60:61], v10 offset:45056
    v_mfma_f32_16x16x32_bf16 v[156:159], v[44:47], a[220:223], v[156:159]
    ds_read_b64_tr_b16 v[62:63], v10 offset:45568
    s_add_u32 m0, s42, 81920
    v_mfma_f32_16x16x32_bf16 v[152:155], v[44:47], a[216:219], v[152:155]
    buffer_load_dwordx4 v5, s[20:23], s40 offen lds
    v_mfma_f32_16x16x32_bf16 v[136:139], v[40:43], a[216:219], v[136:139]
    s_waitcnt vmcnt(15)
    s_barrier
    v_mfma_f32_16x16x32_bf16 v[132:135], v[40:43], a[212:215], v[132:135]
    ds_read_b64_tr_b16 v[32:33], v10 offset:49152
    v_mfma_f32_16x16x32_bf16 v[148:151], v[44:47], a[212:215], v[148:151]
    ds_read_b64_tr_b16 v[34:35], v10 offset:49664
    s_add_u32 m0, s42, 86016
    v_mfma_f32_16x16x32_bf16 v[144:147], v[44:47], a[208:211], v[144:147]
    buffer_load_dwordx4 v6, s[20:23], s40 offen lds
    v_mfma_f32_16x16x32_bf16 v[128:131], v[40:43], a[208:211], v[128:131]
    s_waitcnt lgkmcnt(6)
    v_mfma_f32_16x16x32_bf16 v[128:131], v[48:51], a[224:227], v[128:131]
    ds_read_b64_tr_b16 v[36:37], v10 offset:53248
    v_mfma_f32_16x16x32_bf16 v[144:147], v[52:55], a[224:227], v[144:147]
    ds_read_b64_tr_b16 v[38:39], v10 offset:53760
    s_add_u32 m0, s42, 90112
    v_mfma_f32_16x16x32_bf16 v[148:151], v[52:55], a[228:231], v[148:151]
    buffer_load_dwordx4 v7, s[20:23], s40 offen lds
    v_mfma_f32_16x16x32_bf16 v[132:135], v[48:51], a[228:231], v[132:135]
    v_mfma_f32_16x16x32_bf16 v[136:139], v[48:51], a[232:235], v[136:139]
    ds_read_b64_tr_b16 v[40:41], v10 offset:57344
    v_mfma_f32_16x16x32_bf16 v[152:155], v[52:55], a[232:235], v[152:155]
    ds_read_b64_tr_b16 v[42:43], v10 offset:57856
    s_add_u32 m0, s42, 94208
    v_mfma_f32_16x16x32_bf16 v[156:159], v[52:55], a[236:239], v[156:159]
    buffer_load_dwordx4 v8, s[20:23], s40 offen lds
    v_mfma_f32_16x16x32_bf16 v[140:143], v[48:51], a[236:239], v[140:143]
    s_waitcnt lgkmcnt(6)
    v_mfma_f32_16x16x32_bf16 v[140:143], v[56:59], a[252:255], v[140:143]
    ds_read_b64_tr_b16 v[44:45], v10 offset:61440
    v_mfma_f32_16x16x32_bf16 v[156:159], v[60:63], a[252:255], v[156:159]
    ds_read_b64_tr_b16 v[46:47], v10 offset:61952
    v_mfma_f32_16x16x32_bf16 v[152:155], v[60:63], a[248:251], v[152:155]
    v_mfma_f32_16x16x32_bf16 v[136:139], v[56:59], a[248:251], v[136:139]
    v_mfma_f32_16x16x32_bf16 v[132:135], v[56:59], a[244:247], v[132:135]
    ds_read_b64_tr_b16 v[48:49], v11 offset:16384
    v_mfma_f32_16x16x32_bf16 v[148:151], v[60:63], a[244:247], v[148:151]
    ds_read_b64_tr_b16 v[50:51], v11 offset:16896
    v_mfma_f32_16x16x32_bf16 v[144:147], v[60:63], a[240:243], v[144:147]
    v_mfma_f32_16x16x32_bf16 v[128:131], v[56:59], a[240:243], v[128:131]
    s_waitcnt lgkmcnt(6)
    v_mfma_f32_16x16x32_bf16 v[128:131], v[32:35], v[64:67], v[128:131]
    ds_read_b64_tr_b16 v[52:53], v11 offset:20480
    v_mfma_f32_16x16x32_bf16 v[144:147], v[36:39], v[64:67], v[144:147]
    ds_read_b64_tr_b16 v[54:55], v11 offset:20992
    v_mfma_f32_16x16x32_bf16 v[148:151], v[36:39], v[68:71], v[148:151]
    s_branch K4_ps7
K4_pg7:
    s_branch K4_vrA
K4_ps7:
    v_mfma_f32_16x16x32_bf16 v[132:135], v[32:35], v[68:71], v[132:135]
    v_mfma_f32_16x16x32_bf16 v[136:139], v[32:35], v[72:75], v[136:139]
    ds_read_b64_tr_b16 v[56:57], v11 offset:24576
    v_mfma_f32_16x16x32_bf16 v[152:155], v[36:39], v[72:75], v[152:155]
    ds_read_b64_tr_b16 v[58:59], v11 offset:25088
    v_mfma_f32_16x16x32_bf16 v[156:159], v[36:39], v[76:79], v[156:159]
    v_mfma_f32_16x16x32_bf16 v[140:143], v[32:35], v[76:79], v[140:143]
    s_waitcnt lgkmcnt(6)
    v_mfma_f32_16x16x32_bf16 v[140:143], v[40:43], v[92:95], v[140:143]
    ds_read_b64_tr_b16 v[60:61], v11 offset:28672
    s_mov_b32 s100, 73728
    v_mfma_f32_16x16x32_bf16 v[156:159], v[44:47], v[92:95], v[156:159]
    ds_read_b64_tr_b16 v[62:63], v11 offset:29184
    s_mov_b32 s101, 77824
    v_mfma_f32_16x16x32_bf16 v[152:155], v[44:47], v[88:91], v[152:155]
    buffer_load_dword v20, v19, s[36:39], s47 offen
    v_mfma_f32_16x16x32_bf16 v[136:139], v[40:43], v[88:91], v[136:139]
    v_lshrrev_b32 v2, 4, v1
    v_lshlrev_b32 v2, 9, v2
    v_mfma_f32_16x16x32_bf16 v[132:135], v[40:43], v[84:87], v[132:135]
    ds_read_b64_tr_b16 v[32:33], v11 offset:32768
    v_and_b32 v3, 15, v1
    v_mfma_f32_16x16x32_bf16 v[148:151], v[44:47], v[84:87], v[148:151]
    ds_read_b64_tr_b16 v[34:35], v11 offset:33280
    v_lshl_add_u32 v2, v3, 4, v2
    v_mfma_f32_16x16x32_bf16 v[144:147], v[44:47], v[80:83], v[144:147]
    s_lshl_b32 s41, s13, 2
    s_add_u32 s41, s41, s3
    v_mfma_f32_16x16x32_bf16 v[128:131], v[40:43], v[80:83], v[128:131]
    s_mul_i32 s41, s41, 288
    s_waitcnt lgkmcnt(6)
    v_mfma_f32_16x16x32_bf16 v[160:163], v[48:51], a[192:195], v[160:163]
    ds_read_b64_tr_b16 v[36:37], v11 offset:36864
    s_mul_i32 s61, s12, 72
    v_mfma_f32_16x16x32_bf16 v[176:179], v[52:55], a[192:195], v[176:179]
    ds_read_b64_tr_b16 v[38:39], v11 offset:37376
    s_add_u32 m0, s42, 155648
    v_mfma_f32_16x16x32_bf16 v[180:183], v[52:55], a[196:199], v[180:183]
    buffer_load_dwordx4 v9, s[64:67], s5 offen lds
    v_mfma_f32_16x16x32_bf16 v[164:167], v[48:51], a[196:199], v[164:167]
    s_mul_i32 s40, s5, 18
    s_add_u32 s41, s41, s61
    v_mfma_f32_16x16x32_bf16 v[168:171], v[48:51], a[200:203], v[168:171]
    ds_read_b64_tr_b16 v[40:41], v11 offset:40960
    s_lshl_b32 s41, s41, 10
    v_mfma_f32_16x16x32_bf16 v[184:187], v[52:55], a[200:203], v[184:187]
    ds_read_b64_tr_b16 v[42:43], v11 offset:41472
    s_add_u32 m0, s42, 98304
    v_mfma_f32_16x16x32_bf16 v[188:191], v[52:55], a[204:207], v[188:191]
    buffer_load_dwordx4 v5, s[16:19], s40 offen lds
    v_mfma_f32_16x16x32_bf16 v[172:175], v[48:51], a[204:207], v[172:175]
    v_add_u32 v2, s41, v2
    s_waitcnt lgkmcnt(6)
    v_mfma_f32_16x16x32_bf16 v[172:175], v[56:59], a[220:223], v[172:175]
    ds_read_b64_tr_b16 v[44:45], v11 offset:45056
    v_add_u32 v3, 36864, v2
    v_mfma_f32_16x16x32_bf16 v[188:191], v[60:63], a[220:223], v[188:191]
    ds_read_b64_tr_b16 v[46:47], v11 offset:45568
    s_add_u32 m0, s42, 102400
    v_mfma_f32_16x16x32_bf16 v[184:187], v[60:63], a[216:219], v[184:187]
    buffer_load_dwordx4 v6, s[16:19], s40 offen lds
    v_mfma_f32_16x16x32_bf16 v[168:171], v[56:59], a[216:219], v[168:171]
    v_lshrrev_b32 v24, 5, v1
    v_lshlrev_b32 v24, 10, v24
    v_mfma_f32_16x16x32_bf16 v[164:167], v[56:59], a[212:215], v[164:167]
    ds_read_b64_tr_b16 v[48:49], v11 offset:49152
    v_bfe_u32 v25, v1, 4, 1
    v_mfma_f32_16x16x32_bf16 v[180:183], v[60:63], a[212:215], v[180:183]
    ds_read_b64_tr_b16 v[50:51], v11 offset:49664
    s_add_u32 m0, s42, 106496
    v_mfma_f32_16x16x32_bf16 v[176:179], v[60:63], a[208:211], v[176:179]
    buffer_load_dwordx4 v7, s[16:19], s40 offen lds
    v_mfma_f32_16x16x32_bf16 v[160:163], v[56:59], a[208:211], v[160:163]
    v_mul_u32_u24 v25, 544, v25
    s_waitcnt lgkmcnt(6)
    v_mfma_f32_16x16x32_bf16 v[160:163], v[32:35], a[224:227], v[160:163]
    ds_read_b64_tr_b16 v[52:53], v11 offset:53248
    v_add_u32 v24, v24, v25
    v_mfma_f32_16x16x32_bf16 v[176:179], v[36:39], a[224:227], v[176:179]
    ds_read_b64_tr_b16 v[54:55], v11 offset:53760
    s_add_u32 m0, s42, 110592
    v_mfma_f32_16x16x32_bf16 v[180:183], v[36:39], a[228:231], v[180:183]
    buffer_load_dwordx4 v8, s[16:19], s40 offen lds
    v_mfma_f32_16x16x32_bf16 v[164:167], v[32:35], a[228:231], v[164:167]
    v_bfe_u32 v25, v1, 2, 2
    v_lshl_add_u32 v24, v25, 6, v24
    v_mfma_f32_16x16x32_bf16 v[168:171], v[32:35], a[232:235], v[168:171]
    ds_read_b64_tr_b16 v[56:57], v11 offset:57344
    v_and_b32 v25, 3, v1
    v_mfma_f32_16x16x32_bf16 v[184:187], v[36:39], a[232:235], v[184:187]
    ds_read_b64_tr_b16 v[58:59], v11 offset:57856
    v_lshl_add_u32 v24, v25, 3, v24
    v_mfma_f32_16x16x32_bf16 v[188:191], v[36:39], a[236:239], v[188:191]
    buffer_load_dword v19, v30, s[72:75], 0 offen sc1
    v_mfma_f32_16x16x32_bf16 v[172:175], v[32:35], a[236:239], v[172:175]
    v_xor_b32 v25, 32, v24
    s_waitcnt lgkmcnt(6)
    v_mfma_f32_16x16x32_bf16 v[172:175], v[40:43], a[252:255], v[172:175]
    ds_read_b64_tr_b16 v[60:61], v11 offset:61440
    v_add_u32 v26, 65536, v24
    v_mfma_f32_16x16x32_bf16 v[188:191], v[44:47], a[252:255], v[188:191]
    ds_read_b64_tr_b16 v[62:63], v11 offset:61952
    v_add_u32 v27, 65536, v25
    v_mfma_f32_16x16x32_bf16 v[184:187], v[44:47], a[248:251], v[184:187]
    v_add_u32 v28, 131072, v24
    v_max_f32 v128, 0, v128
    v_mfma_f32_16x16x32_bf16 v[168:171], v[40:43], a[248:251], v[168:171]
    v_max_f32 v129, 0, v129
    v_max_f32 v130, 0, v130
    v_mfma_f32_16x16x32_bf16 v[164:167], v[40:43], a[244:247], v[164:167]
    ds_read_b64_tr_b16 v[32:33], v12 offset:16384
    v_max_f32 v131, 0, v131
    v_mfma_f32_16x16x32_bf16 v[180:183], v[44:47], a[244:247], v[180:183]
    ds_read_b64_tr_b16 v[34:35], v12 offset:16896
    v_mul_f32 v128, v128, v144
    v_mfma_f32_16x16x32_bf16 v[176:179], v[44:47], a[240:243], v[176:179]
    v_mul_f32 v129, v129, v145
    v_mul_f32 v130, v130, v146
    v_mfma_f32_16x16x32_bf16 v[160:163], v[40:43], a[240:243], v[160:163]
    v_mul_f32 v131, v131, v147
    s_waitcnt lgkmcnt(6)
    v_mfma_f32_16x16x32_bf16 v[160:163], v[48:51], v[64:67], v[160:163]
    ds_read_b64_tr_b16 v[36:37], v12 offset:20480
    v_cvt_pk_bf16_f32 v96, v128, v129
    v_mfma_f32_16x16x32_bf16 v[176:179], v[52:55], v[64:67], v[176:179]
    ds_read_b64_tr_b16 v[38:39], v12 offset:20992
    v_cvt_pk_bf16_f32 v97, v130, v131
    v_mfma_f32_16x16x32_bf16 v[180:183], v[52:55], v[68:71], v[180:183]
    v_max_f32 v132, 0, v132
    v_max_f32 v133, 0, v133
    v_mfma_f32_16x16x32_bf16 v[164:167], v[48:51], v[68:71], v[164:167]
    v_max_f32 v134, 0, v134
    v_max_f32 v135, 0, v135
    v_mfma_f32_16x16x32_bf16 v[168:171], v[48:51], v[72:75], v[168:171]
    ds_read_b64_tr_b16 v[40:41], v12 offset:24576
    v_mul_f32 v132, v132, v148
    v_mfma_f32_16x16x32_bf16 v[184:187], v[52:55], v[72:75], v[184:187]
    ds_read_b64_tr_b16 v[42:43], v12 offset:25088
    v_mul_f32 v133, v133, v149
    v_mfma_f32_16x16x32_bf16 v[188:191], v[52:55], v[76:79], v[188:191]
    v_mul_f32 v134, v134, v150
    v_mul_f32 v135, v135, v151
    v_mfma_f32_16x16x32_bf16 v[172:175], v[48:51], v[76:79], v[172:175]
    v_cvt_pk_bf16_f32 v98, v132, v133
    s_waitcnt lgkmcnt(6)
    v_mfma_f32_16x16x32_bf16 v[172:175], v[56:59], v[92:95], v[172:175]
    ds_read_b64_tr_b16 v[44:45], v12 offset:28672
    v_cvt_pk_bf16_f32 v99, v134, v135
    v_mfma_f32_16x16x32_bf16 v[188:191], v[60:63], v[92:95], v[188:191]
    ds_read_b64_tr_b16 v[46:47], v12 offset:29184
    s_add_u32 m0, s42, 0
    v_mfma_f32_16x16x32_bf16 v[184:187], v[60:63], v[88:91], v[184:187]
    buffer_load_dwordx4 v5, s[20:23], s40 offen lds
    v_mfma_f32_16x16x32_bf16 v[168:171], v[56:59], v[88:91], v[168:171]
    v_mfma_f32_16x16x32_bf16 v[164:167], v[56:59], v[84:87], v[164:167]
    ds_read_b64_tr_b16 v[48:49], v12 offset:32768
    v_permlane16_swap_b32 v96, v98
    v_mfma_f32_16x16x32_bf16 v[180:183], v[60:63], v[84:87], v[180:183]
    ds_read_b64_tr_b16 v[50:51], v12 offset:33280
    s_add_u32 m0, s42, 4096
    v_mfma_f32_16x16x32_bf16 v[176:179], v[60:63], v[80:83], v[176:179]
    buffer_load_dwordx4 v6, s[20:23], s40 offen lds
    v_mfma_f32_16x16x32_bf16 v[160:163], v[56:59], v[80:83], v[160:163]
    v_permlane16_swap_b32 v97, v99
    s_waitcnt lgkmcnt(6)
    v_mfma_f32_16x16x32_bf16 v[192:195], v[32:35], a[192:195], v[192:195]
    ds_read_b64_tr_b16 v[52:53], v12 offset:36864
    v_max_f32 v136, 0, v136
    v_mfma_f32_16x16x32_bf16 v[208:211], v[36:39], a[192:195], v[208:211]
    ds_read_b64_tr_b16 v[54:55], v12 offset:37376
    v_max_f32 v137, 0, v137
    v_mfma_f32_16x16x32_bf16 v[212:215], v[36:39], a[196:199], v[212:215]
    buffer_store_dwordx4 v[96:99], v4, s[28:31], s52 offen offset:0 sc1
    v_mfma_f32_16x16x32_bf16 v[196:199], v[32:35], a[196:199], v[196:199]
    v_max_f32 v138, 0, v138
    v_max_f32 v139, 0, v139
    v_mfma_f32_16x16x32_bf16 v[200:203], v[32:35], a[200:203], v[200:203]
    ds_read_b64_tr_b16 v[56:57], v12 offset:40960
    v_mul_f32 v136, v136, v152
    v_mfma_f32_16x16x32_bf16 v[216:219], v[36:39], a[200:203], v[216:219]
    ds_read_b64_tr_b16 v[58:59], v12 offset:41472
    s_add_u32 m0, s42, 8192
    v_mfma_f32_16x16x32_bf16 v[220:223], v[36:39], a[204:207], v[220:223]
    buffer_load_dwordx4 v7, s[20:23], s40 offen lds
    v_mfma_f32_16x16x32_bf16 v[204:207], v[32:35], a[204:207], v[204:207]
    v_mul_f32 v137, v137, v153
    s_waitcnt lgkmcnt(6)
    v_mfma_f32_16x16x32_bf16 v[204:207], v[40:43], a[220:223], v[204:207]
    ds_read_b64_tr_b16 v[60:61], v12 offset:45056
    v_mul_f32 v138, v138, v154
    v_mfma_f32_16x16x32_bf16 v[220:223], v[44:47], a[220:223], v[220:223]
    ds_read_b64_tr_b16 v[62:63], v12 offset:45568
    s_add_u32 m0, s42, 12288
    v_mfma_f32_16x16x32_bf16 v[216:219], v[44:47], a[216:219], v[216:219]
    buffer_load_dwordx4 v8, s[20:23], s40 offen lds
    v_mfma_f32_16x16x32_bf16 v[200:203], v[40:43], a[216:219], v[200:203]
    v_mul_f32 v139, v139, v155
    v_cvt_pk_bf16_f32 v100, v136, v137
    v_mfma_f32_16x16x32_bf16 v[196:199], v[40:43], a[212:215], v[196:199]
    ds_read_b64_tr_b16 v[32:33], v12 offset:49152
    v_cvt_pk_bf16_f32 v101, v138, v139
    v_mfma_f32_16x16x32_bf16 v[212:215], v[44:47], a[212:215], v[212:215]
    ds_read_b64_tr_b16 v[34:35], v12 offset:49664
    v_max_f32 v140, 0, v140
    v_mfma_f32_16x16x32_bf16 v[208:211], v[44:47], a[208:211], v[208:211]
    v_max_f32 v141, 0, v141
    v_max_f32 v142, 0, v142
    v_mfma_f32_16x16x32_bf16 v[192:195], v[40:43], a[208:211], v[192:195]
    v_max_f32 v143, 0, v143
    s_waitcnt lgkmcnt(6)
    v_mfma_f32_16x16x32_bf16 v[192:195], v[48:51], a[224:227], v[192:195]
    ds_read_b64_tr_b16 v[36:37], v12 offset:53248
    v_mul_f32 v140, v140, v156
    v_mfma_f32_16x16x32_bf16 v[208:211], v[52:55], a[224:227], v[208:211]
    ds_read_b64_tr_b16 v[38:39], v12 offset:53760
    v_mul_f32 v141, v141, v157
    v_mfma_f32_16x16x32_bf16 v[212:215], v[52:55], a[228:231], v[212:215]
    v_mul_f32 v142, v142, v158
    v_mul_f32 v143, v143, v159
    v_mfma_f32_16x16x32_bf16 v[196:199], v[48:51], a[228:231], v[196:199]
    v_cvt_pk_bf16_f32 v102, v140, v141
    v_cvt_pk_bf16_f32 v103, v142, v143
    v_mfma_f32_16x16x32_bf16 v[200:203], v[48:51], a[232:235], v[200:203]
    ds_read_b64_tr_b16 v[40:41], v12 offset:57344
    v_mfma_f32_16x16x32_bf16 v[216:219], v[52:55], a[232:235], v[216:219]
    ds_read_b64_tr_b16 v[42:43], v12 offset:57856
    v_permlane16_swap_b32 v100, v102
    v_mfma_f32_16x16x32_bf16 v[220:223], v[52:55], a[236:239], v[220:223]
    v_permlane16_swap_b32 v101, v103
    v_max_f32 v160, 0, v160
    v_mfma_f32_16x16x32_bf16 v[204:207], v[48:51], a[236:239], v[204:207]
    v_max_f32 v161, 0, v161
    s_waitcnt lgkmcnt(6)
    v_mfma_f32_16x16x32_bf16 v[204:207], v[56:59], a[252:255], v[204:207]
    ds_read_b64_tr_b16 v[44:45], v12 offset:61440
    v_max_f32 v162, 0, v162
    v_mfma_f32_16x16x32_bf16 v[220:223], v[60:63], a[252:255], v[220:223]
    ds_read_b64_tr_b16 v[46:47], v12 offset:61952
    v_max_f32 v163, 0, v163
    v_mfma_f32_16x16x32_bf16 v[216:219], v[60:63], a[248:251], v[216:219]
    buffer_store_dwordx4 v[100:103], v4, s[28:31], s53 offen offset:0 sc1
    v_mfma_f32_16x16x32_bf16 v[200:203], v[56:59], a[248:251], v[200:203]
    v_mul_f32 v160, v160, v176
    v_mul_f32 v161, v161, v177
    v_mfma_f32_16x16x32_bf16 v[196:199], v[56:59], a[244:247], v[196:199]
    ds_read_b64_tr_b16 v[48:49], v13 offset:16384
    v_mul_f32 v162, v162, v178
    v_mfma_f32_16x16x32_bf16 v[212:215], v[60:63], a[244:247], v[212:215]
    ds_read_b64_tr_b16 v[50:51], v13 offset:16896
    v_mul_f32 v163, v163, v179
    v_mfma_f32_16x16x32_bf16 v[208:211], v[60:63], a[240:243], v[208:211]
    v_cvt_pk_bf16_f32 v104, v160, v161
    v_cvt_pk_bf16_f32 v105, v162, v163
    v_mfma_f32_16x16x32_bf16 v[192:195], v[56:59], a[240:243], v[192:195]
    v_max_f32 v164, 0, v164
    s_waitcnt lgkmcnt(6)
    v_mfma_f32_16x16x32_bf16 v[192:195], v[32:35], v[64:67], v[192:195]
    ds_read_b64_tr_b16 v[52:53], v13 offset:20480
    v_max_f32 v165, 0, v165
    v_mfma_f32_16x16x32_bf16 v[208:211], v[36:39], v[64:67], v[208:211]
    ds_read_b64_tr_b16 v[54:55], v13 offset:20992
    s_add_u32 m0, s42, 159744
    v_mfma_f32_16x16x32_bf16 v[212:215], v[36:39], v[68:71], v[212:215]
    buffer_load_dwordx4 v9, s[64:67], s6 offen lds
    v_mfma_f32_16x16x32_bf16 v[196:199], v[32:35], v[68:71], v[196:199]
    s_mul_i32 s40, s6, 18
    v_max_f32 v166, 0, v166
    v_mfma_f32_16x16x32_bf16 v[200:203], v[32:35], v[72:75], v[200:203]
    ds_read_b64_tr_b16 v[56:57], v13 offset:24576
    v_max_f32 v167, 0, v167
    v_mfma_f32_16x16x32_bf16 v[216:219], v[36:39], v[72:75], v[216:219]
    ds_read_b64_tr_b16 v[58:59], v13 offset:25088
    v_mul_f32 v164, v164, v180
    v_mfma_f32_16x16x32_bf16 v[220:223], v[36:39], v[76:79], v[220:223]
    v_mul_f32 v165, v165, v181
    v_mul_f32 v166, v166, v182
    v_mfma_f32_16x16x32_bf16 v[204:207], v[32:35], v[76:79], v[204:207]
    v_mul_f32 v167, v167, v183
    s_waitcnt lgkmcnt(6)
    v_mfma_f32_16x16x32_bf16 v[204:207], v[40:43], v[92:95], v[204:207]
    ds_read_b64_tr_b16 v[60:61], v13 offset:28672
    v_cvt_pk_bf16_f32 v106, v164, v165
    v_mfma_f32_16x16x32_bf16 v[220:223], v[44:47], v[92:95], v[220:223]
    ds_read_b64_tr_b16 v[62:63], v13 offset:29184
    v_cvt_pk_bf16_f32 v107, v166, v167
    v_mfma_f32_16x16x32_bf16 v[216:219], v[44:47], v[88:91], v[216:219]
    v_mfma_f32_16x16x32_bf16 v[200:203], v[40:43], v[88:91], v[200:203]
    v_mfma_f32_16x16x32_bf16 v[196:199], v[40:43], v[84:87], v[196:199]
    ds_read_b64_tr_b16 v[32:33], v13 offset:32768
    v_permlane16_swap_b32 v104, v106
    v_mfma_f32_16x16x32_bf16 v[212:215], v[44:47], v[84:87], v[212:215]
    ds_read_b64_tr_b16 v[34:35], v13 offset:33280
    v_permlane16_swap_b32 v105, v107
    v_mfma_f32_16x16x32_bf16 v[208:211], v[44:47], v[80:83], v[208:211]
    buffer_store_dwordx4 v[104:107], v4, s[28:31], s52 offen offset:1024 sc1
    v_mfma_f32_16x16x32_bf16 v[192:195], v[40:43], v[80:83], v[192:195]
    v_max_f32 v168, 0, v168
    s_waitcnt lgkmcnt(6)
    v_mfma_f32_16x16x32_bf16 v[224:227], v[48:51], a[192:195], v[224:227]
    ds_read_b64_tr_b16 v[36:37], v13 offset:36864
    v_max_f32 v169, 0, v169
    v_mfma_f32_16x16x32_bf16 v[240:243], v[52:55], a[192:195], v[240:243]
    ds_read_b64_tr_b16 v[38:39], v13 offset:37376
    v_max_f32 v170, 0, v170
    v_mfma_f32_16x16x32_bf16 v[244:247], v[52:55], a[196:199], v[244:247]
    v_max_f32 v171, 0, v171
    v_mul_f32 v168, v168, v184
    v_mfma_f32_16x16x32_bf16 v[228:231], v[48:51], a[196:199], v[228:231]
    v_mul_f32 v169, v169, v185
    v_mul_f32 v170, v170, v186
    v_mfma_f32_16x16x32_bf16 v[232:235], v[48:51], a[200:203], v[232:235]
    ds_read_b64_tr_b16 v[40:41], v13 offset:40960
    v_mul_f32 v171, v171, v187
    v_mfma_f32_16x16x32_bf16 v[248:251], v[52:55], a[200:203], v[248:251]
    ds_read_b64_tr_b16 v[42:43], v13 offset:41472
    v_cvt_pk_bf16_f32 v108, v168, v169
    v_mfma_f32_16x16x32_bf16 v[252:255], v[52:55], a[204:207], v[252:255]
    v_cvt_pk_bf16_f32 v109, v170, v171
    v_max_f32 v172, 0, v172
    v_mfma_f32_16x16x32_bf16 v[236:239], v[48:51], a[204:207], v[236:239]
    v_max_f32 v173, 0, v173
    s_waitcnt lgkmcnt(6)
    v_mfma_f32_16x16x32_bf16 v[236:239], v[56:59], a[220:223], v[236:239]
    ds_read_b64_tr_b16 v[44:45], v13 offset:45056
    v_max_f32 v174, 0, v174
    v_mfma_f32_16x16x32_bf16 v[252:255], v[60:63], a[220:223], v[252:255]
    ds_read_b64_tr_b16 v[46:47], v13 offset:45568
    v_max_f32 v175, 0, v175
    v_mfma_f32_16x16x32_bf16 v[248:251], v[60:63], a[216:219], v[248:251]
    v_mul_f32 v172, v172, v188
    v_mul_f32 v173, v173, v189
    v_mfma_f32_16x16x32_bf16 v[232:235], v[56:59], a[216:219], v[232:235]
    v_mul_f32 v174, v174, v190
    v_mul_f32 v175, v175, v191
    v_mfma_f32_16x16x32_bf16 v[228:231], v[56:59], a[212:215], v[228:231]
    ds_read_b64_tr_b16 v[48:49], v13 offset:49152
    v_cvt_pk_bf16_f32 v110, v172, v173
    v_mfma_f32_16x16x32_bf16 v[244:247], v[60:63], a[212:215], v[244:247]
    ds_read_b64_tr_b16 v[50:51], v13 offset:49664
    v_cvt_pk_bf16_f32 v111, v174, v175
    v_mfma_f32_16x16x32_bf16 v[240:243], v[60:63], a[208:211], v[240:243]
    v_mfma_f32_16x16x32_bf16 v[224:227], v[56:59], a[208:211], v[224:227]
    s_waitcnt lgkmcnt(6)
    v_mfma_f32_16x16x32_bf16 v[224:227], v[32:35], a[224:227], v[224:227]
    ds_read_b64_tr_b16 v[52:53], v13 offset:53248
    v_permlane16_swap_b32 v108, v110
    v_mfma_f32_16x16x32_bf16 v[240:243], v[36:39], a[224:227], v[240:243]
    ds_read_b64_tr_b16 v[54:55], v13 offset:53760
    v_permlane16_swap_b32 v109, v111
    v_mfma_f32_16x16x32_bf16 v[244:247], v[36:39], a[228:231], v[244:247]
    buffer_store_dwordx4 v[108:111], v4, s[28:31], s53 offen offset:1024 sc1
    v_mfma_f32_16x16x32_bf16 v[228:231], v[32:35], a[228:231], v[228:231]
    v_max_f32 v192, 0, v192
    v_max_f32 v193, 0, v193
    v_mfma_f32_16x16x32_bf16 v[232:235], v[32:35], a[232:235], v[232:235]
    ds_read_b64_tr_b16 v[56:57], v13 offset:57344
    v_max_f32 v194, 0, v194
    v_mfma_f32_16x16x32_bf16 v[248:251], v[36:39], a[232:235], v[248:251]
    ds_read_b64_tr_b16 v[58:59], v13 offset:57856
    v_max_f32 v195, 0, v195
    v_mfma_f32_16x16x32_bf16 v[252:255], v[36:39], a[236:239], v[252:255]
    v_mul_f32 v192, v192, v208
    v_mul_f32 v193, v193, v209
    v_mfma_f32_16x16x32_bf16 v[236:239], v[32:35], a[236:239], v[236:239]
    v_mul_f32 v194, v194, v210
    s_waitcnt lgkmcnt(6)
    v_mfma_f32_16x16x32_bf16 v[236:239], v[40:43], a[252:255], v[236:239]
    ds_read_b64_tr_b16 v[60:61], v13 offset:61440
    v_mul_f32 v195, v195, v211
    v_mfma_f32_16x16x32_bf16 v[252:255], v[44:47], a[252:255], v[252:255]
    ds_read_b64_tr_b16 v[62:63], v13 offset:61952
    v_cvt_pk_bf16_f32 v112, v192, v193
    v_mfma_f32_16x16x32_bf16 v[248:251], v[44:47], a[248:251], v[248:251]
    v_cvt_pk_bf16_f32 v113, v194, v195
    v_max_f32 v196, 0, v196
    v_mfma_f32_16x16x32_bf16 v[232:235], v[40:43], a[248:251], v[232:235]
    v_max_f32 v197, 0, v197
    v_max_f32 v198, 0, v198
    s_waitcnt vmcnt(20)
    s_barrier
    v_mfma_f32_16x16x32_bf16 v[228:231], v[40:43], a[244:247], v[228:231]
    ds_read_b64_tr_b16 v[32:33], v18 offset:0
    v_max_f32 v199, 0, v199
    v_mfma_f32_16x16x32_bf16 v[244:247], v[44:47], a[244:247], v[244:247]
    ds_read_b64_tr_b16 v[34:35], v18 offset:256
    s_add_u32 m0, s42, 16384
    v_mfma_f32_16x16x32_bf16 v[240:243], v[44:47], a[240:243], v[240:243]
    buffer_load_dwordx4 v5, s[16:19], s40 offen lds
    v_mfma_f32_16x16x32_bf16 v[224:227], v[40:43], a[240:243], v[224:227]
    v_mul_f32 v196, v196, v212
    s_waitcnt lgkmcnt(6)
    v_mfma_f32_16x16x32_bf16 v[224:227], v[48:51], v[64:67], v[224:227]
    ds_read_b64_tr_b16 v[36:37], v18 offset:18432
    v_mul_f32 v197, v197, v213
    v_mfma_f32_16x16x32_bf16 v[240:243], v[52:55], v[64:67], v[240:243]
    ds_read_b64_tr_b16 v[38:39], v18 offset:18688
    s_add_u32 m0, s42, 20480
    v_mfma_f32_16x16x32_bf16 v[244:247], v[52:55], v[68:71], v[244:247]
    buffer_load_dwordx4 v6, s[16:19], s40 offen lds
    v_mfma_f32_16x16x32_bf16 v[228:231], v[48:51], v[68:71], v[228:231]
    v_mul_f32 v198, v198, v214
    v_mul_f32 v199, v199, v215
    v_mfma_f32_16x16x32_bf16 v[232:235], v[48:51], v[72:75], v[232:235]
    ds_read_b64_tr_b16 v[40:41], v18 offset:1024
    v_cvt_pk_bf16_f32 v114, v196, v197
    v_mfma_f32_16x16x32_bf16 v[248:251], v[52:55], v[72:75], v[248:251]
    ds_read_b64_tr_b16 v[42:43], v18 offset:1280
    s_add_u32 m0, s42, 24576
    v_mfma_f32_16x16x32_bf16 v[252:255], v[52:55], v[76:79], v[252:255]
    buffer_load_dwordx4 v7, s[16:19], s40 offen lds
    v_mfma_f32_16x16x32_bf16 v[236:239], v[48:51], v[76:79], v[236:239]
    v_cvt_pk_bf16_f32 v115, v198, v199
    s_waitcnt lgkmcnt(6)
    v_mfma_f32_16x16x32_bf16 v[236:239], v[56:59], v[92:95], v[236:239]
    ds_read_b64_tr_b16 v[44:45], v18 offset:19456
    v_mfma_f32_16x16x32_bf16 v[252:255], v[60:63], v[92:95], v[252:255]
    ds_read_b64_tr_b16 v[46:47], v18 offset:19712
    s_add_u32 m0, s42, 28672
    v_mfma_f32_16x16x32_bf16 v[248:251], v[60:63], v[88:91], v[248:251]
    buffer_load_dwordx4 v8, s[16:19], s40 offen lds
    v_mfma_f32_16x16x32_bf16 v[232:235], v[56:59], v[88:91], v[232:235]
    v_permlane16_swap_b32 v112, v114
    v_permlane16_swap_b32 v113, v115
    v_mfma_f32_16x16x32_bf16 v[228:231], v[56:59], v[84:87], v[228:231]
    ds_read_b64_tr_b16 v[48:49], v18 offset:2048
    v_max_f32 v200, 0, v200
    v_mfma_f32_16x16x32_bf16 v[244:247], v[60:63], v[84:87], v[244:247]
    ds_read_b64_tr_b16 v[50:51], v18 offset:2304
    v_max_f32 v201, 0, v201
    v_mfma_f32_16x16x32_bf16 v[240:243], v[60:63], v[80:83], v[240:243]
    buffer_store_dwordx4 v[112:115], v4, s[28:31], s52 offen offset:2048 sc1
    v_mfma_f32_16x16x32_bf16 v[224:227], v[56:59], v[80:83], v[224:227]
    v_max_f32 v202, 0, v202
    s_waitcnt lgkmcnt(6)
    v_mfma_f32_16x16x32_bf16 v[128:131], v[32:35], a[0:3], 0
    ds_read_b64_tr_b16 v[52:53], v18 offset:20480
    v_max_f32 v203, 0, v203
    v_mfma_f32_16x16x32_bf16 v[144:147], v[36:39], a[0:3], 0
    ds_read_b64_tr_b16 v[54:55], v18 offset:20736
    s_add_u32 m0, s42, 32768
    v_mfma_f32_16x16x32_bf16 v[148:151], v[36:39], a[4:7], 0
    buffer_load_dwordx4 v5, s[20:23], s40 offen lds
    v_mfma_f32_16x16x32_bf16 v[132:135], v[32:35], a[4:7], 0
    v_mul_f32 v200, v200, v216
    v_mul_f32 v201, v201, v217
    s_waitcnt vmcnt(15)
    v_cmp_ne_u32 vcc, v22, v19
    s_cbranch_vccnz K4_slow0
K4_ok0:
    v_mov_b32 v15, v23
    v_mov_b32 v23, v30
    v_writelane_b32 v21, 2.0, 1
    v_add_u32 v30, 131072, v25
    v_mfma_f32_16x16x32_bf16 v[136:139], v[32:35], a[8:11], 0
    ds_read_b64_tr_b16 v[56:57], v18 offset:3072
    v_mul_f32 v202, v202, v218
    v_mfma_f32_16x16x32_bf16 v[152:155], v[36:39], a[8:11], 0
    ds_read_b64_tr_b16 v[58:59], v18 offset:3328
    s_add_u32 m0, s42, 36864
    v_mfma_f32_16x16x32_bf16 v[156:159], v[36:39], a[12:15], 0
    buffer_load_dwordx4 v6, s[20:23], s40 offen lds
    v_mfma_f32_16x16x32_bf16 v[140:143], v[32:35], a[12:15], 0
    v_mul_f32 v203, v203, v219
    s_barrier
    s_waitcnt lgkmcnt(6)
    v_mfma_f32_16x16x32_bf16 v[140:143], v[40:43], a[28:31], v[140:143]
    ds_read_b64_tr_b16 v[60:61], v18 offset:21504
    v_cvt_pk_bf16_f32 v116, v200, v201
    v_mfma_f32_16x16x32_bf16 v[156:159], v[44:47], a[28:31], v[156:159]
    ds_read_b64_tr_b16 v[62:63], v18 offset:21760
    s_add_u32 m0, s42, 40960
    v_mfma_f32_16x16x32_bf16 v[152:155], v[44:47], a[24:27], v[152:155]
    buffer_load_dwordx4 v7, s[20:23], s40 offen lds
    v_mfma_f32_16x16x32_bf16 v[136:139], v[40:43], a[24:27], v[136:139]
    v_cvt_pk_bf16_f32 v117, v202, v203
    v_max_f32 v204, 0, v204
    v_mfma_f32_16x16x32_bf16 v[132:135], v[40:43], a[20:23], v[132:135]
    ds_read_b64_tr_b16 v[32:33], v18 offset:4096
    v_max_f32 v205, 0, v205
    v_mfma_f32_16x16x32_bf16 v[148:151], v[44:47], a[20:23], v[148:151]
    ds_read_b64_tr_b16 v[34:35], v18 offset:4352
    s_add_u32 m0, s42, 45056
    v_mfma_f32_16x16x32_bf16 v[144:147], v[44:47], a[16:19], v[144:147]
    buffer_load_dwordx4 v8, s[20:23], s40 offen lds
    v_mfma_f32_16x16x32_bf16 v[128:131], v[40:43], a[16:19], v[128:131]
    v_max_f32 v206, 0, v206
    s_waitcnt lgkmcnt(6)
    v_mfma_f32_16x16x32_bf16 v[128:131], v[48:51], a[32:35], v[128:131]
    ds_read_b64_tr_b16 v[36:37], v18 offset:22528
    v_max_f32 v207, 0, v207
    v_mfma_f32_16x16x32_bf16 v[144:147], v[52:55], a[32:35], v[144:147]
    ds_read_b64_tr_b16 v[38:39], v18 offset:22784
    v_mul_f32 v204, v204, v220
    v_mfma_f32_16x16x32_bf16 v[148:151], v[52:55], a[36:39], v[148:151]
    buffer_load_dwordx4 a[0:3], v2, s[28:31], s4 offen offset:0 sc1
    v_mfma_f32_16x16x32_bf16 v[132:135], v[48:51], a[36:39], v[132:135]
    v_mul_f32 v205, v205, v221
    v_mul_f32 v206, v206, v222
    v_mfma_f32_16x16x32_bf16 v[136:139], v[48:51], a[40:43], v[136:139]
    ds_read_b64_tr_b16 v[40:41], v18 offset:5120
    v_mul_f32 v207, v207, v223
    v_mfma_f32_16x16x32_bf16 v[152:155], v[52:55], a[40:43], v[152:155]
    ds_read_b64_tr_b16 v[42:43], v18 offset:5376
    v_cvt_pk_bf16_f32 v118, v204, v205
    v_mfma_f32_16x16x32_bf16 v[156:159], v[52:55], a[44:47], v[156:159]
    buffer_load_dwordx4 a[4:7], v2, s[28:31], s4 offen offset:256 sc1
    v_mfma_f32_16x16x32_bf16 v[140:143], v[48:51], a[44:47], v[140:143]
    v_cvt_pk_bf16_f32 v119, v206, v207
    s_waitcnt lgkmcnt(6)
    v_mfma_f32_16x16x32_bf16 v[140:143], v[56:59], a[60:63], v[140:143]
    ds_read_b64_tr_b16 v[44:45], v18 offset:23552
    v_mfma_f32_16x16x32_bf16 v[156:159], v[60:63], a[60:63], v[156:159]
    ds_read_b64_tr_b16 v[46:47], v18 offset:23808
    v_permlane16_swap_b32 v116, v118
    v_mfma_f32_16x16x32_bf16 v[152:155], v[60:63], a[56:59], v[152:155]
    buffer_load_dwordx4 a[8:11], v2, s[28:31], s4 offen offset:2048 sc1
    v_mfma_f32_16x16x32_bf16 v[136:139], v[56:59], a[56:59], v[136:139]
    v_permlane16_swap_b32 v117, v119
    v_max_f32 v224, 0, v224
    v_mfma_f32_16x16x32_bf16 v[132:135], v[56:59], a[52:55], v[132:135]
    ds_read_b64_tr_b16 v[48:49], v18 offset:6144
    v_max_f32 v225, 0, v225
    v_mfma_f32_16x16x32_bf16 v[148:151], v[60:63], a[52:55], v[148:151]
    ds_read_b64_tr_b16 v[50:51], v18 offset:6400
    v_max_f32 v226, 0, v226
    v_mfma_f32_16x16x32_bf16 v[144:147], v[60:63], a[48:51], v[144:147]
    buffer_store_dwordx4 v[116:119], v4, s[28:31], s53 offen offset:2048 sc1
    v_mfma_f32_16x16x32_bf16 v[128:131], v[56:59], a[48:51], v[128:131]
    v_max_f32 v227, 0, v227
    s_waitcnt lgkmcnt(6)
    v_mfma_f32_16x16x32_bf16 v[128:131], v[32:35], a[64:67], v[128:131]
    ds_read_b64_tr_b16 v[52:53], v18 offset:24576
    v_mul_f32 v224, v224, v240
    v_mfma_f32_16x16x32_bf16 v[144:147], v[36:39], a[64:67], v[144:147]
    ds_read_b64_tr_b16 v[54:55], v18 offset:24832
    v_mul_f32 v225, v225, v241
    v_mfma_f32_16x16x32_bf16 v[148:151], v[36:39], a[68:71], v[148:151]
    buffer_load_dwordx4 a[12:15], v2, s[28:31], s4 offen offset:2304 sc1
    v_mfma_f32_16x16x32_bf16 v[132:135], v[32:35], a[68:71], v[132:135]
    v_mul_f32 v226, v226, v242
    v_mul_f32 v227, v227, v243
    v_mfma_f32_16x16x32_bf16 v[136:139], v[32:35], a[72:75], v[136:139]
    ds_read_b64_tr_b16 v[56:57], v18 offset:7168
    v_cvt_pk_bf16_f32 v120, v224, v225
    v_mfma_f32_16x16x32_bf16 v[152:155], v[36:39], a[72:75], v[152:155]
    ds_read_b64_tr_b16 v[58:59], v18 offset:7424
    v_cvt_pk_bf16_f32 v121, v226, v227
    v_mfma_f32_16x16x32_bf16 v[156:159], v[36:39], a[76:79], v[156:159]
    buffer_load_dwordx4 a[16:19], v3, s[28:31], s4 offen offset:0 sc1
    v_mfma_f32_16x16x32_bf16 v[140:143], v[32:35], a[76:79], v[140:143]
    v_max_f32 v228, 0, v228
    s_waitcnt lgkmcnt(6)
    v_mfma_f32_16x16x32_bf16 v[140:143], v[40:43], a[92:95], v[140:143]
    ds_read_b64_tr_b16 v[60:61], v18 offset:25600
    v_max_f32 v229, 0, v229
    v_mfma_f32_16x16x32_bf16 v[156:159], v[44:47], a[92:95], v[156:159]
    ds_read_b64_tr_b16 v[62:63], v18 offset:25856
    v_max_f32 v230, 0, v230
    v_mfma_f32_16x16x32_bf16 v[152:155], v[44:47], a[88:91], v[152:155]
    buffer_load_dwordx4 a[20:23], v3, s[28:31], s4 offen offset:256 sc1
    v_mfma_f32_16x16x32_bf16 v[136:139], v[40:43], a[88:91], v[136:139]
    v_max_f32 v231, 0, v231
    v_mul_f32 v228, v228, v244
    v_mfma_f32_16x16x32_bf16 v[132:135], v[40:43], a[84:87], v[132:135]
    ds_read_b64_tr_b16 v[32:33], v18 offset:8192
    v_mul_f32 v229, v229, v245
    v_mfma_f32_16x16x32_bf16 v[148:151], v[44:47], a[84:87], v[148:151]
    ds_read_b64_tr_b16 v[34:35], v18 offset:8448
    v_mul_f32 v230, v230, v246
    v_mfma_f32_16x16x32_bf16 v[144:147], v[44:47], a[80:83], v[144:147]
    buffer_load_dwordx4 a[24:27], v3, s[28:31], s4 offen offset:2048 sc1
    v_mfma_f32_16x16x32_bf16 v[128:131], v[40:43], a[80:83], v[128:131]
    v_mul_f32 v231, v231, v247
    s_waitcnt lgkmcnt(6)
    v_mfma_f32_16x16x32_bf16 v[128:131], v[48:51], a[96:99], v[128:131]
    ds_read_b64_tr_b16 v[36:37], v18 offset:26624
    v_cvt_pk_bf16_f32 v122, v228, v229
    v_mfma_f32_16x16x32_bf16 v[144:147], v[52:55], a[96:99], v[144:147]
    ds_read_b64_tr_b16 v[38:39], v18 offset:26880
    v_cvt_pk_bf16_f32 v123, v230, v231
    v_mfma_f32_16x16x32_bf16 v[148:151], v[52:55], a[100:103], v[148:151]
    buffer_load_dwordx4 a[28:31], v3, s[28:31], s4 offen offset:2304 sc1
    v_mfma_f32_16x16x32_bf16 v[132:135], v[48:51], a[100:103], v[132:135]
    v_mfma_f32_16x16x32_bf16 v[136:139], v[48:51], a[104:107], v[136:139]
    ds_read_b64_tr_b16 v[40:41], v18 offset:9216
    v_permlane16_swap_b32 v120, v122
    v_mfma_f32_16x16x32_bf16 v[152:155], v[52:55], a[104:107], v[152:155]
    ds_read_b64_tr_b16 v[42:43], v18 offset:9472
    v_permlane16_swap_b32 v121, v123
    v_mfma_f32_16x16x32_bf16 v[156:159], v[52:55], a[108:111], v[156:159]
    buffer_load_dwordx4 a[32:35], v2, s[28:31], s5 offen offset:0 sc1
    v_mfma_f32_16x16x32_bf16 v[140:143], v[48:51], a[108:111], v[140:143]
    v_max_f32 v232, 0, v232
    s_waitcnt lgkmcnt(6)
    v_mfma_f32_16x16x32_bf16 v[140:143], v[56:59], a[124:127], v[140:143]
    ds_read_b64_tr_b16 v[44:45], v18 offset:27648
    v_max_f32 v233, 0, v233
    v_mfma_f32_16x16x32_bf16 v[156:159], v[60:63], a[124:127], v[156:159]
    ds_read_b64_tr_b16 v[46:47], v18 offset:27904
    v_max_f32 v234, 0, v234
    v_mfma_f32_16x16x32_bf16 v[152:155], v[60:63], a[120:123], v[152:155]
    s_branch K4_ps8
K4_pg8:
    s_branch K4_vrA
K4_ps8:
    buffer_store_dwordx4 v[120:123], v4, s[28:31], s52 offen offset:3072 sc1
    v_mfma_f32_16x16x32_bf16 v[136:139], v[56:59], a[120:123], v[136:139]
    v_max_f32 v235, 0, v235
    v_mul_f32 v232, v232, v248
    v_mfma_f32_16x16x32_bf16 v[132:135], v[56:59], a[116:119], v[132:135]
    ds_read_b64_tr_b16 v[48:49], v18 offset:10240
    v_mul_f32 v233, v233, v249
    v_mfma_f32_16x16x32_bf16 v[148:151], v[60:63], a[116:119], v[148:151]
    ds_read_b64_tr_b16 v[50:51], v18 offset:10496
    v_mul_f32 v234, v234, v250
    v_mfma_f32_16x16x32_bf16 v[144:147], v[60:63], a[112:115], v[144:147]
    buffer_load_dwordx4 a[36:39], v2, s[28:31], s5 offen offset:256 sc1
    v_mfma_f32_16x16x32_bf16 v[128:131], v[56:59], a[112:115], v[128:131]
    v_mul_f32 v235, v235, v251
    s_waitcnt lgkmcnt(6)
    v_mfma_f32_16x16x32_bf16 v[128:131], v[32:35], a[128:131], v[128:131]
    ds_read_b64_tr_b16 v[52:53], v18 offset:28672
    v_cvt_pk_bf16_f32 v124, v232, v233
    v_mfma_f32_16x16x32_bf16 v[144:147], v[36:39], a[128:131], v[144:147]
    ds_read_b64_tr_b16 v[54:55], v18 offset:28928
    v_cvt_pk_bf16_f32 v125, v234, v235
    v_mfma_f32_16x16x32_bf16 v[148:151], v[36:39], a[132:135], v[148:151]
    buffer_load_dwordx4 a[40:43], v2, s[28:31], s5 offen offset:2048 sc1
    v_mfma_f32_16x16x32_bf16 v[132:135], v[32:35], a[132:135], v[132:135]
    v_max_f32 v236, 0, v236
    v_max_f32 v237, 0, v237
    v_mfma_f32_16x16x32_bf16 v[136:139], v[32:35], a[136:139], v[136:139]
    ds_read_b64_tr_b16 v[56:57], v18 offset:11264
    v_max_f32 v238, 0, v238
    v_mfma_f32_16x16x32_bf16 v[152:155], v[36:39], a[136:139], v[152:155]
    ds_read_b64_tr_b16 v[58:59], v18 offset:11520
    v_max_f32 v239, 0, v239
    v_mfma_f32_16x16x32_bf16 v[156:159], v[36:39], a[140:143], v[156:159]
    buffer_load_dwordx4 a[44:47], v2, s[28:31], s5 offen offset:2304 sc1
    v_mfma_f32_16x16x32_bf16 v[140:143], v[32:35], a[140:143], v[140:143]
    v_mul_f32 v236, v236, v252
    s_waitcnt lgkmcnt(6)
    v_mfma_f32_16x16x32_bf16 v[140:143], v[40:43], a[156:159], v[140:143]
    ds_read_b64_tr_b16 v[60:61], v18 offset:29696
    v_mul_f32 v237, v237, v253
    v_mfma_f32_16x16x32_bf16 v[156:159], v[44:47], a[156:159], v[156:159]
    ds_read_b64_tr_b16 v[62:63], v18 offset:29952
    v_mul_f32 v238, v238, v254
    v_mfma_f32_16x16x32_bf16 v[152:155], v[44:47], a[152:155], v[152:155]
    buffer_load_dwordx4 a[48:51], v3, s[28:31], s5 offen offset:0 sc1
    v_mfma_f32_16x16x32_bf16 v[136:139], v[40:43], a[152:155], v[136:139]
    v_mul_f32 v239, v239, v255
    v_cvt_pk_bf16_f32 v126, v236, v237
    v_mfma_f32_16x16x32_bf16 v[132:135], v[40:43], a[148:151], v[132:135]
    ds_read_b64_tr_b16 v[32:33], v18 offset:12288
    v_cvt_pk_bf16_f32 v127, v238, v239
    v_mfma_f32_16x16x32_bf16 v[148:151], v[44:47], a[148:151], v[148:151]
    ds_read_b64_tr_b16 v[34:35], v18 offset:12544
    v_mfma_f32_16x16x32_bf16 v[144:147], v[44:47], a[144:147], v[144:147]
    buffer_load_dwordx4 a[52:55], v3, s[28:31], s5 offen offset:256 sc1
    v_mfma_f32_16x16x32_bf16 v[128:131], v[40:43], a[144:147], v[128:131]
    v_permlane16_swap_b32 v124, v126
    s_waitcnt lgkmcnt(6)
    v_mfma_f32_16x16x32_bf16 v[128:131], v[48:51], a[160:163], v[128:131]
    ds_read_b64_tr_b16 v[36:37], v18 offset:30720
    v_permlane16_swap_b32 v125, v127
    v_mfma_f32_16x16x32_bf16 v[144:147], v[52:55], a[160:163], v[144:147]
    ds_read_b64_tr_b16 v[38:39], v18 offset:30976
    v_mfma_f32_16x16x32_bf16 v[148:151], v[52:55], a[164:167], v[148:151]
    buffer_store_dwordx4 v[124:127], v4, s[28:31], s53 offen offset:3072 sc1
    v_mfma_f32_16x16x32_bf16 v[132:135], v[48:51], a[164:167], v[132:135]
    v_mfma_f32_16x16x32_bf16 v[136:139], v[48:51], a[168:171], v[136:139]
    ds_read_b64_tr_b16 v[40:41], v18 offset:13312
    v_mfma_f32_16x16x32_bf16 v[152:155], v[52:55], a[168:171], v[152:155]
    ds_read_b64_tr_b16 v[42:43], v18 offset:13568
    v_mfma_f32_16x16x32_bf16 v[156:159], v[52:55], a[172:175], v[156:159]
    buffer_load_dwordx4 a[56:59], v3, s[28:31], s5 offen offset:2048 sc1
    v_mfma_f32_16x16x32_bf16 v[140:143], v[48:51], a[172:175], v[140:143]
    s_waitcnt lgkmcnt(6)
    v_mfma_f32_16x16x32_bf16 v[140:143], v[56:59], a[188:191], v[140:143]
    ds_read_b64_tr_b16 v[44:45], v18 offset:31744
    v_mfma_f32_16x16x32_bf16 v[156:159], v[60:63], a[188:191], v[156:159]
    ds_read_b64_tr_b16 v[46:47], v18 offset:32000
    v_mfma_f32_16x16x32_bf16 v[152:155], v[60:63], a[184:187], v[152:155]
    buffer_load_dwordx4 a[60:63], v3, s[28:31], s5 offen offset:2304 sc1
    v_mfma_f32_16x16x32_bf16 v[136:139], v[56:59], a[184:187], v[136:139]
    v_mfma_f32_16x16x32_bf16 v[132:135], v[56:59], a[180:183], v[132:135]
    ds_read_b64_tr_b16 v[48:49], v18 offset:14336
    v_mfma_f32_16x16x32_bf16 v[148:151], v[60:63], a[180:183], v[148:151]
    ds_read_b64_tr_b16 v[50:51], v18 offset:14592
    v_mfma_f32_16x16x32_bf16 v[144:147], v[60:63], a[176:179], v[144:147]
    buffer_load_dwordx4 a[64:67], v2, s[28:31], s6 offen offset:0 sc1
    v_mfma_f32_16x16x32_bf16 v[128:131], v[56:59], a[176:179], v[128:131]
    s_waitcnt lgkmcnt(6)
    v_mfma_f32_16x16x32_bf16 v[128:131], v[32:35], a[192:195], v[128:131]
    ds_read_b64_tr_b16 v[52:53], v18 offset:32768
    v_mfma_f32_16x16x32_bf16 v[144:147], v[36:39], a[192:195], v[144:147]
    ds_read_b64_tr_b16 v[54:55], v18 offset:33024
    v_mfma_f32_16x16x32_bf16 v[148:151], v[36:39], a[196:199], v[148:151]
    buffer_load_dwordx4 a[68:71], v2, s[28:31], s6 offen offset:256 sc1
    v_mfma_f32_16x16x32_bf16 v[132:135], v[32:35], a[196:199], v[132:135]
    v_mfma_f32_16x16x32_bf16 v[136:139], v[32:35], a[200:203], v[136:139]
    ds_read_b64_tr_b16 v[56:57], v18 offset:15360
    v_mfma_f32_16x16x32_bf16 v[152:155], v[36:39], a[200:203], v[152:155]
    ds_read_b64_tr_b16 v[58:59], v18 offset:15616
    v_mfma_f32_16x16x32_bf16 v[156:159], v[36:39], a[204:207], v[156:159]
    buffer_load_dwordx4 a[72:75], v2, s[28:31], s6 offen offset:2048 sc1
    v_mfma_f32_16x16x32_bf16 v[140:143], v[32:35], a[204:207], v[140:143]
    s_waitcnt lgkmcnt(6)
    v_mfma_f32_16x16x32_bf16 v[140:143], v[40:43], a[220:223], v[140:143]
    ds_read_b64_tr_b16 v[60:61], v18 offset:33792
    v_mfma_f32_16x16x32_bf16 v[156:159], v[44:47], a[220:223], v[156:159]
    ds_read_b64_tr_b16 v[62:63], v18 offset:34048
    v_mfma_f32_16x16x32_bf16 v[152:155], v[44:47], a[216:219], v[152:155]
    buffer_load_dwordx4 a[76:79], v2, s[28:31], s6 offen offset:2304 sc1
    v_mfma_f32_16x16x32_bf16 v[136:139], v[40:43], a[216:219], v[136:139]
    v_mfma_f32_16x16x32_bf16 v[132:135], v[40:43], a[212:215], v[132:135]
    ds_read_b64_tr_b16 v[32:33], v18 offset:16384
    v_mfma_f32_16x16x32_bf16 v[148:151], v[44:47], a[212:215], v[148:151]
    ds_read_b64_tr_b16 v[34:35], v18 offset:16640
    v_mfma_f32_16x16x32_bf16 v[144:147], v[44:47], a[208:211], v[144:147]
    v_mfma_f32_16x16x32_bf16 v[128:131], v[40:43], a[208:211], v[128:131]
    s_waitcnt lgkmcnt(6)
    v_mfma_f32_16x16x32_bf16 v[128:131], v[48:51], a[224:227], v[128:131]
    ds_read_b64_tr_b16 v[36:37], v18 offset:34816
    v_mfma_f32_16x16x32_bf16 v[144:147], v[52:55], a[224:227], v[144:147]
    ds_read_b64_tr_b16 v[38:39], v18 offset:35072
    v_mfma_f32_16x16x32_bf16 v[148:151], v[52:55], a[228:231], v[148:151]
    v_mfma_f32_16x16x32_bf16 v[132:135], v[48:51], a[228:231], v[132:135]
    v_mfma_f32_16x16x32_bf16 v[136:139], v[48:51], a[232:235], v[136:139]
    ds_read_b64_tr_b16 v[40:41], v18 offset:17408
    v_mfma_f32_16x16x32_bf16 v[152:155], v[52:55], a[232:235], v[152:155]
    ds_read_b64_tr_b16 v[42:43], v18 offset:17664
    v_mfma_f32_16x16x32_bf16 v[156:159], v[52:55], a[236:239], v[156:159]
    v_mfma_f32_16x16x32_bf16 v[140:143], v[48:51], a[236:239], v[140:143]
    s_waitcnt lgkmcnt(6)
    v_mfma_f32_16x16x32_bf16 v[140:143], v[56:59], a[252:255], v[140:143]
    ds_read_b64_tr_b16 v[44:45], v18 offset:35840
    v_mfma_f32_16x16x32_bf16 v[156:159], v[60:63], a[252:255], v[156:159]
    ds_read_b64_tr_b16 v[46:47], v18 offset:36096
    v_mfma_f32_16x16x32_bf16 v[152:155], v[60:63], a[248:251], v[152:155]
    v_mfma_f32_16x16x32_bf16 v[136:139], v[56:59], a[248:251], v[136:139]
    v_mfma_f32_16x16x32_bf16 v[132:135], v[56:59], a[244:247], v[132:135]
    v_mfma_f32_16x16x32_bf16 v[148:151], v[60:63], a[244:247], v[148:151]
    v_mfma_f32_16x16x32_bf16 v[144:147], v[60:63], a[240:243], v[144:147]
    v_mfma_f32_16x16x32_bf16 v[128:131], v[56:59], a[240:243], v[128:131]
    s_waitcnt lgkmcnt(4)
    v_mfma_f32_16x16x32_bf16 v[128:131], v[32:35], v[64:67], v[128:131]
    v_mfma_f32_16x16x32_bf16 v[144:147], v[36:39], v[64:67], v[144:147]
    v_mfma_f32_16x16x32_bf16 v[148:151], v[36:39], v[68:71], v[148:151]
    v_mfma_f32_16x16x32_bf16 v[132:135], v[32:35], v[68:71], v[132:135]
    v_mfma_f32_16x16x32_bf16 v[136:139], v[32:35], v[72:75], v[136:139]
    v_mfma_f32_16x16x32_bf16 v[152:155], v[36:39], v[72:75], v[152:155]
    v_mfma_f32_16x16x32_bf16 v[156:159], v[36:39], v[76:79], v[156:159]
    v_mfma_f32_16x16x32_bf16 v[140:143], v[32:35], v[76:79], v[140:143]
    s_waitcnt lgkmcnt(0)
    v_mfma_f32_16x16x32_bf16 v[140:143], v[40:43], v[92:95], v[140:143]
    v_mfma_f32_16x16x32_bf16 v[156:159], v[44:47], v[92:95], v[156:159]
    v_mfma_f32_16x16x32_bf16 v[152:155], v[44:47], v[88:91], v[152:155]
    v_mfma_f32_16x16x32_bf16 v[136:139], v[40:43], v[88:91], v[136:139]
    v_mfma_f32_16x16x32_bf16 v[132:135], v[40:43], v[84:87], v[132:135]
    v_mfma_f32_16x16x32_bf16 v[148:151], v[44:47], v[84:87], v[148:151]
    v_mfma_f32_16x16x32_bf16 v[144:147], v[44:47], v[80:83], v[144:147]
    v_mfma_f32_16x16x32_bf16 v[128:131], v[40:43], v[80:83], v[128:131]
    s_waitcnt vmcnt(6)
    s_barrier
    ds_read_b64_tr_b16 v[48:49], v26 offset:4096
    ds_read_b64_tr_b16 v[50:51], v26 offset:4352
    ds_read_b64_tr_b16 v[52:53], v27 offset:4096
    ds_read_b64_tr_b16 v[54:55], v27 offset:4352
    ds_read_b64_tr_b16 v[56:57], v26 offset:8192
    ds_read_b64_tr_b16 v[58:59], v26 offset:8448
    ds_read_b64_tr_b16 v[60:61], v27 offset:8192
    ds_read_b64_tr_b16 v[62:63], v27 offset:8448
    ds_read_b64_tr_b16 v[32:33], v26 offset:12288
    ds_read_b64_tr_b16 v[34:35], v26 offset:12544
    buffer_store_dword v22, v21, s[72:75], s100 offen sc1
    s_waitcnt lgkmcnt(6)
    v_mfma_f32_16x16x32_bf16 v[176:179], v[48:51], a[0:3], 0
    ds_read_b64_tr_b16 v[36:37], v27 offset:12288
    buffer_load_dwordx4 a[80:83], v3, s[28:31], s6 offen offset:0 sc1
    v_mfma_f32_16x16x32_bf16 v[184:187], v[48:51], a[4:7], 0
    ds_read_b64_tr_b16 v[38:39], v27 offset:12544
    v_max_f32 v128, 0, v128
    v_mfma_f32_16x16x32_bf16 v[188:191], v[52:55], a[4:7], 0
    ds_read_b64_tr_b16 v[40:41], v31 offset:4096
    v_max_f32 v129, 0, v129
    v_mfma_f32_16x16x32_bf16 v[180:183], v[52:55], a[0:3], 0
    ds_read_b64_tr_b16 v[42:43], v31 offset:4352
    v_max_f32 v130, 0, v130
    s_waitcnt lgkmcnt(6)
    v_mfma_f32_16x16x32_bf16 v[192:195], v[56:59], a[0:3], 0
    ds_read_b64_tr_b16 v[44:45], v26 offset:6144
    buffer_load_dwordx4 a[84:87], v3, s[28:31], s6 offen offset:256 sc1
    v_mfma_f32_16x16x32_bf16 v[200:203], v[56:59], a[4:7], 0
    ds_read_b64_tr_b16 v[46:47], v26 offset:6400
    v_max_f32 v131, 0, v131
    v_mfma_f32_16x16x32_bf16 v[204:207], v[60:63], a[4:7], 0
    ds_read_b64_tr_b16 v[48:49], v27 offset:6144
    v_mul_f32 v128, v128, v144
    v_mfma_f32_16x16x32_bf16 v[196:199], v[60:63], a[0:3], 0
    ds_read_b64_tr_b16 v[50:51], v27 offset:6400
    v_mul_f32 v129, v129, v145
    s_waitcnt lgkmcnt(6)
    v_mfma_f32_16x16x32_bf16 v[208:211], v[32:35], a[0:3], 0
    ds_read_b64_tr_b16 v[52:53], v26 offset:10240
    buffer_load_dwordx4 a[88:91], v3, s[28:31], s6 offen offset:2048 sc1
    v_mfma_f32_16x16x32_bf16 v[216:219], v[32:35], a[4:7], 0
    ds_read_b64_tr_b16 v[54:55], v26 offset:10496
    v_mul_f32 v130, v130, v146
    v_mfma_f32_16x16x32_bf16 v[220:223], v[36:39], a[4:7], 0
    ds_read_b64_tr_b16 v[56:57], v27 offset:10240
    v_mul_f32 v131, v131, v147
    v_mfma_f32_16x16x32_bf16 v[212:215], v[36:39], a[0:3], 0
    ds_read_b64_tr_b16 v[58:59], v27 offset:10496
    v_cvt_pk_bf16_f32 v96, v128, v129
    s_waitcnt lgkmcnt(6)
    v_mfma_f32_16x16x32_bf16 v[224:227], v[40:43], a[0:3], 0
    ds_read_b64_tr_b16 v[60:61], v26 offset:14336
    buffer_load_dwordx4 a[92:95], v3, s[28:31], s6 offen offset:2304 sc1
    v_mfma_f32_16x16x32_bf16 v[228:231], v[40:43], a[4:7], 0
    ds_read_b64_tr_b16 v[62:63], v26 offset:14592
    v_cvt_pk_bf16_f32 v97, v130, v131
    v_mfma_f32_16x16x32_bf16 v[184:187], v[44:47], a[12:15], v[184:187]
    ds_read_b64_tr_b16 v[32:33], v27 offset:14336
    v_max_f32 v132, 0, v132
    v_mfma_f32_16x16x32_bf16 v[176:179], v[44:47], a[8:11], v[176:179]
    ds_read_b64_tr_b16 v[34:35], v27 offset:14592
    v_max_f32 v133, 0, v133
    s_waitcnt lgkmcnt(6)
    v_mfma_f32_16x16x32_bf16 v[180:183], v[48:51], a[8:11], v[180:183]
    ds_read_b64_tr_b16 v[36:37], v31 offset:5120
    s_add_u32 m0, s42, 147456
    v_mfma_f32_16x16x32_bf16 v[188:191], v[48:51], a[12:15], v[188:191]
    ds_read_b64_tr_b16 v[38:39], v31 offset:5376
    buffer_load_dwordx4 v9, s[64:67], s7 offen lds
    s_mul_i32 s40, s7, 18
    s_barrier
    v_mfma_f32_16x16x32_bf16 v[200:203], v[52:55], a[12:15], v[200:203]
    ds_read_b64_tr_b16 v[40:41], v26 offset:20480
    v_max_f32 v134, 0, v134
    v_mfma_f32_16x16x32_bf16 v[192:195], v[52:55], a[8:11], v[192:195]
    ds_read_b64_tr_b16 v[42:43], v26 offset:20736
    v_max_f32 v135, 0, v135
    s_waitcnt lgkmcnt(6)
    v_mfma_f32_16x16x32_bf16 v[196:199], v[56:59], a[8:11], v[196:199]
    ds_read_b64_tr_b16 v[44:45], v27 offset:20480
    s_add_u32 m0, s42, 49152
    v_mfma_f32_16x16x32_bf16 v[204:207], v[56:59], a[12:15], v[204:207]
    ds_read_b64_tr_b16 v[46:47], v27 offset:20736
    buffer_load_dwordx4 v5, s[16:19], s40 offen lds
    v_mfma_f32_16x16x32_bf16 v[216:219], v[60:63], a[12:15], v[216:219]
    ds_read_b64_tr_b16 v[48:49], v26 offset:24576
    v_mul_f32 v132, v132, v148
    v_mfma_f32_16x16x32_bf16 v[208:211], v[60:63], a[8:11], v[208:211]
    ds_read_b64_tr_b16 v[50:51], v26 offset:24832
    v_mul_f32 v133, v133, v149
    s_waitcnt lgkmcnt(6)
    v_mfma_f32_16x16x32_bf16 v[212:215], v[32:35], a[8:11], v[212:215]
    ds_read_b64_tr_b16 v[52:53], v27 offset:24576
    s_add_u32 m0, s42, 53248
    v_mfma_f32_16x16x32_bf16 v[220:223], v[32:35], a[12:15], v[220:223]
    ds_read_b64_tr_b16 v[54:55], v27 offset:24832
    buffer_load_dwordx4 v6, s[16:19], s40 offen lds
    v_mfma_f32_16x16x32_bf16 v[228:231], v[36:39], a[12:15], v[228:231]
    ds_read_b64_tr_b16 v[56:57], v26 offset:28672
    v_mul_f32 v134, v134, v150
    v_mfma_f32_16x16x32_bf16 v[224:227], v[36:39], a[8:11], v[224:227]
    ds_read_b64_tr_b16 v[58:59], v26 offset:28928
    v_mul_f32 v135, v135, v151
    s_waitcnt lgkmcnt(6)
    v_mfma_f32_16x16x32_bf16 v[176:179], v[40:43], a[16:19], v[176:179]
    ds_read_b64_tr_b16 v[60:61], v27 offset:28672
    s_add_u32 m0, s42, 57344
    v_mfma_f32_16x16x32_bf16 v[184:187], v[40:43], a[20:23], v[184:187]
    ds_read_b64_tr_b16 v[62:63], v27 offset:28928
    buffer_load_dwordx4 v7, s[16:19], s40 offen lds
    v_mfma_f32_16x16x32_bf16 v[188:191], v[44:47], a[20:23], v[188:191]
    ds_read_b64_tr_b16 v[32:33], v31 offset:6144
    v_cvt_pk_bf16_f32 v98, v132, v133
    v_mfma_f32_16x16x32_bf16 v[180:183], v[44:47], a[16:19], v[180:183]
    ds_read_b64_tr_b16 v[34:35], v31 offset:6400
    v_cvt_pk_bf16_f32 v99, v134, v135
    s_waitcnt lgkmcnt(6)
    v_mfma_f32_16x16x32_bf16 v[192:195], v[48:51], a[16:19], v[192:195]
    ds_read_b64_tr_b16 v[36:37], v26 offset:22528
    s_add_u32 m0, s42, 61440
    v_mfma_f32_16x16x32_bf16 v[200:203], v[48:51], a[20:23], v[200:203]
    ds_read_b64_tr_b16 v[38:39], v26 offset:22784
    buffer_load_dwordx4 v8, s[16:19], s40 offen lds
    v_mfma_f32_16x16x32_bf16 v[204:207], v[52:55], a[20:23], v[204:207]
    ds_read_b64_tr_b16 v[40:41], v27 offset:22528
    s_nop 1
    v_mfma_f32_16x16x32_bf16 v[196:199], v[52:55], a[16:19], v[196:199]
    ds_read_b64_tr_b16 v[42:43], v27 offset:22784
    v_permlane16_swap_b32 v96, v98
    s_waitcnt lgkmcnt(6)
    v_mfma_f32_16x16x32_bf16 v[208:211], v[56:59], a[16:19], v[208:211]
    ds_read_b64_tr_b16 v[44:45], v26 offset:26624
    buffer_load_dwordx4 a[96:99], v2, s[28:31], s7 offen offset:0 sc1
    v_mfma_f32_16x16x32_bf16 v[216:219], v[56:59], a[20:23], v[216:219]
    ds_read_b64_tr_b16 v[46:47], v26 offset:26880
    v_permlane16_swap_b32 v97, v99
    v_mfma_f32_16x16x32_bf16 v[220:223], v[60:63], a[20:23], v[220:223]
    ds_read_b64_tr_b16 v[48:49], v27 offset:26624
    buffer_store_dwordx4 v[96:99], v4, s[28:31], s54 offen offset:0 sc1
    v_mfma_f32_16x16x32_bf16 v[212:215], v[60:63], a[16:19], v[212:215]
    ds_read_b64_tr_b16 v[50:51], v27 offset:26880
    buffer_load_dwordx4 a[100:103], v2, s[28:31], s7 offen offset:256 sc1
    s_waitcnt lgkmcnt(6)
    v_mfma_f32_16x16x32_bf16 v[224:227], v[32:35], a[16:19], v[224:227]
    ds_read_b64_tr_b16 v[52:53], v26 offset:30720
    v_max_f32 v136, 0, v136
    v_mfma_f32_16x16x32_bf16 v[228:231], v[32:35], a[20:23], v[228:231]
    ds_read_b64_tr_b16 v[54:55], v26 offset:30976
    v_max_f32 v137, 0, v137
    v_mfma_f32_16x16x32_bf16 v[184:187], v[36:39], a[28:31], v[184:187]
    ds_read_b64_tr_b16 v[56:57], v27 offset:30720
    v_max_f32 v138, 0, v138
    v_mfma_f32_16x16x32_bf16 v[176:179], v[36:39], a[24:27], v[176:179]
    ds_read_b64_tr_b16 v[58:59], v27 offset:30976
    buffer_load_dwordx4 a[104:107], v2, s[28:31], s7 offen offset:2048 sc1
    s_waitcnt lgkmcnt(6)
    v_mfma_f32_16x16x32_bf16 v[180:183], v[40:43], a[24:27], v[180:183]
    ds_read_b64_tr_b16 v[60:61], v31 offset:7168
    v_max_f32 v139, 0, v139
    v_mfma_f32_16x16x32_bf16 v[188:191], v[40:43], a[28:31], v[188:191]
    ds_read_b64_tr_b16 v[62:63], v31 offset:7424
    v_mul_f32 v136, v136, v152
    s_barrier
    v_mfma_f32_16x16x32_bf16 v[200:203], v[44:47], a[28:31], v[200:203]
    ds_read_b64_tr_b16 v[32:33], v26 offset:36864
    v_mul_f32 v137, v137, v153
    v_mfma_f32_16x16x32_bf16 v[192:195], v[44:47], a[24:27], v[192:195]
    ds_read_b64_tr_b16 v[34:35], v26 offset:37120
    buffer_load_dwordx4 a[108:111], v2, s[28:31], s7 offen offset:2304 sc1
    s_waitcnt lgkmcnt(6)
    v_mfma_f32_16x16x32_bf16 v[196:199], v[48:51], a[24:27], v[196:199]
    ds_read_b64_tr_b16 v[36:37], v27 offset:36864
    v_mul_f32 v138, v138, v154
    v_mfma_f32_16x16x32_bf16 v[204:207], v[48:51], a[28:31], v[204:207]
    ds_read_b64_tr_b16 v[38:39], v27 offset:37120
    v_mul_f32 v139, v139, v155
    v_mfma_f32_16x16x32_bf16 v[216:219], v[52:55], a[28:31], v[216:219]
    ds_read_b64_tr_b16 v[40:41], v26 offset:40960
    v_cvt_pk_bf16_f32 v100, v136, v137
    v_mfma_f32_16x16x32_bf16 v[208:211], v[52:55], a[24:27], v[208:211]
    ds_read_b64_tr_b16 v[42:43], v26 offset:41216
    s_add_u32 m0, s42, 114688
    s_waitcnt lgkmcnt(6)
    v_mfma_f32_16x16x32_bf16 v[212:215], v[56:59], a[24:27], v[212:215]
    ds_read_b64_tr_b16 v[44:45], v27 offset:40960
    buffer_load_dwordx4 v5, s[20:23], s40 offen lds
    v_mfma_f32_16x16x32_bf16 v[220:223], v[56:59], a[28:31], v[220:223]
    ds_read_b64_tr_b16 v[46:47], v27 offset:41216
    v_cvt_pk_bf16_f32 v101, v138, v139
    v_mfma_f32_16x16x32_bf16 v[228:231], v[60:63], a[28:31], v[228:231]
    ds_read_b64_tr_b16 v[48:49], v26 offset:45056
    v_max_f32 v140, 0, v140
    v_mfma_f32_16x16x32_bf16 v[224:227], v[60:63], a[24:27], v[224:227]
    ds_read_b64_tr_b16 v[50:51], v26 offset:45312
    s_add_u32 m0, s42, 118784
    s_waitcnt lgkmcnt(6)
    v_mfma_f32_16x16x32_bf16 v[176:179], v[32:35], a[32:35], v[176:179]
    ds_read_b64_tr_b16 v[52:53], v27 offset:45056
    buffer_load_dwordx4 v6, s[20:23], s40 offen lds
    v_mfma_f32_16x16x32_bf16 v[184:187], v[32:35], a[36:39], v[184:187]
    ds_read_b64_tr_b16 v[54:55], v27 offset:45312
    v_max_f32 v141, 0, v141
    v_mfma_f32_16x16x32_bf16 v[188:191], v[36:39], a[36:39], v[188:191]
    ds_read_b64_tr_b16 v[56:57], v31 offset:8192
    v_max_f32 v142, 0, v142
    v_mfma_f32_16x16x32_bf16 v[180:183], v[36:39], a[32:35], v[180:183]
    ds_read_b64_tr_b16 v[58:59], v31 offset:8448
    s_add_u32 m0, s42, 122880
    s_waitcnt lgkmcnt(6)
    v_mfma_f32_16x16x32_bf16 v[192:195], v[40:43], a[32:35], v[192:195]
    ds_read_b64_tr_b16 v[60:61], v26 offset:38912
    buffer_load_dwordx4 v7, s[20:23], s40 offen lds
    v_mfma_f32_16x16x32_bf16 v[200:203], v[40:43], a[36:39], v[200:203]
    ds_read_b64_tr_b16 v[62:63], v26 offset:39168
    v_max_f32 v143, 0, v143
    v_mfma_f32_16x16x32_bf16 v[204:207], v[44:47], a[36:39], v[204:207]
    ds_read_b64_tr_b16 v[32:33], v27 offset:38912
    v_mul_f32 v140, v140, v156
    v_mfma_f32_16x16x32_bf16 v[196:199], v[44:47], a[32:35], v[196:199]
    ds_read_b64_tr_b16 v[34:35], v27 offset:39168
    s_add_u32 m0, s42, 126976
    s_waitcnt lgkmcnt(6)
    v_mfma_f32_16x16x32_bf16 v[208:211], v[48:51], a[32:35], v[208:211]
    ds_read_b64_tr_b16 v[36:37], v26 offset:43008
    buffer_load_dwordx4 v8, s[20:23], s40 offen lds
    v_mfma_f32_16x16x32_bf16 v[216:219], v[48:51], a[36:39], v[216:219]
    ds_read_b64_tr_b16 v[38:39], v26 offset:43264
    v_mul_f32 v141, v141, v157
    v_mfma_f32_16x16x32_bf16 v[220:223], v[52:55], a[36:39], v[220:223]
    ds_read_b64_tr_b16 v[40:41], v27 offset:43008
    v_mul_f32 v142, v142, v158
    v_mfma_f32_16x16x32_bf16 v[212:215], v[52:55], a[32:35], v[212:215]
    ds_read_b64_tr_b16 v[42:43], v27 offset:43264
    buffer_load_dwordx4 a[112:115], v3, s[28:31], s7 offen offset:0 sc1
    s_waitcnt lgkmcnt(6)
    v_mfma_f32_16x16x32_bf16 v[224:227], v[56:59], a[32:35], v[224:227]
    ds_read_b64_tr_b16 v[44:45], v26 offset:47104
    v_mul_f32 v143, v143, v159
    v_mfma_f32_16x16x32_bf16 v[228:231], v[56:59], a[36:39], v[228:231]
    ds_read_b64_tr_b16 v[46:47], v26 offset:47360
    v_cvt_pk_bf16_f32 v102, v140, v141
    v_mfma_f32_16x16x32_bf16 v[184:187], v[60:63], a[44:47], v[184:187]
    ds_read_b64_tr_b16 v[48:49], v27 offset:47104
    v_cvt_pk_bf16_f32 v103, v142, v143
    v_mfma_f32_16x16x32_bf16 v[176:179], v[60:63], a[40:43], v[176:179]
    ds_read_b64_tr_b16 v[50:51], v27 offset:47360
    buffer_load_dwordx4 a[116:119], v3, s[28:31], s7 offen offset:256 sc1
    s_waitcnt lgkmcnt(6)
    v_mfma_f32_16x16x32_bf16 v[180:183], v[32:35], a[40:43], v[180:183]
    ds_read_b64_tr_b16 v[52:53], v31 offset:9216
    s_nop 1
    v_mfma_f32_16x16x32_bf16 v[188:191], v[32:35], a[44:47], v[188:191]
    ds_read_b64_tr_b16 v[54:55], v31 offset:9472
    v_permlane16_swap_b32 v100, v102
    s_barrier
    v_mfma_f32_16x16x32_bf16 v[200:203], v[36:39], a[44:47], v[200:203]
    ds_read_b64_tr_b16 v[56:57], v24 offset:4096
    v_permlane16_swap_b32 v101, v103
    v_mfma_f32_16x16x32_bf16 v[192:195], v[36:39], a[40:43], v[192:195]
    ds_read_b64_tr_b16 v[58:59], v24 offset:4352
    buffer_load_dwordx4 a[120:123], v3, s[28:31], s7 offen offset:2048 sc1
    s_waitcnt lgkmcnt(6)
    v_mfma_f32_16x16x32_bf16 v[196:199], v[40:43], a[40:43], v[196:199]
    ds_read_b64_tr_b16 v[60:61], v25 offset:4096
    buffer_store_dwordx4 v[100:103], v4, s[28:31], s55 offen offset:0 sc1
    v_mfma_f32_16x16x32_bf16 v[204:207], v[40:43], a[44:47], v[204:207]
    ds_read_b64_tr_b16 v[62:63], v25 offset:4352
    v_and_b32 v14, 15, v1
    v_mfma_f32_16x16x32_bf16 v[216:219], v[44:47], a[44:47], v[216:219]
    ds_read_b64_tr_b16 v[32:33], v24 offset:8192
    buffer_load_dwordx4 a[124:127], v3, s[28:31], s7 offen offset:2304 sc1
    v_mfma_f32_16x16x32_bf16 v[208:211], v[44:47], a[40:43], v[208:211]
    ds_read_b64_tr_b16 v[34:35], v24 offset:8448
    v_mul_u32_u24 v14, 1152, v14
    s_waitcnt lgkmcnt(6)
    v_mfma_f32_16x16x32_bf16 v[212:215], v[48:51], a[40:43], v[212:215]
    ds_read_b64_tr_b16 v[36:37], v25 offset:8192
    v_bfe_u32 v10, v1, 4, 1
    v_mfma_f32_16x16x32_bf16 v[220:223], v[48:51], a[44:47], v[220:223]
    ds_read_b64_tr_b16 v[38:39], v25 offset:8448
    v_lshl_add_u32 v10, v10, 5, v14
    v_mfma_f32_16x16x32_bf16 v[228:231], v[52:55], a[44:47], v[228:231]
    ds_read_b64_tr_b16 v[40:41], v24 offset:12288
    s_add_u32 m0, s42, 151552
    v_mfma_f32_16x16x32_bf16 v[224:227], v[52:55], a[40:43], v[224:227]
    ds_read_b64_tr_b16 v[42:43], v24 offset:12544
    buffer_load_dwordx4 v9, s[64:67], s8 offen lds
    s_mul_i32 s40, s8, 18
    s_waitcnt vmcnt(29)
    s_waitcnt lgkmcnt(6)
    v_mfma_f32_16x16x32_bf16 v[176:179], v[56:59], a[48:51], v[176:179]
    ds_read_b64_tr_b16 v[44:45], v25 offset:12288
    v_lshrrev_b32 v11, 5, v1
    v_mfma_f32_16x16x32_bf16 v[184:187], v[56:59], a[52:55], v[184:187]
    ds_read_b64_tr_b16 v[46:47], v25 offset:12544
    v_lshl_add_u32 v10, v11, 4, v10
    v_mfma_f32_16x16x32_bf16 v[188:191], v[60:63], a[52:55], v[188:191]
    ds_read_b64_tr_b16 v[48:49], v31 offset:10240
    s_add_u32 m0, s42, 131072
    v_mfma_f32_16x16x32_bf16 v[180:183], v[60:63], a[48:51], v[180:183]
    ds_read_b64_tr_b16 v[50:51], v31 offset:10496
    buffer_load_dwordx4 v5, s[16:19], s40 offen lds
    s_waitcnt lgkmcnt(6)
    v_mfma_f32_16x16x32_bf16 v[192:195], v[32:35], a[48:51], v[192:195]
    ds_read_b64_tr_b16 v[52:53], v24 offset:6144
    s_mul_i32 s44, s13, 147456
    v_mfma_f32_16x16x32_bf16 v[200:203], v[32:35], a[52:55], v[200:203]
    ds_read_b64_tr_b16 v[54:55], v24 offset:6400
    s_mul_i32 s45, s3, 36864
    v_mfma_f32_16x16x32_bf16 v[204:207], v[36:39], a[52:55], v[204:207]
    ds_read_b64_tr_b16 v[56:57], v25 offset:6144
    s_add_u32 m0, s42, 135168
    v_mfma_f32_16x16x32_bf16 v[196:199], v[36:39], a[48:51], v[196:199]
    ds_read_b64_tr_b16 v[58:59], v25 offset:6400
    buffer_load_dwordx4 v6, s[16:19], s40 offen lds
    s_waitcnt lgkmcnt(6)
    v_mfma_f32_16x16x32_bf16 v[208:211], v[40:43], a[48:51], v[208:211]
    ds_read_b64_tr_b16 v[60:61], v24 offset:10240
    s_add_u32 s45, s45, s44
    v_mfma_f32_16x16x32_bf16 v[216:219], v[40:43], a[52:55], v[216:219]
    ds_read_b64_tr_b16 v[62:63], v24 offset:10496
    s_add_u32 s45, s45, s15
    v_mfma_f32_16x16x32_bf16 v[220:223], v[44:47], a[52:55], v[220:223]
    ds_read_b64_tr_b16 v[32:33], v25 offset:10240
    s_add_u32 m0, s42, 139264
    v_mfma_f32_16x16x32_bf16 v[212:215], v[44:47], a[48:51], v[212:215]
    ds_read_b64_tr_b16 v[34:35], v25 offset:10496
    buffer_load_dwordx4 v7, s[16:19], s40 offen lds
    s_waitcnt lgkmcnt(6)
    v_mfma_f32_16x16x32_bf16 v[224:227], v[48:51], a[48:51], v[224:227]
    ds_read_b64_tr_b16 v[36:37], v24 offset:14336
    s_lshl_b32 s46, s12, 6
    v_mfma_f32_16x16x32_bf16 v[228:231], v[48:51], a[52:55], v[228:231]
    ds_read_b64_tr_b16 v[38:39], v24 offset:14592
    s_add_u32 s45, s45, s46
    v_mfma_f32_16x16x32_bf16 v[184:187], v[52:55], a[60:63], v[184:187]
    ds_read_b64_tr_b16 v[40:41], v25 offset:14336
    s_add_u32 m0, s42, 143360
    v_mfma_f32_16x16x32_bf16 v[176:179], v[52:55], a[56:59], v[176:179]
    ds_read_b64_tr_b16 v[42:43], v25 offset:14592
    buffer_load_dwordx4 v8, s[16:19], s40 offen lds
    s_waitcnt lgkmcnt(6)
    v_mfma_f32_16x16x32_bf16 v[180:183], v[56:59], a[56:59], v[180:183]
    ds_read_b64_tr_b16 v[44:45], v31 offset:11264
    v_add_u32 v10, s45, v10
    v_mfma_f32_16x16x32_bf16 v[188:191], v[56:59], a[60:63], v[188:191]
    ds_read_b64_tr_b16 v[46:47], v31 offset:11520
    v_add_u32 v11, 18432, v10
    s_barrier
    v_mfma_f32_16x16x32_bf16 v[200:203], v[60:63], a[60:63], v[200:203]
    ds_read_b64_tr_b16 v[48:49], v24 offset:20480
    s_add_u32 m0, s42, 69632
    v_mfma_f32_16x16x32_bf16 v[192:195], v[60:63], a[56:59], v[192:195]
    ds_read_b64_tr_b16 v[50:51], v24 offset:20736
    buffer_load_dwordx4 v5, s[20:23], s40 offen lds
    s_waitcnt lgkmcnt(6)
    v_mfma_f32_16x16x32_bf16 v[196:199], v[32:35], a[56:59], v[196:199]
    ds_read_b64_tr_b16 v[52:53], v25 offset:20480
    v_lshrrev_b32 v12, 4, v1
    v_mfma_f32_16x16x32_bf16 v[204:207], v[32:35], a[60:63], v[204:207]
    ds_read_b64_tr_b16 v[54:55], v25 offset:20736
    v_lshl_add_u32 v12, v12, 3, v14
    v_mfma_f32_16x16x32_bf16 v[216:219], v[36:39], a[60:63], v[216:219]
    ds_read_b64_tr_b16 v[56:57], v24 offset:24576
    s_add_u32 m0, s42, 73728
    v_mfma_f32_16x16x32_bf16 v[208:211], v[36:39], a[56:59], v[208:211]
    ds_read_b64_tr_b16 v[58:59], v24 offset:24832
    buffer_load_dwordx4 v6, s[20:23], s40 offen lds
    s_waitcnt lgkmcnt(6)
    v_mfma_f32_16x16x32_bf16 v[212:215], v[40:43], a[56:59], v[212:215]
    ds_read_b64_tr_b16 v[60:61], v25 offset:24576
    s_lshl_b32 s45, s12, 1
    v_mfma_f32_16x16x32_bf16 v[220:223], v[40:43], a[60:63], v[220:223]
    ds_read_b64_tr_b16 v[62:63], v25 offset:24832
    s_lshr_b32 s46, s3, 1
    v_mfma_f32_16x16x32_bf16 v[228:231], v[44:47], a[60:63], v[228:231]
    ds_read_b64_tr_b16 v[32:33], v24 offset:28672
    s_add_u32 m0, s42, 77824
    v_mfma_f32_16x16x32_bf16 v[224:227], v[44:47], a[56:59], v[224:227]
    ds_read_b64_tr_b16 v[34:35], v24 offset:28928
    buffer_load_dwordx4 v7, s[20:23], s40 offen lds
    s_waitcnt vmcnt(32)
    s_waitcnt lgkmcnt(6)
    v_mfma_f32_16x16x32_bf16 v[176:179], v[48:51], a[64:67], v[176:179]
    ds_read_b64_tr_b16 v[36:37], v25 offset:28672
    s_add_u32 s45, s45, s46
    v_mfma_f32_16x16x32_bf16 v[184:187], v[48:51], a[68:71], v[184:187]
    ds_read_b64_tr_b16 v[38:39], v25 offset:28928
    s_mul_i32 s45, s45, 18432
    v_mfma_f32_16x16x32_bf16 v[188:191], v[52:55], a[68:71], v[188:191]
    ds_read_b64_tr_b16 v[40:41], v31 offset:12288
    s_add_u32 m0, s42, 86016
    v_mfma_f32_16x16x32_bf16 v[180:183], v[52:55], a[64:67], v[180:183]
    ds_read_b64_tr_b16 v[42:43], v31 offset:12544
    buffer_load_dwordx4 v8, s[20:23], s40 offen lds
    s_waitcnt lgkmcnt(6)
    v_mfma_f32_16x16x32_bf16 v[192:195], v[56:59], a[64:67], v[192:195]
    ds_read_b64_tr_b16 v[44:45], v24 offset:22528
    s_add_u32 s44, s44, s45
    v_mfma_f32_16x16x32_bf16 v[200:203], v[56:59], a[68:71], v[200:203]
    ds_read_b64_tr_b16 v[46:47], v24 offset:22784
    s_lshl_b32 s45, s14, 5
    v_mfma_f32_16x16x32_bf16 v[204:207], v[60:63], a[68:71], v[204:207]
    ds_read_b64_tr_b16 v[48:49], v25 offset:22528
    s_add_u32 s44, s44, s45
    v_mfma_f32_16x16x32_bf16 v[196:199], v[60:63], a[64:67], v[196:199]
    ds_read_b64_tr_b16 v[50:51], v25 offset:22784
    s_and_b32 s45, s3, 1
    s_waitcnt lgkmcnt(6)
    v_mfma_f32_16x16x32_bf16 v[208:211], v[32:35], a[64:67], v[208:211]
    s_branch K4_ps9
K4_pg9:
    s_branch K4_vrB
K4_ps9:
    ds_read_b64_tr_b16 v[52:53], v24 offset:26624
    s_lshl_b32 s45, s45, 2
    v_mfma_f32_16x16x32_bf16 v[216:219], v[32:35], a[68:71], v[216:219]
    ds_read_b64_tr_b16 v[54:55], v24 offset:26880
    s_add_u32 s44, s44, s45
    v_mfma_f32_16x16x32_bf16 v[220:223], v[36:39], a[68:71], v[220:223]
    ds_read_b64_tr_b16 v[56:57], v25 offset:26624
    s_add_u32 s44, s44, 1024
    v_mfma_f32_16x16x32_bf16 v[212:215], v[36:39], a[64:67], v[212:215]
    ds_read_b64_tr_b16 v[58:59], v25 offset:26880
    v_add_u32 v12, s44, v12
    s_waitcnt lgkmcnt(6)
    v_mfma_f32_16x16x32_bf16 v[224:227], v[40:43], a[64:67], v[224:227]
    ds_read_b64_tr_b16 v[60:61], v24 offset:30720
    s_lshl_b32 s44, s3, 11
    v_mfma_f32_16x16x32_bf16 v[228:231], v[40:43], a[68:71], v[228:231]
    ds_read_b64_tr_b16 v[62:63], v24 offset:30976
    v_add_u32 v13, s44, v4
    v_mfma_f32_16x16x32_bf16 v[184:187], v[44:47], a[76:79], v[184:187]
    ds_read_b64_tr_b16 v[32:33], v25 offset:30720
    v_and_b32 v14, 15, v1
    v_mfma_f32_16x16x32_bf16 v[176:179], v[44:47], a[72:75], v[176:179]
    ds_read_b64_tr_b16 v[34:35], v25 offset:30976
    v_lshlrev_b32 v14, 4, v14
    s_waitcnt lgkmcnt(6)
    v_mfma_f32_16x16x32_bf16 v[180:183], v[48:51], a[72:75], v[180:183]
    ds_read_b64_tr_b16 v[36:37], v31 offset:13312
    v_lshrrev_b32 v17, 5, v1
    v_mfma_f32_16x16x32_bf16 v[188:191], v[48:51], a[76:79], v[188:191]
    ds_read_b64_tr_b16 v[38:39], v31 offset:13568
    v_lshl_add_u32 v14, v17, 8, v14
    s_barrier
    v_mfma_f32_16x16x32_bf16 v[200:203], v[52:55], a[76:79], v[200:203]
    ds_read_b64_tr_b16 v[40:41], v24 offset:36864
    s_add_u32 m0, s42, 155648
    v_mfma_f32_16x16x32_bf16 v[192:195], v[52:55], a[72:75], v[192:195]
    ds_read_b64_tr_b16 v[42:43], v24 offset:37120
    buffer_load_dwordx4 v9, s[64:67], s9 offen lds
    s_mul_i32 s40, s9, 18
    s_waitcnt lgkmcnt(6)
    v_mfma_f32_16x16x32_bf16 v[196:199], v[56:59], a[72:75], v[196:199]
    ds_read_b64_tr_b16 v[44:45], v25 offset:36864
    buffer_load_dword v19, v23, s[72:75], s100 offen sc1
    v_mfma_f32_16x16x32_bf16 v[204:207], v[56:59], a[76:79], v[204:207]
    ds_read_b64_tr_b16 v[46:47], v25 offset:37120
    v_bfe_u32 v17, v1, 4, 1
    v_mfma_f32_16x16x32_bf16 v[216:219], v[60:63], a[76:79], v[216:219]
    ds_read_b64_tr_b16 v[48:49], v24 offset:40960
    s_add_u32 m0, s42, 90112
    v_mfma_f32_16x16x32_bf16 v[208:211], v[60:63], a[72:75], v[208:211]
    ds_read_b64_tr_b16 v[50:51], v24 offset:41216
    buffer_load_dwordx4 v5, s[16:19], s40 offen lds
    s_waitcnt lgkmcnt(6)
    v_mfma_f32_16x16x32_bf16 v[212:215], v[32:35], a[72:75], v[212:215]
    ds_read_b64_tr_b16 v[52:53], v25 offset:40960
    v_lshl_add_u32 v16, v17, 9, v14
    v_mfma_f32_16x16x32_bf16 v[220:223], v[32:35], a[76:79], v[220:223]
    ds_read_b64_tr_b16 v[54:55], v25 offset:41216
    v_lshl_add_u32 v18, v17, 3, v14
    v_mfma_f32_16x16x32_bf16 v[228:231], v[36:39], a[76:79], v[228:231]
    ds_read_b64_tr_b16 v[56:57], v24 offset:45056
    s_add_u32 m0, s42, 94208
    v_mfma_f32_16x16x32_bf16 v[224:227], v[36:39], a[72:75], v[224:227]
    ds_read_b64_tr_b16 v[58:59], v24 offset:45312
    buffer_load_dwordx4 v6, s[16:19], s40 offen lds
    s_waitcnt vmcnt(32)
    s_waitcnt lgkmcnt(6)
    v_mfma_f32_16x16x32_bf16 v[176:179], v[40:43], a[80:83], v[176:179]
    ds_read_b64_tr_b16 v[60:61], v25 offset:45056
    s_lshl_b32 s44, s13, 2
    v_mfma_f32_16x16x32_bf16 v[184:187], v[40:43], a[84:87], v[184:187]
    ds_read_b64_tr_b16 v[62:63], v25 offset:45312
    s_add_u32 s45, s44, s3
    v_mfma_f32_16x16x32_bf16 v[188:191], v[44:47], a[84:87], v[188:191]
    ds_read_b64_tr_b16 v[32:33], v31 offset:14336
    s_add_u32 m0, s42, 102400
    v_mfma_f32_16x16x32_bf16 v[180:183], v[44:47], a[80:83], v[180:183]
    ds_read_b64_tr_b16 v[34:35], v31 offset:14592
    buffer_load_dwordx4 v7, s[16:19], s40 offen lds
    s_waitcnt lgkmcnt(6)
    v_mfma_f32_16x16x32_bf16 v[192:195], v[48:51], a[80:83], v[192:195]
    ds_read_b64_tr_b16 v[36:37], v24 offset:38912
    s_mul_i32 s45, s45, 36864
    v_mfma_f32_16x16x32_bf16 v[200:203], v[48:51], a[84:87], v[200:203]
    ds_read_b64_tr_b16 v[38:39], v24 offset:39168
    s_lshl_b32 s46, s14, 12
    v_mfma_f32_16x16x32_bf16 v[204:207], v[52:55], a[84:87], v[204:207]
    ds_read_b64_tr_b16 v[40:41], v25 offset:38912
    s_add_u32 m0, s42, 106496
    v_mfma_f32_16x16x32_bf16 v[196:199], v[52:55], a[80:83], v[196:199]
    ds_read_b64_tr_b16 v[42:43], v25 offset:39168
    buffer_load_dwordx4 v8, s[16:19], s40 offen lds
    s_waitcnt lgkmcnt(6)
    v_mfma_f32_16x16x32_bf16 v[208:211], v[56:59], a[80:83], v[208:211]
    ds_read_b64_tr_b16 v[44:45], v24 offset:43008
    s_add_u32 s45, s45, s46
    v_mfma_f32_16x16x32_bf16 v[216:219], v[56:59], a[84:87], v[216:219]
    ds_read_b64_tr_b16 v[46:47], v24 offset:43264
    s_lshl_b32 s46, s12, 10
    v_mfma_f32_16x16x32_bf16 v[220:223], v[60:63], a[84:87], v[220:223]
    ds_read_b64_tr_b16 v[48:49], v25 offset:43008
    s_add_u32 m0, s42, 110592
    v_mfma_f32_16x16x32_bf16 v[212:215], v[60:63], a[80:83], v[212:215]
    ds_read_b64_tr_b16 v[50:51], v25 offset:43264
    buffer_load_dwordx4 v5, s[20:23], s40 offen lds
    s_waitcnt lgkmcnt(6)
    v_mfma_f32_16x16x32_bf16 v[224:227], v[32:35], a[80:83], v[224:227]
    ds_read_b64_tr_b16 v[52:53], v24 offset:47104
    s_add_u32 s45, s45, s46
    v_mfma_f32_16x16x32_bf16 v[228:231], v[32:35], a[84:87], v[228:231]
    ds_read_b64_tr_b16 v[54:55], v24 offset:47360
    v_add_u32 v16, s45, v16
    v_mfma_f32_16x16x32_bf16 v[184:187], v[36:39], a[92:95], v[184:187]
    ds_read_b64_tr_b16 v[56:57], v25 offset:47104
    s_add_u32 m0, s42, 4096
    v_mfma_f32_16x16x32_bf16 v[176:179], v[36:39], a[88:91], v[176:179]
    ds_read_b64_tr_b16 v[58:59], v25 offset:47360
    buffer_load_dwordx4 v6, s[20:23], s40 offen lds
    s_waitcnt lgkmcnt(6)
    v_mfma_f32_16x16x32_bf16 v[180:183], v[40:43], a[88:91], v[180:183]
    ds_read_b64_tr_b16 v[60:61], v31 offset:15360
    v_add_u32 v17, 18432, v16
    v_mfma_f32_16x16x32_bf16 v[188:191], v[40:43], a[92:95], v[188:191]
    ds_read_b64_tr_b16 v[62:63], v31 offset:15616
    s_add_u32 s44, s44, s12
    s_waitcnt vmcnt(31)
    s_barrier
    v_mfma_f32_16x16x32_bf16 v[200:203], v[44:47], a[92:95], v[200:203]
    ds_read_b64_tr_b16 v[32:33], v24 offset:53248
    s_add_u32 m0, s42, 8192
    v_mfma_f32_16x16x32_bf16 v[192:195], v[44:47], a[88:91], v[192:195]
    ds_read_b64_tr_b16 v[34:35], v24 offset:53504
    buffer_load_dwordx4 v7, s[20:23], s40 offen lds
    s_waitcnt lgkmcnt(6)
    v_mfma_f32_16x16x32_bf16 v[196:199], v[48:51], a[88:91], v[196:199]
    ds_read_b64_tr_b16 v[36:37], v25 offset:53248
    s_lshl_b32 s44, s44, 1
    v_mfma_f32_16x16x32_bf16 v[204:207], v[48:51], a[92:95], v[204:207]
    ds_read_b64_tr_b16 v[38:39], v25 offset:53504
    s_lshr_b32 s45, s3, 1
    v_mfma_f32_16x16x32_bf16 v[216:219], v[52:55], a[92:95], v[216:219]
    ds_read_b64_tr_b16 v[40:41], v24 offset:57344
    s_add_u32 m0, s42, 12288
    v_mfma_f32_16x16x32_bf16 v[208:211], v[52:55], a[88:91], v[208:211]
    ds_read_b64_tr_b16 v[42:43], v24 offset:57600
    buffer_load_dwordx4 v8, s[20:23], s40 offen lds
    s_waitcnt lgkmcnt(6)
    v_mfma_f32_16x16x32_bf16 v[212:215], v[56:59], a[88:91], v[212:215]
    ds_read_b64_tr_b16 v[44:45], v25 offset:57344
    s_add_u32 s44, s44, s45
    v_mfma_f32_16x16x32_bf16 v[220:223], v[56:59], a[92:95], v[220:223]
    ds_read_b64_tr_b16 v[46:47], v25 offset:57600
    s_mul_i32 s44, s44, 18432
    v_mfma_f32_16x16x32_bf16 v[228:231], v[60:63], a[92:95], v[228:231]
    ds_read_b64_tr_b16 v[48:49], v24 offset:61440
    s_lshl_b32 s45, s14, 9
    v_mfma_f32_16x16x32_bf16 v[224:227], v[60:63], a[88:91], v[224:227]
    ds_read_b64_tr_b16 v[50:51], v24 offset:61696
    s_add_u32 s44, s44, s45
    s_waitcnt vmcnt(8)
    v_cmp_ne_u32 vcc, v22, v19
    s_cbranch_vccnz K4_slow1
K4_ok1:
    s_waitcnt lgkmcnt(6)
    v_mfma_f32_16x16x32_bf16 v[176:179], v[32:35], a[96:99], v[176:179]
    ds_read_b64_tr_b16 v[52:53], v25 offset:61440
    buffer_load_dwordx4 a[128:131], v2, s[28:31], s8 offen offset:0 sc1
    v_mfma_f32_16x16x32_bf16 v[184:187], v[32:35], a[100:103], v[184:187]
    ds_read_b64_tr_b16 v[54:55], v25 offset:61696
    buffer_load_dwordx4 a[132:135], v2, s[28:31], s8 offen offset:256 sc1
    v_mfma_f32_16x16x32_bf16 v[188:191], v[36:39], a[100:103], v[188:191]
    ds_read_b64_tr_b16 v[56:57], v31 offset:0
    s_and_b32 s45, s3, 1
    v_mfma_f32_16x16x32_bf16 v[180:183], v[36:39], a[96:99], v[180:183]
    ds_read_b64_tr_b16 v[58:59], v31 offset:256
    s_lshl_b32 s45, s45, 2
    s_waitcnt lgkmcnt(6)
    v_mfma_f32_16x16x32_bf16 v[192:195], v[40:43], a[96:99], v[192:195]
    ds_read_b64_tr_b16 v[60:61], v24 offset:55296
    s_add_u32 s44, s44, s45
    v_mfma_f32_16x16x32_bf16 v[200:203], v[40:43], a[100:103], v[200:203]
    ds_read_b64_tr_b16 v[62:63], v24 offset:55552
    buffer_load_dwordx4 a[136:139], v2, s[28:31], s8 offen offset:2048 sc1
    v_mfma_f32_16x16x32_bf16 v[204:207], v[44:47], a[100:103], v[204:207]
    ds_read_b64_tr_b16 v[32:33], v25 offset:55296
    s_add_u32 s44, s44, 16384
    v_mfma_f32_16x16x32_bf16 v[196:199], v[44:47], a[96:99], v[196:199]
    ds_read_b64_tr_b16 v[34:35], v25 offset:55552
    v_add_u32 v18, s44, v18
    s_waitcnt lgkmcnt(6)
    v_mfma_f32_16x16x32_bf16 v[208:211], v[48:51], a[96:99], v[208:211]
    ds_read_b64_tr_b16 v[36:37], v24 offset:59392
    s_mov_b32 s32, s70
    v_mfma_f32_16x16x32_bf16 v[216:219], v[48:51], a[100:103], v[216:219]
    ds_read_b64_tr_b16 v[38:39], v24 offset:59648
    buffer_load_dwordx4 a[140:143], v2, s[28:31], s8 offen offset:2304 sc1
    v_mfma_f32_16x16x32_bf16 v[220:223], v[52:55], a[100:103], v[220:223]
    ds_read_b64_tr_b16 v[40:41], v25 offset:59392
    s_mov_b32 s33, s71
    v_mfma_f32_16x16x32_bf16 v[212:215], v[52:55], a[96:99], v[212:215]
    ds_read_b64_tr_b16 v[42:43], v25 offset:59648
    s_mov_b32 s34, 2359296
    s_waitcnt lgkmcnt(6)
    v_mfma_f32_16x16x32_bf16 v[224:227], v[56:59], a[96:99], v[224:227]
    ds_read_b64_tr_b16 v[44:45], v24 offset:63488
    s_xor_b32 s45, s12, 1
    v_mfma_f32_16x16x32_bf16 v[228:231], v[56:59], a[100:103], v[228:231]
    ds_read_b64_tr_b16 v[46:47], v24 offset:63744
    buffer_load_dwordx4 a[144:147], v3, s[28:31], s8 offen offset:0 sc1
    v_mfma_f32_16x16x32_bf16 v[184:187], v[60:63], a[108:111], v[184:187]
    ds_read_b64_tr_b16 v[48:49], v25 offset:63488
    s_mul_i32 s45, s45, 28672
    v_mfma_f32_16x16x32_bf16 v[176:179], v[60:63], a[104:107], v[176:179]
    ds_read_b64_tr_b16 v[50:51], v25 offset:63744
    s_add_u32 s45, s45, s48
    s_waitcnt lgkmcnt(6)
    v_mfma_f32_16x16x32_bf16 v[180:183], v[32:35], a[104:107], v[180:183]
    ds_read_b64_tr_b16 v[52:53], v31 offset:1024
    s_add_u32 s36, s45, 0
    v_mfma_f32_16x16x32_bf16 v[188:191], v[32:35], a[108:111], v[188:191]
    ds_read_b64_tr_b16 v[54:55], v31 offset:1280
    buffer_load_dwordx4 a[148:151], v3, s[28:31], s8 offen offset:256 sc1
    s_barrier
    v_mfma_f32_16x16x32_bf16 v[200:203], v[36:39], a[108:111], v[200:203]
    ds_read_b64_tr_b16 v[56:57], v26 offset:53248
    s_xor_b32 s45, s12, 2
    v_mfma_f32_16x16x32_bf16 v[192:195], v[36:39], a[104:107], v[192:195]
    ds_read_b64_tr_b16 v[58:59], v26 offset:53504
    s_mul_i32 s45, s45, 28672
    s_waitcnt lgkmcnt(6)
    v_mfma_f32_16x16x32_bf16 v[196:199], v[40:43], a[104:107], v[196:199]
    ds_read_b64_tr_b16 v[60:61], v27 offset:53248
    s_add_u32 s45, s45, s48
    v_mfma_f32_16x16x32_bf16 v[204:207], v[40:43], a[108:111], v[204:207]
    ds_read_b64_tr_b16 v[62:63], v27 offset:53504
    buffer_store_dword v22, v21, s[72:75], s101 offen sc1
    v_mfma_f32_16x16x32_bf16 v[216:219], v[44:47], a[108:111], v[216:219]
    ds_read_b64_tr_b16 v[32:33], v26 offset:57344
    s_add_u32 s37, s45, 8192
    v_mfma_f32_16x16x32_bf16 v[208:211], v[44:47], a[104:107], v[208:211]
    ds_read_b64_tr_b16 v[34:35], v26 offset:57600
    s_xor_b32 s45, s12, 3
    s_waitcnt lgkmcnt(6)
    v_mfma_f32_16x16x32_bf16 v[212:215], v[48:51], a[104:107], v[212:215]
    ds_read_b64_tr_b16 v[36:37], v27 offset:57344
    s_mul_i32 s45, s45, 28672
    v_mfma_f32_16x16x32_bf16 v[220:223], v[48:51], a[108:111], v[220:223]
    ds_read_b64_tr_b16 v[38:39], v27 offset:57600
    buffer_load_dwordx4 a[152:155], v3, s[28:31], s8 offen offset:2048 sc1
    v_mfma_f32_16x16x32_bf16 v[228:231], v[52:55], a[108:111], v[228:231]
    ds_read_b64_tr_b16 v[40:41], v26 offset:61440
    s_add_u32 s45, s45, s48
    v_mfma_f32_16x16x32_bf16 v[224:227], v[52:55], a[104:107], v[224:227]
    ds_read_b64_tr_b16 v[42:43], v26 offset:61696
    s_add_u32 s38, s45, 16384
    s_waitcnt lgkmcnt(6)
    v_mfma_f32_16x16x32_bf16 v[176:179], v[56:59], a[112:115], v[176:179]
    ds_read_b64_tr_b16 v[44:45], v27 offset:61440
    s_mul_i32 s45, s3, 26624
    v_mfma_f32_16x16x32_bf16 v[184:187], v[56:59], a[116:119], v[184:187]
    ds_read_b64_tr_b16 v[46:47], v27 offset:61696
    buffer_load_dwordx4 a[156:159], v3, s[28:31], s8 offen offset:2304 sc1
    v_mfma_f32_16x16x32_bf16 v[188:191], v[60:63], a[116:119], v[188:191]
    ds_read_b64_tr_b16 v[48:49], v31 offset:2048
    s_add_u32 s45, s45, s48
    v_mfma_f32_16x16x32_bf16 v[180:183], v[60:63], a[112:115], v[180:183]
    ds_read_b64_tr_b16 v[50:51], v31 offset:2304
    s_lshl_b32 s46, s12, 10
    s_waitcnt lgkmcnt(6)
    v_mfma_f32_16x16x32_bf16 v[192:195], v[32:35], a[112:115], v[192:195]
    ds_read_b64_tr_b16 v[52:53], v26 offset:55296
    s_add_u32 s45, s45, s46
    v_mfma_f32_16x16x32_bf16 v[200:203], v[32:35], a[116:119], v[200:203]
    ds_read_b64_tr_b16 v[54:55], v26 offset:55552
    buffer_load_dwordx4 a[160:163], v2, s[28:31], s9 offen offset:0 sc1
    v_mfma_f32_16x16x32_bf16 v[204:207], v[36:39], a[116:119], v[204:207]
    ds_read_b64_tr_b16 v[56:57], v27 offset:55296
    s_add_u32 s39, s45, 24576
    v_mfma_f32_16x16x32_bf16 v[196:199], v[36:39], a[112:115], v[196:199]
    ds_read_b64_tr_b16 v[58:59], v27 offset:55552
    s_mov_b32 s44, s49
    s_waitcnt lgkmcnt(6)
    v_mfma_f32_16x16x32_bf16 v[208:211], v[40:43], a[112:115], v[208:211]
    ds_read_b64_tr_b16 v[60:61], v26 offset:59392
    s_add_u32 s45, s49, 8192
    v_mfma_f32_16x16x32_bf16 v[216:219], v[40:43], a[116:119], v[216:219]
    ds_read_b64_tr_b16 v[62:63], v26 offset:59648
    buffer_load_dwordx4 a[164:167], v2, s[28:31], s9 offen offset:256 sc1
    v_mfma_f32_16x16x32_bf16 v[220:223], v[44:47], a[116:119], v[220:223]
    ds_read_b64_tr_b16 v[32:33], v27 offset:59392
    s_add_u32 s46, s49, 16384
    v_mfma_f32_16x16x32_bf16 v[212:215], v[44:47], a[112:115], v[212:215]
    ds_read_b64_tr_b16 v[34:35], v27 offset:59648
    s_mul_i32 s43, s3, 2044
    s_waitcnt lgkmcnt(6)
    v_mfma_f32_16x16x32_bf16 v[224:227], v[48:51], a[112:115], v[224:227]
    ds_read_b64_tr_b16 v[36:37], v26 offset:63488
    buffer_load_dwordx4 a[168:171], v2, s[28:31], s9 offen offset:2048 sc1
    v_mfma_f32_16x16x32_bf16 v[228:231], v[48:51], a[116:119], v[228:231]
    ds_read_b64_tr_b16 v[38:39], v26 offset:63744
    s_add_u32 s47, s49, 24576
    v_mfma_f32_16x16x32_bf16 v[184:187], v[52:55], a[124:127], v[184:187]
    ds_read_b64_tr_b16 v[40:41], v27 offset:63488
    s_sub_u32 s47, s47, s43
    v_mfma_f32_16x16x32_bf16 v[176:179], v[52:55], a[120:123], v[176:179]
    ds_read_b64_tr_b16 v[42:43], v27 offset:63744
    s_waitcnt lgkmcnt(6)
    v_mfma_f32_16x16x32_bf16 v[180:183], v[56:59], a[120:123], v[180:183]
    ds_read_b64_tr_b16 v[44:45], v31 offset:3072
    buffer_load_dwordx4 a[172:175], v2, s[28:31], s9 offen offset:2304 sc1
    v_mfma_f32_16x16x32_bf16 v[188:191], v[56:59], a[124:127], v[188:191]
    ds_read_b64_tr_b16 v[46:47], v31 offset:3328
    s_barrier
    v_mfma_f32_16x16x32_bf16 v[200:203], v[60:63], a[124:127], v[200:203]
    ds_read_b64_tr_b16 v[48:49], v28 offset:4096
    v_mfma_f32_16x16x32_bf16 v[192:195], v[60:63], a[120:123], v[192:195]
    ds_read_b64_tr_b16 v[50:51], v28 offset:4352
    s_waitcnt lgkmcnt(6)
    v_mfma_f32_16x16x32_bf16 v[196:199], v[32:35], a[120:123], v[196:199]
    ds_read_b64_tr_b16 v[52:53], v30 offset:4096
    buffer_load_dwordx4 a[176:179], v3, s[28:31], s9 offen offset:0 sc1
    v_mfma_f32_16x16x32_bf16 v[204:207], v[32:35], a[124:127], v[204:207]
    ds_read_b64_tr_b16 v[54:55], v30 offset:4352
    v_mfma_f32_16x16x32_bf16 v[216:219], v[36:39], a[124:127], v[216:219]
    ds_read_b64_tr_b16 v[56:57], v28 offset:8192
    v_mfma_f32_16x16x32_bf16 v[208:211], v[36:39], a[120:123], v[208:211]
    ds_read_b64_tr_b16 v[58:59], v28 offset:8448
    s_waitcnt lgkmcnt(6)
    v_mfma_f32_16x16x32_bf16 v[212:215], v[40:43], a[120:123], v[212:215]
    ds_read_b64_tr_b16 v[60:61], v30 offset:8192
    buffer_load_dwordx4 a[180:183], v3, s[28:31], s9 offen offset:256 sc1
    v_mfma_f32_16x16x32_bf16 v[220:223], v[40:43], a[124:127], v[220:223]
    ds_read_b64_tr_b16 v[62:63], v30 offset:8448
    v_mfma_f32_16x16x32_bf16 v[228:231], v[44:47], a[124:127], v[228:231]
    ds_read_b64_tr_b16 v[32:33], v28 offset:12288
    v_mfma_f32_16x16x32_bf16 v[224:227], v[44:47], a[120:123], v[224:227]
    ds_read_b64_tr_b16 v[34:35], v28 offset:12544
    s_waitcnt vmcnt(11)
    s_waitcnt lgkmcnt(6)
    v_mfma_f32_16x16x32_bf16 v[176:179], v[48:51], a[128:131], v[176:179]
    ds_read_b64_tr_b16 v[36:37], v30 offset:12288
    buffer_load_dwordx4 a[184:187], v3, s[28:31], s9 offen offset:2048 sc1
    v_mfma_f32_16x16x32_bf16 v[184:187], v[48:51], a[132:135], v[184:187]
    ds_read_b64_tr_b16 v[38:39], v30 offset:12544
    v_mfma_f32_16x16x32_bf16 v[188:191], v[52:55], a[132:135], v[188:191]
    ds_read_b64_tr_b16 v[40:41], v31 offset:4096
    v_mfma_f32_16x16x32_bf16 v[180:183], v[52:55], a[128:131], v[180:183]
    ds_read_b64_tr_b16 v[42:43], v31 offset:4352
    s_waitcnt lgkmcnt(6)
    v_mfma_f32_16x16x32_bf16 v[192:195], v[56:59], a[128:131], v[192:195]
    ds_read_b64_tr_b16 v[44:45], v28 offset:6144
    buffer_load_dwordx4 a[188:191], v3, s[28:31], s9 offen offset:2304 sc1
    v_mfma_f32_16x16x32_bf16 v[200:203], v[56:59], a[132:135], v[200:203]
    ds_read_b64_tr_b16 v[46:47], v28 offset:6400
    v_mfma_f32_16x16x32_bf16 v[204:207], v[60:63], a[132:135], v[204:207]
    ds_read_b64_tr_b16 v[48:49], v30 offset:6144
    v_mfma_f32_16x16x32_bf16 v[196:199], v[60:63], a[128:131], v[196:199]
    ds_read_b64_tr_b16 v[50:51], v30 offset:6400
    s_waitcnt lgkmcnt(6)
    v_mfma_f32_16x16x32_bf16 v[208:211], v[32:35], a[128:131], v[208:211]
    ds_read_b64_tr_b16 v[52:53], v28 offset:10240
    s_add_u32 m0, s42, 159744
    v_mfma_f32_16x16x32_bf16 v[216:219], v[32:35], a[132:135], v[216:219]
    ds_read_b64_tr_b16 v[54:55], v28 offset:10496
    buffer_load_dwordx4 v9, s[64:67], s76 offen lds
    s_mul_i32 s40, s76, 18
    v_mfma_f32_16x16x32_bf16 v[220:223], v[36:39], a[132:135], v[220:223]
    ds_read_b64_tr_b16 v[56:57], v30 offset:10240
    v_mfma_f32_16x16x32_bf16 v[212:215], v[36:39], a[128:131], v[212:215]
    ds_read_b64_tr_b16 v[58:59], v30 offset:10496
    s_waitcnt lgkmcnt(6)
    v_mfma_f32_16x16x32_bf16 v[224:227], v[40:43], a[128:131], v[224:227]
    ds_read_b64_tr_b16 v[60:61], v28 offset:14336
    s_add_u32 m0, s42, 20480
    v_mfma_f32_16x16x32_bf16 v[228:231], v[40:43], a[132:135], v[228:231]
    ds_read_b64_tr_b16 v[62:63], v28 offset:14592
    buffer_load_dwordx4 v5, s[16:19], s40 offen lds
    v_mfma_f32_16x16x32_bf16 v[184:187], v[44:47], a[140:143], v[184:187]
    ds_read_b64_tr_b16 v[32:33], v30 offset:14336
    v_mfma_f32_16x16x32_bf16 v[176:179], v[44:47], a[136:139], v[176:179]
    ds_read_b64_tr_b16 v[34:35], v30 offset:14592
    s_waitcnt lgkmcnt(6)
    v_mfma_f32_16x16x32_bf16 v[180:183], v[48:51], a[136:139], v[180:183]
    ds_read_b64_tr_b16 v[36:37], v31 offset:5120
    s_add_u32 m0, s42, 24576
    v_mfma_f32_16x16x32_bf16 v[188:191], v[48:51], a[140:143], v[188:191]
    ds_read_b64_tr_b16 v[38:39], v31 offset:5376
    buffer_load_dwordx4 v6, s[16:19], s40 offen lds
    s_barrier
    v_mfma_f32_16x16x32_bf16 v[200:203], v[52:55], a[140:143], v[200:203]
    ds_read_b64_tr_b16 v[40:41], v26 offset:8192
    v_mfma_f32_16x16x32_bf16 v[192:195], v[52:55], a[136:139], v[192:195]
    ds_read_b64_tr_b16 v[42:43], v26 offset:8448
    s_waitcnt lgkmcnt(6)
    v_mfma_f32_16x16x32_bf16 v[196:199], v[56:59], a[136:139], v[196:199]
    ds_read_b64_tr_b16 v[44:45], v27 offset:8192
    s_add_u32 m0, s42, 28672
    v_mfma_f32_16x16x32_bf16 v[204:207], v[56:59], a[140:143], v[204:207]
    ds_read_b64_tr_b16 v[46:47], v27 offset:8448
    buffer_load_dwordx4 v7, s[16:19], s40 offen lds
    v_mfma_f32_16x16x32_bf16 v[216:219], v[60:63], a[140:143], v[216:219]
    ds_read_b64_tr_b16 v[48:49], v26 offset:12288
    v_mfma_f32_16x16x32_bf16 v[208:211], v[60:63], a[136:139], v[208:211]
    ds_read_b64_tr_b16 v[50:51], v26 offset:12544
    s_add_u32 m0, s42, 36864
    s_waitcnt lgkmcnt(6)
    v_mfma_f32_16x16x32_bf16 v[212:215], v[32:35], a[136:139], v[212:215]
    ds_read_b64_tr_b16 v[52:53], v27 offset:12288
    buffer_load_dwordx4 v8, s[16:19], s40 offen lds
    v_mfma_f32_16x16x32_bf16 v[220:223], v[32:35], a[140:143], v[220:223]
    ds_read_b64_tr_b16 v[54:55], v27 offset:12544
    v_mfma_f32_16x16x32_bf16 v[228:231], v[36:39], a[140:143], v[228:231]
    ds_read_b64_tr_b16 v[56:57], v26 offset:20480
    v_mfma_f32_16x16x32_bf16 v[224:227], v[36:39], a[136:139], v[224:227]
    ds_read_b64_tr_b16 v[58:59], v26 offset:20736
    buffer_load_dwordx4 a[192:195], v2, s[28:31], s76 offen offset:0 sc1
    s_waitcnt vmcnt(14)
    s_waitcnt lgkmcnt(6)
    v_mfma_f32_16x16x32_bf16 v[176:179], v[40:43], a[144:147], v[176:179]
    ds_read_b64_tr_b16 v[60:61], v27 offset:20480
    v_mfma_f32_16x16x32_bf16 v[184:187], v[40:43], a[148:151], v[184:187]
    ds_read_b64_tr_b16 v[62:63], v27 offset:20736
    v_mfma_f32_16x16x32_bf16 v[188:191], v[44:47], a[148:151], v[188:191]
    ds_read_b64_tr_b16 v[32:33], v31 offset:6144
    v_mfma_f32_16x16x32_bf16 v[180:183], v[44:47], a[144:147], v[180:183]
    ds_read_b64_tr_b16 v[34:35], v31 offset:6400
    buffer_load_dwordx4 a[196:199], v2, s[28:31], s76 offen offset:256 sc1
    s_waitcnt lgkmcnt(6)
    v_mfma_f32_16x16x32_bf16 v[192:195], v[48:51], a[144:147], v[192:195]
    ds_read_b64_tr_b16 v[36:37], v26 offset:10240
    v_mfma_f32_16x16x32_bf16 v[200:203], v[48:51], a[148:151], v[200:203]
    ds_read_b64_tr_b16 v[38:39], v26 offset:10496
    v_mfma_f32_16x16x32_bf16 v[204:207], v[52:55], a[148:151], v[204:207]
    ds_read_b64_tr_b16 v[40:41], v27 offset:10240
    v_mfma_f32_16x16x32_bf16 v[196:199], v[52:55], a[144:147], v[196:199]
    ds_read_b64_tr_b16 v[42:43], v27 offset:10496
    buffer_load_dwordx4 a[200:203], v2, s[28:31], s76 offen offset:2048 sc1
    s_waitcnt lgkmcnt(6)
    v_mfma_f32_16x16x32_bf16 v[208:211], v[56:59], a[144:147], v[208:211]
    ds_read_b64_tr_b16 v[44:45], v26 offset:14336
    v_mfma_f32_16x16x32_bf16 v[216:219], v[56:59], a[148:151], v[216:219]
    ds_read_b64_tr_b16 v[46:47], v26 offset:14592
    v_mfma_f32_16x16x32_bf16 v[220:223], v[60:63], a[148:151], v[220:223]
    ds_read_b64_tr_b16 v[48:49], v27 offset:14336
    v_mfma_f32_16x16x32_bf16 v[212:215], v[60:63], a[144:147], v[212:215]
    ds_read_b64_tr_b16 v[50:51], v27 offset:14592
    buffer_load_dwordx4 a[204:207], v2, s[28:31], s76 offen offset:2304 sc1
    s_waitcnt lgkmcnt(6)
    v_mfma_f32_16x16x32_bf16 v[224:227], v[32:35], a[144:147], v[224:227]
    ds_read_b64_tr_b16 v[52:53], v26 offset:22528
    v_mfma_f32_16x16x32_bf16 v[228:231], v[32:35], a[148:151], v[228:231]
    ds_read_b64_tr_b16 v[54:55], v26 offset:22784
    v_mfma_f32_16x16x32_bf16 v[184:187], v[36:39], a[156:159], v[184:187]
    ds_read_b64_tr_b16 v[56:57], v27 offset:22528
    v_mfma_f32_16x16x32_bf16 v[176:179], v[36:39], a[152:155], v[176:179]
    ds_read_b64_tr_b16 v[58:59], v27 offset:22784
    s_add_u32 m0, s42, 40960
    s_waitcnt lgkmcnt(6)
    v_mfma_f32_16x16x32_bf16 v[180:183], v[40:43], a[152:155], v[180:183]
    ds_read_b64_tr_b16 v[60:61], v31 offset:7168
    buffer_load_dwordx4 v5, s[20:23], s40 offen lds
    v_mfma_f32_16x16x32_bf16 v[188:191], v[40:43], a[156:159], v[188:191]
    ds_read_b64_tr_b16 v[62:63], v31 offset:7424
    s_barrier
    v_mfma_f32_16x16x32_bf16 v[200:203], v[44:47], a[156:159], v[200:203]
    ds_read_b64_tr_b16 v[32:33], v26 offset:28672
    v_mfma_f32_16x16x32_bf16 v[192:195], v[44:47], a[152:155], v[192:195]
    ds_read_b64_tr_b16 v[34:35], v26 offset:28928
    s_add_u32 m0, s42, 45056
    s_waitcnt lgkmcnt(6)
    v_mfma_f32_16x16x32_bf16 v[196:199], v[48:51], a[152:155], v[196:199]
    ds_read_b64_tr_b16 v[36:37], v27 offset:28672
    buffer_load_dwordx4 v6, s[20:23], s40 offen lds
    v_mfma_f32_16x16x32_bf16 v[204:207], v[48:51], a[156:159], v[204:207]
    ds_read_b64_tr_b16 v[38:39], v27 offset:28928
    v_mfma_f32_16x16x32_bf16 v[216:219], v[52:55], a[156:159], v[216:219]
    ds_read_b64_tr_b16 v[40:41], v26 offset:36864
    v_mfma_f32_16x16x32_bf16 v[208:211], v[52:55], a[152:155], v[208:211]
    ds_read_b64_tr_b16 v[42:43], v26 offset:37120
    s_add_u32 m0, s42, 53248
    s_waitcnt lgkmcnt(6)
    v_mfma_f32_16x16x32_bf16 v[212:215], v[56:59], a[152:155], v[212:215]
    ds_read_b64_tr_b16 v[44:45], v27 offset:36864
    buffer_load_dwordx4 v7, s[20:23], s40 offen lds
    v_mfma_f32_16x16x32_bf16 v[220:223], v[56:59], a[156:159], v[220:223]
    ds_read_b64_tr_b16 v[46:47], v27 offset:37120
    v_mfma_f32_16x16x32_bf16 v[228:231], v[60:63], a[156:159], v[228:231]
    ds_read_b64_tr_b16 v[48:49], v26 offset:40960
    v_mfma_f32_16x16x32_bf16 v[224:227], v[60:63], a[152:155], v[224:227]
    ds_read_b64_tr_b16 v[50:51], v26 offset:41216
    s_add_u32 m0, s42, 57344
    s_waitcnt vmcnt(16)
    s_waitcnt lgkmcnt(6)
    v_mfma_f32_16x16x32_bf16 v[176:179], v[32:35], a[160:163], v[176:179]
    ds_read_b64_tr_b16 v[52:53], v27 offset:40960
    buffer_load_dwordx4 v8, s[20:23], s40 offen lds
    v_mfma_f32_16x16x32_bf16 v[184:187], v[32:35], a[164:167], v[184:187]
    ds_read_b64_tr_b16 v[54:55], v27 offset:41216
    v_mfma_f32_16x16x32_bf16 v[188:191], v[36:39], a[164:167], v[188:191]
    ds_read_b64_tr_b16 v[56:57], v31 offset:8192
    v_mfma_f32_16x16x32_bf16 v[180:183], v[36:39], a[160:163], v[180:183]
    ds_read_b64_tr_b16 v[58:59], v31 offset:8448
    buffer_load_dwordx4 a[208:211], v3, s[28:31], s76 offen offset:0 sc1
    s_waitcnt lgkmcnt(6)
    v_mfma_f32_16x16x32_bf16 v[192:195], v[40:43], a[160:163], v[192:195]
    ds_read_b64_tr_b16 v[60:61], v26 offset:30720
    v_mfma_f32_16x16x32_bf16 v[200:203], v[40:43], a[164:167], v[200:203]
    ds_read_b64_tr_b16 v[62:63], v26 offset:30976
    v_mfma_f32_16x16x32_bf16 v[204:207], v[44:47], a[164:167], v[204:207]
    ds_read_b64_tr_b16 v[32:33], v27 offset:30720
    buffer_load_dwordx4 a[212:215], v3, s[28:31], s76 offen offset:256 sc1
    v_mfma_f32_16x16x32_bf16 v[196:199], v[44:47], a[160:163], v[196:199]
    ds_read_b64_tr_b16 v[34:35], v27 offset:30976
    s_waitcnt lgkmcnt(6)
    v_mfma_f32_16x16x32_bf16 v[208:211], v[48:51], a[160:163], v[208:211]
    ds_read_b64_tr_b16 v[36:37], v26 offset:38912
    v_mfma_f32_16x16x32_bf16 v[216:219], v[48:51], a[164:167], v[216:219]
    ds_read_b64_tr_b16 v[38:39], v26 offset:39168
    v_mfma_f32_16x16x32_bf16 v[220:223], v[52:55], a[164:167], v[220:223]
    ds_read_b64_tr_b16 v[40:41], v27 offset:38912
    buffer_load_dwordx4 a[216:219], v3, s[28:31], s76 offen offset:2048 sc1
    v_mfma_f32_16x16x32_bf16 v[212:215], v[52:55], a[160:163], v[212:215]
    ds_read_b64_tr_b16 v[42:43], v27 offset:39168
    s_waitcnt lgkmcnt(6)
    v_mfma_f32_16x16x32_bf16 v[224:227], v[56:59], a[160:163], v[224:227]
    ds_read_b64_tr_b16 v[44:45], v26 offset:43008
    v_mfma_f32_16x16x32_bf16 v[228:231], v[56:59], a[164:167], v[228:231]
    ds_read_b64_tr_b16 v[46:47], v26 offset:43264
    v_mfma_f32_16x16x32_bf16 v[184:187], v[60:63], a[172:175], v[184:187]
    ds_read_b64_tr_b16 v[48:49], v27 offset:43008
    buffer_load_dwordx4 a[220:223], v3, s[28:31], s76 offen offset:2304 sc1
    v_mfma_f32_16x16x32_bf16 v[176:179], v[60:63], a[168:171], v[176:179]
    ds_read_b64_tr_b16 v[50:51], v27 offset:43264
    s_waitcnt lgkmcnt(6)
    v_mfma_f32_16x16x32_bf16 v[180:183], v[32:35], a[168:171], v[180:183]
    ds_read_b64_tr_b16 v[52:53], v31 offset:9216
    v_mfma_f32_16x16x32_bf16 v[188:191], v[32:35], a[172:175], v[188:191]
    ds_read_b64_tr_b16 v[54:55], v31 offset:9472
    s_barrier
    v_mfma_f32_16x16x32_bf16 v[200:203], v[36:39], a[172:175], v[200:203]
    ds_read_b64_tr_b16 v[56:57], v24 offset:4096
    s_add_u32 m0, s42, 147456
    v_mfma_f32_16x16x32_bf16 v[192:195], v[36:39], a[168:171], v[192:195]
    ds_read_b64_tr_b16 v[58:59], v24 offset:4352
    buffer_load_dwordx4 v9, s[64:67], s77 offen lds
    s_mul_i32 s40, s77, 18
    s_waitcnt lgkmcnt(6)
    v_mfma_f32_16x16x32_bf16 v[196:199], v[40:43], a[168:171], v[196:199]
    ds_read_b64_tr_b16 v[60:61], v25 offset:4096
    v_mfma_f32_16x16x32_bf16 v[204:207], v[40:43], a[172:175], v[204:207]
    ds_read_b64_tr_b16 v[62:63], v25 offset:4352
    v_mfma_f32_16x16x32_bf16 v[216:219], v[44:47], a[172:175], v[216:219]
    ds_read_b64_tr_b16 v[32:33], v24 offset:8192
    buffer_load_dword v19, v15, s[72:75], s101 offen sc1
    v_mfma_f32_16x16x32_bf16 v[208:211], v[44:47], a[168:171], v[208:211]
    ds_read_b64_tr_b16 v[34:35], v24 offset:8448
    s_waitcnt lgkmcnt(6)
    v_mfma_f32_16x16x32_bf16 v[212:215], v[48:51], a[168:171], v[212:215]
    ds_read_b64_tr_b16 v[36:37], v25 offset:8192
    v_mfma_f32_16x16x32_bf16 v[220:223], v[48:51], a[172:175], v[220:223]
    ds_read_b64_tr_b16 v[38:39], v25 offset:8448
    v_mfma_f32_16x16x32_bf16 v[228:231], v[52:55], a[172:175], v[228:231]
    s_branch K4_ps10
K4_pg10:
    s_branch K4_vrB
K4_ps10:
    ds_read_b64_tr_b16 v[40:41], v24 offset:12288
    s_add_u32 m0, s42, 61440
    v_mfma_f32_16x16x32_bf16 v[224:227], v[52:55], a[168:171], v[224:227]
    ds_read_b64_tr_b16 v[42:43], v24 offset:12544
    buffer_load_dwordx4 v5, s[16:19], s40 offen lds
    s_waitcnt vmcnt(20)
    s_waitcnt lgkmcnt(6)
    v_mfma_f32_16x16x32_bf16 v[176:179], v[56:59], a[176:179], v[176:179]
    ds_read_b64_tr_b16 v[44:45], v25 offset:12288
    v_mfma_f32_16x16x32_bf16 v[184:187], v[56:59], a[180:183], v[184:187]
    ds_read_b64_tr_b16 v[46:47], v25 offset:12544
    v_mfma_f32_16x16x32_bf16 v[188:191], v[60:63], a[180:183], v[188:191]
    ds_read_b64_tr_b16 v[48:49], v31 offset:10240
    s_add_u32 m0, s42, 118784
    v_mfma_f32_16x16x32_bf16 v[180:183], v[60:63], a[176:179], v[180:183]
    ds_read_b64_tr_b16 v[50:51], v31 offset:10496
    buffer_load_dwordx4 v6, s[16:19], s40 offen lds
    s_waitcnt lgkmcnt(6)
    v_mfma_f32_16x16x32_bf16 v[192:195], v[32:35], a[176:179], v[192:195]
    ds_read_b64_tr_b16 v[52:53], v24 offset:6144
    v_mfma_f32_16x16x32_bf16 v[200:203], v[32:35], a[180:183], v[200:203]
    ds_read_b64_tr_b16 v[54:55], v24 offset:6400
    v_mfma_f32_16x16x32_bf16 v[204:207], v[36:39], a[180:183], v[204:207]
    ds_read_b64_tr_b16 v[56:57], v25 offset:6144
    s_add_u32 m0, s42, 122880
    v_mfma_f32_16x16x32_bf16 v[196:199], v[36:39], a[176:179], v[196:199]
    ds_read_b64_tr_b16 v[58:59], v25 offset:6400
    buffer_load_dwordx4 v7, s[16:19], s40 offen lds
    s_waitcnt lgkmcnt(6)
    v_mfma_f32_16x16x32_bf16 v[208:211], v[40:43], a[176:179], v[208:211]
    ds_read_b64_tr_b16 v[60:61], v24 offset:10240
    v_mfma_f32_16x16x32_bf16 v[216:219], v[40:43], a[180:183], v[216:219]
    ds_read_b64_tr_b16 v[62:63], v24 offset:10496
    v_mfma_f32_16x16x32_bf16 v[220:223], v[44:47], a[180:183], v[220:223]
    ds_read_b64_tr_b16 v[32:33], v25 offset:10240
    s_add_u32 m0, s42, 126976
    v_mfma_f32_16x16x32_bf16 v[212:215], v[44:47], a[176:179], v[212:215]
    ds_read_b64_tr_b16 v[34:35], v25 offset:10496
    buffer_load_dwordx4 v8, s[16:19], s40 offen lds
    s_waitcnt lgkmcnt(6)
    v_mfma_f32_16x16x32_bf16 v[224:227], v[48:51], a[176:179], v[224:227]
    ds_read_b64_tr_b16 v[36:37], v24 offset:14336
    v_mfma_f32_16x16x32_bf16 v[228:231], v[48:51], a[180:183], v[228:231]
    ds_read_b64_tr_b16 v[38:39], v24 offset:14592
    buffer_load_dwordx4 a[224:227], v2, s[28:31], s77 offen offset:0 sc1
    v_mfma_f32_16x16x32_bf16 v[184:187], v[52:55], a[188:191], v[184:187]
    ds_read_b64_tr_b16 v[40:41], v25 offset:14336
    v_mfma_f32_16x16x32_bf16 v[176:179], v[52:55], a[184:187], v[176:179]
    ds_read_b64_tr_b16 v[42:43], v25 offset:14592
    s_waitcnt lgkmcnt(6)
    v_mfma_f32_16x16x32_bf16 v[180:183], v[56:59], a[184:187], v[180:183]
    ds_read_b64_tr_b16 v[44:45], v31 offset:11264
    v_mfma_f32_16x16x32_bf16 v[188:191], v[56:59], a[188:191], v[188:191]
    ds_read_b64_tr_b16 v[46:47], v31 offset:11520
    buffer_load_dwordx4 a[228:231], v2, s[28:31], s77 offen offset:256 sc1
    s_waitcnt vmcnt(20)
    s_barrier
    v_mfma_f32_16x16x32_bf16 v[200:203], v[60:63], a[188:191], v[200:203]
    ds_read_b64_tr_b16 v[48:49], v24 offset:24576
    v_mfma_f32_16x16x32_bf16 v[192:195], v[60:63], a[184:187], v[192:195]
    ds_read_b64_tr_b16 v[50:51], v24 offset:24832
    s_waitcnt lgkmcnt(6)
    v_mfma_f32_16x16x32_bf16 v[196:199], v[32:35], a[184:187], v[196:199]
    ds_read_b64_tr_b16 v[52:53], v25 offset:24576
    v_mfma_f32_16x16x32_bf16 v[204:207], v[32:35], a[188:191], v[204:207]
    ds_read_b64_tr_b16 v[54:55], v25 offset:24832
    buffer_load_dwordx4 a[232:235], v2, s[28:31], s77 offen offset:2048 sc1
    v_mfma_f32_16x16x32_bf16 v[216:219], v[36:39], a[188:191], v[216:219]
    ds_read_b64_tr_b16 v[56:57], v24 offset:28672
    v_mfma_f32_16x16x32_bf16 v[208:211], v[36:39], a[184:187], v[208:211]
    ds_read_b64_tr_b16 v[58:59], v24 offset:28928
    s_waitcnt lgkmcnt(6)
    v_mfma_f32_16x16x32_bf16 v[212:215], v[40:43], a[184:187], v[212:215]
    ds_read_b64_tr_b16 v[60:61], v25 offset:28672
    v_mfma_f32_16x16x32_bf16 v[220:223], v[40:43], a[188:191], v[220:223]
    ds_read_b64_tr_b16 v[62:63], v25 offset:28928
    buffer_load_dwordx4 a[236:239], v2, s[28:31], s77 offen offset:2304 sc1
    v_mfma_f32_16x16x32_bf16 v[228:231], v[44:47], a[188:191], v[228:231]
    ds_read_b64_tr_b16 v[32:33], v24 offset:36864
    v_mfma_f32_16x16x32_bf16 v[224:227], v[44:47], a[184:187], v[224:227]
    ds_read_b64_tr_b16 v[34:35], v24 offset:37120
    s_waitcnt vmcnt(18)
    s_waitcnt lgkmcnt(6)
    v_mfma_f32_16x16x32_bf16 v[176:179], v[48:51], a[192:195], v[176:179]
    ds_read_b64_tr_b16 v[36:37], v25 offset:36864
    v_mfma_f32_16x16x32_bf16 v[184:187], v[48:51], a[196:199], v[184:187]
    ds_read_b64_tr_b16 v[38:39], v25 offset:37120
    s_add_u32 m0, s42, 135168
    v_mfma_f32_16x16x32_bf16 v[188:191], v[52:55], a[196:199], v[188:191]
    ds_read_b64_tr_b16 v[40:41], v31 offset:12288
    buffer_load_dwordx4 v5, s[20:23], s40 offen lds
    v_mfma_f32_16x16x32_bf16 v[180:183], v[52:55], a[192:195], v[180:183]
    ds_read_b64_tr_b16 v[42:43], v31 offset:12544
    s_waitcnt lgkmcnt(6)
    v_mfma_f32_16x16x32_bf16 v[192:195], v[56:59], a[192:195], v[192:195]
    ds_read_b64_tr_b16 v[44:45], v24 offset:26624
    v_mfma_f32_16x16x32_bf16 v[200:203], v[56:59], a[196:199], v[200:203]
    ds_read_b64_tr_b16 v[46:47], v24 offset:26880
    s_add_u32 m0, s42, 139264
    v_mfma_f32_16x16x32_bf16 v[204:207], v[60:63], a[196:199], v[204:207]
    ds_read_b64_tr_b16 v[48:49], v25 offset:26624
    buffer_load_dwordx4 v6, s[20:23], s40 offen lds
    v_mfma_f32_16x16x32_bf16 v[196:199], v[60:63], a[192:195], v[196:199]
    ds_read_b64_tr_b16 v[50:51], v25 offset:26880
    s_waitcnt lgkmcnt(6)
    v_mfma_f32_16x16x32_bf16 v[208:211], v[32:35], a[192:195], v[208:211]
    ds_read_b64_tr_b16 v[52:53], v24 offset:30720
    v_mfma_f32_16x16x32_bf16 v[216:219], v[32:35], a[196:199], v[216:219]
    ds_read_b64_tr_b16 v[54:55], v24 offset:30976
    s_add_u32 m0, s42, 143360
    v_mfma_f32_16x16x32_bf16 v[220:223], v[36:39], a[196:199], v[220:223]
    ds_read_b64_tr_b16 v[56:57], v25 offset:30720
    buffer_load_dwordx4 v7, s[20:23], s40 offen lds
    v_mfma_f32_16x16x32_bf16 v[212:215], v[36:39], a[192:195], v[212:215]
    ds_read_b64_tr_b16 v[58:59], v25 offset:30976
    s_waitcnt lgkmcnt(6)
    v_mfma_f32_16x16x32_bf16 v[224:227], v[40:43], a[192:195], v[224:227]
    ds_read_b64_tr_b16 v[60:61], v24 offset:38912
    v_mfma_f32_16x16x32_bf16 v[228:231], v[40:43], a[196:199], v[228:231]
    ds_read_b64_tr_b16 v[62:63], v24 offset:39168
    s_add_u32 m0, s42, 73728
    v_mfma_f32_16x16x32_bf16 v[184:187], v[44:47], a[204:207], v[184:187]
    ds_read_b64_tr_b16 v[32:33], v25 offset:38912
    buffer_load_dwordx4 v8, s[20:23], s40 offen lds
    v_mfma_f32_16x16x32_bf16 v[176:179], v[44:47], a[200:203], v[176:179]
    ds_read_b64_tr_b16 v[34:35], v25 offset:39168
    s_waitcnt lgkmcnt(6)
    v_mfma_f32_16x16x32_bf16 v[180:183], v[48:51], a[200:203], v[180:183]
    ds_read_b64_tr_b16 v[36:37], v31 offset:13312
    v_mfma_f32_16x16x32_bf16 v[188:191], v[48:51], a[204:207], v[188:191]
    ds_read_b64_tr_b16 v[38:39], v31 offset:13568
    buffer_load_dwordx4 a[240:243], v3, s[28:31], s77 offen offset:0 sc1
    s_waitcnt vmcnt(19)
    s_barrier
    v_mfma_f32_16x16x32_bf16 v[200:203], v[52:55], a[204:207], v[200:203]
    ds_read_b64_tr_b16 v[40:41], v24 offset:45056
    v_mfma_f32_16x16x32_bf16 v[192:195], v[52:55], a[200:203], v[192:195]
    ds_read_b64_tr_b16 v[42:43], v24 offset:45312
    s_waitcnt lgkmcnt(6)
    v_mfma_f32_16x16x32_bf16 v[196:199], v[56:59], a[200:203], v[196:199]
    ds_read_b64_tr_b16 v[44:45], v25 offset:45056
    v_mfma_f32_16x16x32_bf16 v[204:207], v[56:59], a[204:207], v[204:207]
    ds_read_b64_tr_b16 v[46:47], v25 offset:45312
    buffer_load_dwordx4 a[244:247], v3, s[28:31], s77 offen offset:256 sc1
    v_mfma_f32_16x16x32_bf16 v[216:219], v[60:63], a[204:207], v[216:219]
    ds_read_b64_tr_b16 v[48:49], v24 offset:53248
    v_mfma_f32_16x16x32_bf16 v[208:211], v[60:63], a[200:203], v[208:211]
    ds_read_b64_tr_b16 v[50:51], v24 offset:53504
    s_waitcnt vmcnt(14)
    v_cmp_ne_u32 vcc, v22, v19
    s_cbranch_vccnz K4_slow2
K4_ok2:
    s_waitcnt lgkmcnt(6)
    v_mfma_f32_16x16x32_bf16 v[212:215], v[32:35], a[200:203], v[212:215]
    ds_read_b64_tr_b16 v[52:53], v25 offset:53248
    buffer_load_dwordx4 a[248:251], v3, s[28:31], s77 offen offset:2048 sc1
    v_mfma_f32_16x16x32_bf16 v[220:223], v[32:35], a[204:207], v[220:223]
    ds_read_b64_tr_b16 v[54:55], v25 offset:53504
    v_mfma_f32_16x16x32_bf16 v[228:231], v[36:39], a[204:207], v[228:231]
    ds_read_b64_tr_b16 v[56:57], v24 offset:57344
    v_mfma_f32_16x16x32_bf16 v[224:227], v[36:39], a[200:203], v[224:227]
    ds_read_b64_tr_b16 v[58:59], v24 offset:57600
    s_waitcnt lgkmcnt(6)
    v_mfma_f32_16x16x32_bf16 v[176:179], v[40:43], a[208:211], v[176:179]
    ds_read_b64_tr_b16 v[60:61], v25 offset:57344
    buffer_load_dwordx4 a[252:255], v3, s[28:31], s77 offen offset:2304 sc1
    v_mfma_f32_16x16x32_bf16 v[184:187], v[40:43], a[212:215], v[184:187]
    ds_read_b64_tr_b16 v[62:63], v25 offset:57600
    v_mfma_f32_16x16x32_bf16 v[188:191], v[44:47], a[212:215], v[188:191]
    ds_read_b64_tr_b16 v[32:33], v31 offset:14336
    v_mfma_f32_16x16x32_bf16 v[180:183], v[44:47], a[208:211], v[180:183]
    ds_read_b64_tr_b16 v[34:35], v31 offset:14592
    s_waitcnt lgkmcnt(6)
    v_mfma_f32_16x16x32_bf16 v[192:195], v[48:51], a[208:211], v[192:195]
    ds_read_b64_tr_b16 v[36:37], v24 offset:47104
    buffer_load_dwordx4 v[232:235], v16, s[24:27], 0 offen sc1
    v_mfma_f32_16x16x32_bf16 v[200:203], v[48:51], a[212:215], v[200:203]
    ds_read_b64_tr_b16 v[38:39], v24 offset:47360
    v_mfma_f32_16x16x32_bf16 v[204:207], v[52:55], a[212:215], v[204:207]
    ds_read_b64_tr_b16 v[40:41], v25 offset:47104
    v_mfma_f32_16x16x32_bf16 v[196:199], v[52:55], a[208:211], v[196:199]
    ds_read_b64_tr_b16 v[42:43], v25 offset:47360
    s_waitcnt lgkmcnt(6)
    v_mfma_f32_16x16x32_bf16 v[208:211], v[56:59], a[208:211], v[208:211]
    ds_read_b64_tr_b16 v[44:45], v24 offset:55296
    buffer_load_dwordx4 v[236:239], v17, s[24:27], 0 offen sc1
    v_mfma_f32_16x16x32_bf16 v[216:219], v[56:59], a[212:215], v[216:219]
    ds_read_b64_tr_b16 v[46:47], v24 offset:55552
    v_mfma_f32_16x16x32_bf16 v[220:223], v[60:63], a[212:215], v[220:223]
    ds_read_b64_tr_b16 v[48:49], v25 offset:55296
    v_mfma_f32_16x16x32_bf16 v[212:215], v[60:63], a[208:211], v[212:215]
    ds_read_b64_tr_b16 v[50:51], v25 offset:55552
    s_waitcnt lgkmcnt(6)
    v_mfma_f32_16x16x32_bf16 v[224:227], v[32:35], a[208:211], v[224:227]
    ds_read_b64_tr_b16 v[52:53], v24 offset:59392
    buffer_load_dword v240, v18, s[24:27], 0 offen sc1
    v_mfma_f32_16x16x32_bf16 v[228:231], v[32:35], a[212:215], v[228:231]
    ds_read_b64_tr_b16 v[54:55], v24 offset:59648
    v_mfma_f32_16x16x32_bf16 v[184:187], v[36:39], a[220:223], v[184:187]
    ds_read_b64_tr_b16 v[56:57], v25 offset:59392
    v_mfma_f32_16x16x32_bf16 v[176:179], v[36:39], a[216:219], v[176:179]
    ds_read_b64_tr_b16 v[58:59], v25 offset:59648
    s_waitcnt lgkmcnt(6)
    v_mfma_f32_16x16x32_bf16 v[180:183], v[40:43], a[216:219], v[180:183]
    ds_read_b64_tr_b16 v[60:61], v31 offset:15360
    s_add_u32 m0, s42, 151552
    v_mfma_f32_16x16x32_bf16 v[188:191], v[40:43], a[220:223], v[188:191]
    ds_read_b64_tr_b16 v[62:63], v31 offset:15616
    buffer_load_dwordx4 v9, s[64:67], s78 offen lds
    s_mul_i32 s40, s78, 18
    s_waitcnt vmcnt(16)
    s_barrier
    v_mfma_f32_16x16x32_bf16 v[200:203], v[44:47], a[220:223], v[200:203]
    ds_read_b64_tr_b16 v[32:33], v26 offset:53248
    v_mfma_f32_16x16x32_bf16 v[192:195], v[44:47], a[216:219], v[192:195]
    ds_read_b64_tr_b16 v[34:35], v26 offset:53504
    s_waitcnt lgkmcnt(6)
    v_mfma_f32_16x16x32_bf16 v[196:199], v[48:51], a[216:219], v[196:199]
    ds_read_b64_tr_b16 v[36:37], v27 offset:53248
    s_add_u32 m0, s42, 77824
    v_mfma_f32_16x16x32_bf16 v[204:207], v[48:51], a[220:223], v[204:207]
    ds_read_b64_tr_b16 v[38:39], v27 offset:53504
    buffer_load_dwordx4 v5, s[16:19], s40 offen lds
    v_mfma_f32_16x16x32_bf16 v[216:219], v[52:55], a[220:223], v[216:219]
    ds_read_b64_tr_b16 v[40:41], v26 offset:57344
    v_mfma_f32_16x16x32_bf16 v[208:211], v[52:55], a[216:219], v[208:211]
    ds_read_b64_tr_b16 v[42:43], v26 offset:57600
    s_waitcnt lgkmcnt(6)
    v_mfma_f32_16x16x32_bf16 v[212:215], v[56:59], a[216:219], v[212:215]
    ds_read_b64_tr_b16 v[44:45], v27 offset:57344
    s_add_u32 m0, s42, 86016
    v_mfma_f32_16x16x32_bf16 v[220:223], v[56:59], a[220:223], v[220:223]
    ds_read_b64_tr_b16 v[46:47], v27 offset:57600
    buffer_load_dwordx4 v6, s[16:19], s40 offen lds
    v_mfma_f32_16x16x32_bf16 v[228:231], v[60:63], a[220:223], v[228:231]
    ds_read_b64_tr_b16 v[48:49], v26 offset:61440
    v_mfma_f32_16x16x32_bf16 v[224:227], v[60:63], a[216:219], v[224:227]
    ds_read_b64_tr_b16 v[50:51], v26 offset:61696
    s_waitcnt vmcnt(14)
    s_waitcnt lgkmcnt(6)
    v_mfma_f32_16x16x32_bf16 v[176:179], v[32:35], a[224:227], v[176:179]
    ds_read_b64_tr_b16 v[52:53], v27 offset:61440
    s_add_u32 m0, s42, 94208
    v_mfma_f32_16x16x32_bf16 v[184:187], v[32:35], a[228:231], v[184:187]
    ds_read_b64_tr_b16 v[54:55], v27 offset:61696
    buffer_load_dwordx4 v7, s[16:19], s40 offen lds
    v_mfma_f32_16x16x32_bf16 v[188:191], v[36:39], a[228:231], v[188:191]
    ds_read_b64_tr_b16 v[56:57], v31 offset:0
    v_mfma_f32_16x16x32_bf16 v[180:183], v[36:39], a[224:227], v[180:183]
    ds_read_b64_tr_b16 v[58:59], v31 offset:256
    s_waitcnt lgkmcnt(6)
    v_mfma_f32_16x16x32_bf16 v[192:195], v[40:43], a[224:227], v[192:195]
    ds_read_b64_tr_b16 v[60:61], v26 offset:55296
    s_add_u32 m0, s42, 102400
    v_mfma_f32_16x16x32_bf16 v[200:203], v[40:43], a[228:231], v[200:203]
    ds_read_b64_tr_b16 v[62:63], v26 offset:55552
    buffer_load_dwordx4 v8, s[16:19], s40 offen lds
    v_mfma_f32_16x16x32_bf16 v[204:207], v[44:47], a[228:231], v[204:207]
    ds_read_b64_tr_b16 v[32:33], v27 offset:55296
    v_mfma_f32_16x16x32_bf16 v[196:199], v[44:47], a[224:227], v[196:199]
    ds_read_b64_tr_b16 v[34:35], v27 offset:55552
    buffer_load_dwordx4 v[64:67], v2, s[28:31], s78 offen offset:0 sc1
    s_waitcnt lgkmcnt(6)
    v_mfma_f32_16x16x32_bf16 v[208:211], v[48:51], a[224:227], v[208:211]
    ds_read_b64_tr_b16 v[36:37], v26 offset:59392
    v_mfma_f32_16x16x32_bf16 v[216:219], v[48:51], a[228:231], v[216:219]
    ds_read_b64_tr_b16 v[38:39], v26 offset:59648
    v_mfma_f32_16x16x32_bf16 v[220:223], v[52:55], a[228:231], v[220:223]
    ds_read_b64_tr_b16 v[40:41], v27 offset:59392
    v_mfma_f32_16x16x32_bf16 v[212:215], v[52:55], a[224:227], v[212:215]
    ds_read_b64_tr_b16 v[42:43], v27 offset:59648
    buffer_load_dwordx4 v[68:71], v2, s[28:31], s78 offen offset:256 sc1
    s_waitcnt lgkmcnt(6)
    v_mfma_f32_16x16x32_bf16 v[224:227], v[56:59], a[224:227], v[224:227]
    ds_read_b64_tr_b16 v[44:45], v26 offset:63488
    v_mfma_f32_16x16x32_bf16 v[228:231], v[56:59], a[228:231], v[228:231]
    ds_read_b64_tr_b16 v[46:47], v26 offset:63744
    v_mfma_f32_16x16x32_bf16 v[184:187], v[60:63], a[236:239], v[184:187]
    ds_read_b64_tr_b16 v[48:49], v27 offset:63488
    v_mfma_f32_16x16x32_bf16 v[176:179], v[60:63], a[232:235], v[176:179]
    ds_read_b64_tr_b16 v[50:51], v27 offset:63744
    buffer_load_dwordx4 v[72:75], v2, s[28:31], s78 offen offset:2048 sc1
    s_waitcnt lgkmcnt(6)
    v_mfma_f32_16x16x32_bf16 v[180:183], v[32:35], a[232:235], v[180:183]
    ds_read_b64_tr_b16 v[52:53], v31 offset:1024
    v_mfma_f32_16x16x32_bf16 v[188:191], v[32:35], a[236:239], v[188:191]
    ds_read_b64_tr_b16 v[54:55], v31 offset:1280
    s_waitcnt vmcnt(15)
    s_barrier
    v_mfma_f32_16x16x32_bf16 v[200:203], v[36:39], a[236:239], v[200:203]
    ds_read_b64_tr_b16 v[56:57], v28 offset:8192
    v_mfma_f32_16x16x32_bf16 v[192:195], v[36:39], a[232:235], v[192:195]
    ds_read_b64_tr_b16 v[58:59], v28 offset:8448
    buffer_load_dwordx4 v[76:79], v2, s[28:31], s78 offen offset:2304 sc1
    s_waitcnt lgkmcnt(6)
    v_mfma_f32_16x16x32_bf16 v[196:199], v[40:43], a[232:235], v[196:199]
    ds_read_b64_tr_b16 v[60:61], v30 offset:8192
    v_mfma_f32_16x16x32_bf16 v[204:207], v[40:43], a[236:239], v[204:207]
    ds_read_b64_tr_b16 v[62:63], v30 offset:8448
    v_mfma_f32_16x16x32_bf16 v[216:219], v[44:47], a[236:239], v[216:219]
    ds_read_b64_tr_b16 v[32:33], v28 offset:12288
    v_mfma_f32_16x16x32_bf16 v[208:211], v[44:47], a[232:235], v[208:211]
    ds_read_b64_tr_b16 v[34:35], v28 offset:12544
    s_add_u32 m0, s42, 106496
    s_waitcnt lgkmcnt(6)
    v_mfma_f32_16x16x32_bf16 v[212:215], v[48:51], a[232:235], v[212:215]
    ds_read_b64_tr_b16 v[36:37], v30 offset:12288
    buffer_load_dwordx4 v5, s[20:23], s40 offen lds
    v_mfma_f32_16x16x32_bf16 v[220:223], v[48:51], a[236:239], v[220:223]
    ds_read_b64_tr_b16 v[38:39], v30 offset:12544
    v_mfma_f32_16x16x32_bf16 v[228:231], v[52:55], a[236:239], v[228:231]
    ds_read_b64_tr_b16 v[40:41], v26 offset:8192
    v_mfma_f32_16x16x32_bf16 v[224:227], v[52:55], a[232:235], v[224:227]
    ds_read_b64_tr_b16 v[42:43], v26 offset:8448
    s_add_u32 m0, s42, 4096
    s_waitcnt vmcnt(13)
    s_waitcnt lgkmcnt(6)
    v_mfma_f32_16x16x32_bf16 v[176:179], v[56:59], a[240:243], v[176:179]
    ds_read_b64_tr_b16 v[44:45], v27 offset:8192
    buffer_load_dwordx4 v6, s[20:23], s40 offen lds
    v_mfma_f32_16x16x32_bf16 v[184:187], v[56:59], a[244:247], v[184:187]
    ds_read_b64_tr_b16 v[46:47], v27 offset:8448
    v_mfma_f32_16x16x32_bf16 v[188:191], v[60:63], a[244:247], v[188:191]
    ds_read_b64_tr_b16 v[48:49], v31 offset:2048
    v_mfma_f32_16x16x32_bf16 v[180:183], v[60:63], a[240:243], v[180:183]
    ds_read_b64_tr_b16 v[50:51], v31 offset:2304
    s_add_u32 m0, s42, 8192
    s_waitcnt lgkmcnt(6)
    v_mfma_f32_16x16x32_bf16 v[192:195], v[32:35], a[240:243], v[192:195]
    ds_read_b64_tr_b16 v[52:53], v28 offset:10240
    buffer_load_dwordx4 v7, s[20:23], s40 offen lds
    v_mfma_f32_16x16x32_bf16 v[200:203], v[32:35], a[244:247], v[200:203]
    ds_read_b64_tr_b16 v[54:55], v28 offset:10496
    v_mfma_f32_16x16x32_bf16 v[204:207], v[36:39], a[244:247], v[204:207]
    ds_read_b64_tr_b16 v[56:57], v30 offset:10240
    v_mfma_f32_16x16x32_bf16 v[196:199], v[36:39], a[240:243], v[196:199]
    ds_read_b64_tr_b16 v[58:59], v30 offset:10496
    s_add_u32 m0, s42, 12288
    s_waitcnt lgkmcnt(6)
    v_mfma_f32_16x16x32_bf16 v[208:211], v[40:43], a[240:243], v[208:211]
    ds_read_b64_tr_b16 v[60:61], v28 offset:14336
    buffer_load_dwordx4 v8, s[20:23], s40 offen lds
    v_mfma_f32_16x16x32_bf16 v[216:219], v[40:43], a[244:247], v[216:219]
    ds_read_b64_tr_b16 v[62:63], v28 offset:14592
    v_mfma_f32_16x16x32_bf16 v[220:223], v[44:47], a[244:247], v[220:223]
    ds_read_b64_tr_b16 v[32:33], v30 offset:14336
    v_mfma_f32_16x16x32_bf16 v[212:215], v[44:47], a[240:243], v[212:215]
    ds_read_b64_tr_b16 v[34:35], v30 offset:14592
    buffer_load_dwordx4 v[80:83], v3, s[28:31], s78 offen offset:0 sc1
    s_waitcnt lgkmcnt(6)
    v_mfma_f32_16x16x32_bf16 v[224:227], v[48:51], a[240:243], v[224:227]
    ds_read_b64_tr_b16 v[36:37], v26 offset:10240
    v_mfma_f32_16x16x32_bf16 v[228:231], v[48:51], a[244:247], v[228:231]
    ds_read_b64_tr_b16 v[38:39], v26 offset:10496
    v_mfma_f32_16x16x32_bf16 v[184:187], v[52:55], a[252:255], v[184:187]
    ds_read_b64_tr_b16 v[40:41], v27 offset:10240
    v_mfma_f32_16x16x32_bf16 v[176:179], v[52:55], a[248:251], v[176:179]
    ds_read_b64_tr_b16 v[42:43], v27 offset:10496
    buffer_load_dwordx4 v[84:87], v3, s[28:31], s78 offen offset:256 sc1
    s_waitcnt lgkmcnt(6)
    v_mfma_f32_16x16x32_bf16 v[180:183], v[56:59], a[248:251], v[180:183]
    ds_read_b64_tr_b16 v[44:45], v31 offset:3072
    v_mfma_f32_16x16x32_bf16 v[188:191], v[56:59], a[252:255], v[188:191]
    ds_read_b64_tr_b16 v[46:47], v31 offset:3328
    s_waitcnt vmcnt(10)
    s_barrier
    v_mfma_f32_16x16x32_bf16 v[200:203], v[60:63], a[252:255], v[200:203]
    ds_read_b64_tr_b16 v[48:49], v26 offset:20480
    buffer_load_dwordx4 v[88:91], v3, s[28:31], s78 offen offset:2048 sc1
    v_mfma_f32_16x16x32_bf16 v[192:195], v[60:63], a[248:251], v[192:195]
    ds_read_b64_tr_b16 v[50:51], v26 offset:20736
    s_waitcnt lgkmcnt(6)
    v_mfma_f32_16x16x32_bf16 v[196:199], v[32:35], a[248:251], v[196:199]
    ds_read_b64_tr_b16 v[52:53], v27 offset:20480
    v_mfma_f32_16x16x32_bf16 v[204:207], v[32:35], a[252:255], v[204:207]
    ds_read_b64_tr_b16 v[54:55], v27 offset:20736
    v_mfma_f32_16x16x32_bf16 v[216:219], v[36:39], a[252:255], v[216:219]
    ds_read_b64_tr_b16 v[56:57], v26 offset:28672
    buffer_load_dwordx4 v[92:95], v3, s[28:31], s78 offen offset:2304 sc1
    v_mfma_f32_16x16x32_bf16 v[208:211], v[36:39], a[248:251], v[208:211]
    ds_read_b64_tr_b16 v[58:59], v26 offset:28928
    s_waitcnt lgkmcnt(6)
    v_mfma_f32_16x16x32_bf16 v[212:215], v[40:43], a[248:251], v[212:215]
    ds_read_b64_tr_b16 v[60:61], v27 offset:28672
    v_mfma_f32_16x16x32_bf16 v[220:223], v[40:43], a[252:255], v[220:223]
    ds_read_b64_tr_b16 v[62:63], v27 offset:28928
    v_mfma_f32_16x16x32_bf16 v[228:231], v[44:47], a[252:255], v[228:231]
    ds_read_b64_tr_b16 v[32:33], v26 offset:36864
    v_mfma_f32_16x16x32_bf16 v[224:227], v[44:47], a[248:251], v[224:227]
    ds_read_b64_tr_b16 v[34:35], v26 offset:37120
    s_waitcnt vmcnt(8)
    s_waitcnt lgkmcnt(6)
    v_mfma_f32_16x16x32_bf16 v[176:179], v[48:51], v[64:67], v[176:179]
    ds_read_b64_tr_b16 v[36:37], v27 offset:36864
    v_mfma_f32_16x16x32_bf16 v[184:187], v[48:51], v[68:71], v[184:187]
    ds_read_b64_tr_b16 v[38:39], v27 offset:37120
    v_mfma_f32_16x16x32_bf16 v[188:191], v[52:55], v[68:71], v[188:191]
    ds_read_b64_tr_b16 v[40:41], v31 offset:4096
    v_mfma_f32_16x16x32_bf16 v[180:183], v[52:55], v[64:67], v[180:183]
    ds_read_b64_tr_b16 v[42:43], v31 offset:4352
    s_waitcnt lgkmcnt(6)
    v_mfma_f32_16x16x32_bf16 v[192:195], v[56:59], v[64:67], v[192:195]
    ds_read_b64_tr_b16 v[44:45], v26 offset:22528
    v_mfma_f32_16x16x32_bf16 v[200:203], v[56:59], v[68:71], v[200:203]
    ds_read_b64_tr_b16 v[46:47], v26 offset:22784
    v_permlane16_swap_b32 v232, v234
    v_mfma_f32_16x16x32_bf16 v[204:207], v[60:63], v[68:71], v[204:207]
    ds_read_b64_tr_b16 v[48:49], v27 offset:22528
    v_permlane16_swap_b32 v233, v235
    v_mfma_f32_16x16x32_bf16 v[196:199], v[60:63], v[64:67], v[196:199]
    ds_read_b64_tr_b16 v[50:51], v27 offset:22784
    v_permlane16_swap_b32 v236, v238
    s_waitcnt lgkmcnt(6)
    v_mfma_f32_16x16x32_bf16 v[208:211], v[32:35], v[64:67], v[208:211]
    ds_read_b64_tr_b16 v[52:53], v26 offset:30720
    v_permlane16_swap_b32 v237, v239
    v_mfma_f32_16x16x32_bf16 v[216:219], v[32:35], v[68:71], v[216:219]
    ds_read_b64_tr_b16 v[54:55], v26 offset:30976
    v_lshlrev_b32 v160, 16, v232
    v_mfma_f32_16x16x32_bf16 v[220:223], v[36:39], v[68:71], v[220:223]
    ds_read_b64_tr_b16 v[56:57], v27 offset:30720
    v_and_b32 v161, 0xffff0000, v232
    v_mfma_f32_16x16x32_bf16 v[212:215], v[36:39], v[64:67], v[212:215]
    ds_read_b64_tr_b16 v[58:59], v27 offset:30976
    v_lshlrev_b32 v162, 16, v233
    s_waitcnt lgkmcnt(6)
    v_mfma_f32_16x16x32_bf16 v[224:227], v[40:43], v[64:67], v[224:227]
    ds_read_b64_tr_b16 v[60:61], v26 offset:38912
    v_and_b32 v163, 0xffff0000, v233
    v_mfma_f32_16x16x32_bf16 v[228:231], v[40:43], v[68:71], v[228:231]
    ds_read_b64_tr_b16 v[62:63], v26 offset:39168
    v_lshlrev_b32 v164, 16, v234
    v_mfma_f32_16x16x32_bf16 v[184:187], v[44:47], v[76:79], v[184:187]
    ds_read_b64_tr_b16 v[32:33], v27 offset:38912
    v_and_b32 v165, 0xffff0000, v234
    v_mfma_f32_16x16x32_bf16 v[176:179], v[44:47], v[72:75], v[176:179]
    ds_read_b64_tr_b16 v[34:35], v27 offset:39168
    v_lshlrev_b32 v166, 16, v235
    s_waitcnt lgkmcnt(6)
    v_mfma_f32_16x16x32_bf16 v[180:183], v[48:51], v[72:75], v[180:183]
    ds_read_b64_tr_b16 v[36:37], v31 offset:5120
    v_and_b32 v167, 0xffff0000, v235
    v_mfma_f32_16x16x32_bf16 v[188:191], v[48:51], v[76:79], v[188:191]
    ds_read_b64_tr_b16 v[38:39], v31 offset:5376
    v_lshlrev_b32 v168, 16, v236
    s_waitcnt vmcnt(4)
    s_barrier
    v_mfma_f32_16x16x32_bf16 v[200:203], v[52:55], v[76:79], v[200:203]
    ds_read_b64_tr_b16 v[40:41], v24 offset:4096
    v_and_b32 v169, 0xffff0000, v236
    v_mfma_f32_16x16x32_bf16 v[192:195], v[52:55], v[72:75], v[192:195]
    ds_read_b64_tr_b16 v[42:43], v24 offset:4352
    v_lshlrev_b32 v170, 16, v237
    s_waitcnt lgkmcnt(6)
    v_mfma_f32_16x16x32_bf16 v[196:199], v[56:59], v[72:75], v[196:199]
    ds_read_b64_tr_b16 v[44:45], v25 offset:4096
    v_and_b32 v171, 0xffff0000, v237
    v_mfma_f32_16x16x32_bf16 v[204:207], v[56:59], v[76:79], v[204:207]
    ds_read_b64_tr_b16 v[46:47], v25 offset:4352
    v_lshlrev_b32 v172, 16, v238
    v_mfma_f32_16x16x32_bf16 v[216:219], v[60:63], v[76:79], v[216:219]
    ds_read_b64_tr_b16 v[48:49], v24 offset:6144
    v_and_b32 v173, 0xffff0000, v238
    v_mfma_f32_16x16x32_bf16 v[208:211], v[60:63], v[72:75], v[208:211]
    ds_read_b64_tr_b16 v[50:51], v24 offset:6400
    v_lshlrev_b32 v174, 16, v239
    s_waitcnt lgkmcnt(6)
    v_mfma_f32_16x16x32_bf16 v[212:215], v[32:35], v[72:75], v[212:215]
    ds_read_b64_tr_b16 v[52:53], v25 offset:6144
    v_and_b32 v175, 0xffff0000, v239
    v_mfma_f32_16x16x32_bf16 v[220:223], v[32:35], v[76:79], v[220:223]
    ds_read_b64_tr_b16 v[54:55], v25 offset:6400
    v_lshlrev_b32 v242, 16, v240
    v_mfma_f32_16x16x32_bf16 v[228:231], v[36:39], v[76:79], v[228:231]
    ds_read_b64_tr_b16 v[56:57], v24 offset:8192
    v_and_b32 v243, 0xffff0000, v240
    v_mfma_f32_16x16x32_bf16 v[224:227], v[36:39], v[72:75], v[224:227]
    ds_read_b64_tr_b16 v[58:59], v24 offset:8448
    s_waitcnt vmcnt(0)
    s_waitcnt lgkmcnt(6)
    v_mfma_f32_16x16x32_bf16 v[176:179], v[40:43], v[80:83], v[176:179]
    ds_read_b64_tr_b16 v[60:61], v25 offset:8192
    v_mfma_f32_16x16x32_bf16 v[184:187], v[40:43], v[84:87], v[184:187]
    ds_read_b64_tr_b16 v[62:63], v25 offset:8448
    v_mfma_f32_16x16x32_bf16 v[188:191], v[44:47], v[84:87], v[188:191]
    ds_read_b64_tr_b16 v[32:33], v24 offset:10240
    v_mfma_f32_16x16x32_bf16 v[180:183], v[44:47], v[80:83], v[180:183]
    ds_read_b64_tr_b16 v[34:35], v24 offset:10496
    s_waitcnt lgkmcnt(6)
    v_mfma_f32_16x16x32_bf16 v[176:179], v[48:51], v[88:91], v[176:179]
    ds_read_b64_tr_b16 v[36:37], v25 offset:10240
    v_mfma_f32_16x16x32_bf16 v[184:187], v[48:51], v[92:95], v[184:187]
    ds_read_b64_tr_b16 v[38:39], v25 offset:10496
    v_mfma_f32_16x16x32_bf16 v[188:191], v[52:55], v[92:95], v[188:191]
    ds_read_b64_tr_b16 v[40:41], v24 offset:12288
    v_mfma_f32_16x16x32_bf16 v[180:183], v[52:55], v[88:91], v[180:183]
    ds_read_b64_tr_b16 v[42:43], v24 offset:12544
    s_waitcnt lgkmcnt(6)
    v_mfma_f32_16x16x32_bf16 v[192:195], v[56:59], v[80:83], v[192:195]
    ds_read_b64_tr_b16 v[44:45], v25 offset:12288
    v_cvt_pk_bf16_f32 v128, v176, v177
    v_cvt_pk_bf16_f32 v129, v178, v179
    v_mfma_f32_16x16x32_bf16 v[200:203], v[56:59], v[84:87], v[200:203]
    ds_read_b64_tr_b16 v[46:47], v25 offset:12544
    v_cvt_pk_bf16_f32 v130, v180, v181
    v_cvt_pk_bf16_f32 v131, v182, v183
    v_min_u32 v128, -2, v128
    v_mfma_f32_16x16x32_bf16 v[204:207], v[60:63], v[84:87], v[204:207]
    ds_read_b64_tr_b16 v[48:49], v24 offset:14336
    v_min_u32 v129, -2, v129
    v_min_u32 v130, -2, v130
    v_min_u32 v131, -2, v131
    v_mfma_f32_16x16x32_bf16 v[196:199], v[60:63], v[80:83], v[196:199]
    ds_read_b64_tr_b16 v[50:51], v24 offset:14592
    buffer_store_dwordx4 v[128:131], v13, s[56:59], s36 offen offset:0 sc1
    v_cvt_pk_bf16_f32 v132, v184, v185
    v_cvt_pk_bf16_f32 v133, v186, v187
    s_waitcnt lgkmcnt(6)
    v_mfma_f32_16x16x32_bf16 v[192:195], v[32:35], v[88:91], v[192:195]
    ds_read_b64_tr_b16 v[52:53], v25 offset:14336
    v_cvt_pk_bf16_f32 v134, v188, v189
    v_cvt_pk_bf16_f32 v135, v190, v191
    v_min_u32 v132, -2, v132
    v_mfma_f32_16x16x32_bf16 v[200:203], v[32:35], v[92:95], v[200:203]
    ds_read_b64_tr_b16 v[54:55], v25 offset:14592
    v_min_u32 v133, -2, v133
    v_min_u32 v134, -2, v134
    v_min_u32 v135, -2, v135
    v_mfma_f32_16x16x32_bf16 v[204:207], v[36:39], v[92:95], v[204:207]
    ds_read_b64_tr_b16 v[56:57], v31 offset:6144
    buffer_store_dwordx4 v[132:135], v13, s[56:59], s36 offen offset:1024 sc1
    v_mfma_f32_16x16x32_bf16 v[196:199], v[36:39], v[88:91], v[196:199]
    ds_read_b64_tr_b16 v[58:59], v31 offset:6400
    s_waitcnt lgkmcnt(6)
    v_mfma_f32_16x16x32_bf16 v[208:211], v[40:43], v[80:83], v[208:211]
    ds_read_b64_tr_b16 v[60:61], v31 offset:7168
    v_cvt_pk_bf16_f32 v136, v192, v193
    v_cvt_pk_bf16_f32 v137, v194, v195
    v_mfma_f32_16x16x32_bf16 v[216:219], v[40:43], v[84:87], v[216:219]
    ds_read_b64_tr_b16 v[62:63], v31 offset:7424
    v_cvt_pk_bf16_f32 v138, v196, v197
    v_cvt_pk_bf16_f32 v139, v198, v199
    v_min_u32 v136, -2, v136
    v_mfma_f32_16x16x32_bf16 v[220:223], v[44:47], v[84:87], v[220:223]
    ds_read_b64_tr_b16 v[32:33], v26 offset:0
    v_min_u32 v137, -2, v137
    v_min_u32 v138, -2, v138
    v_min_u32 v139, -2, v139
    v_mfma_f32_16x16x32_bf16 v[212:215], v[44:47], v[80:83], v[212:215]
    ds_read_b64_tr_b16 v[34:35], v26 offset:256
    buffer_store_dwordx4 v[136:139], v13, s[56:59], s37 offen offset:0 sc1
    v_cvt_pk_bf16_f32 v140, v200, v201
    v_cvt_pk_bf16_f32 v141, v202, v203
    s_waitcnt lgkmcnt(6)
    v_mfma_f32_16x16x32_bf16 v[208:211], v[48:51], v[88:91], v[208:211]
    ds_read_b64_tr_b16 v[36:37], v27 offset:0
    v_cvt_pk_bf16_f32 v142, v204, v205
    v_cvt_pk_bf16_f32 v143, v206, v207
    v_min_u32 v140, -2, v140
    v_mfma_f32_16x16x32_bf16 v[216:219], v[48:51], v[92:95], v[216:219]
    s_branch K4_ps11
K4_pg11:
    s_branch K4_vrB
K4_ps11:
    ds_read_b64_tr_b16 v[38:39], v27 offset:256
    v_min_u32 v141, -2, v141
    v_min_u32 v142, -2, v142
    v_min_u32 v143, -2, v143
    v_mfma_f32_16x16x32_bf16 v[220:223], v[52:55], v[92:95], v[220:223]
    ds_read_b64_tr_b16 v[40:41], v26 offset:2048
    buffer_store_dwordx4 v[140:143], v13, s[56:59], s37 offen offset:1024 sc1
    v_mfma_f32_16x16x32_bf16 v[212:215], v[52:55], v[88:91], v[212:215]
    ds_read_b64_tr_b16 v[42:43], v26 offset:2304
    s_waitcnt lgkmcnt(6)
    v_mfma_f32_16x16x32_bf16 v[224:227], v[56:59], v[80:83], v[224:227]
    ds_read_b64_tr_b16 v[44:45], v27 offset:2048
    v_cvt_pk_bf16_f32 v144, v208, v209
    v_cvt_pk_bf16_f32 v145, v210, v211
    v_mfma_f32_16x16x32_bf16 v[228:231], v[56:59], v[84:87], v[228:231]
    ds_read_b64_tr_b16 v[46:47], v27 offset:2304
    v_cvt_pk_bf16_f32 v146, v212, v213
    v_cvt_pk_bf16_f32 v147, v214, v215
    v_min_u32 v144, -2, v144
    v_mfma_f32_16x16x32_bf16 v[224:227], v[60:63], v[88:91], v[224:227]
    ds_read_b64_tr_b16 v[48:49], v26 offset:16384
    v_min_u32 v145, -2, v145
    v_min_u32 v146, -2, v146
    v_min_u32 v147, -2, v147
    v_mfma_f32_16x16x32_bf16 v[228:231], v[60:63], v[92:95], v[228:231]
    ds_read_b64_tr_b16 v[50:51], v26 offset:16640
    buffer_store_dwordx4 v[144:147], v13, s[56:59], s38 offen offset:0 sc1
    v_cvt_pk_bf16_f32 v148, v216, v217
    v_cvt_pk_bf16_f32 v149, v218, v219
    s_waitcnt lgkmcnt(6)
    v_mfma_f32_16x16x32_bf16 v[160:163], v[32:35], a[0:3], v[160:163]
    ds_read_b64_tr_b16 v[52:53], v27 offset:16384
    v_cvt_pk_bf16_f32 v150, v220, v221
    v_cvt_pk_bf16_f32 v151, v222, v223
    v_min_u32 v148, -2, v148
    v_mfma_f32_16x16x32_bf16 v[168:171], v[32:35], a[4:7], v[168:171]
    ds_read_b64_tr_b16 v[54:55], v27 offset:16640
    v_min_u32 v149, -2, v149
    v_min_u32 v150, -2, v150
    v_min_u32 v151, -2, v151
    v_mfma_f32_16x16x32_bf16 v[172:175], v[36:39], a[4:7], v[172:175]
    ds_read_b64_tr_b16 v[56:57], v26 offset:18432
    buffer_store_dwordx4 v[148:151], v13, s[56:59], s38 offen offset:1024 sc1
    v_cvt_pk_bf16_f32 v152, v224, v225
    v_cvt_pk_bf16_f32 v153, v226, v227
    v_mfma_f32_16x16x32_bf16 v[164:167], v[36:39], a[0:3], v[164:167]
    ds_read_b64_tr_b16 v[58:59], v26 offset:18688
    v_cvt_pk_bf16_f32 v154, v228, v229
    v_cvt_pk_bf16_f32 v155, v230, v231
    v_min_u32 v152, -2, v152
    s_waitcnt lgkmcnt(6)
    v_mfma_f32_16x16x32_bf16 v[160:163], v[40:43], a[8:11], v[160:163]
    ds_read_b64_tr_b16 v[60:61], v27 offset:18432
    v_min_u32 v153, -2, v153
    v_min_u32 v154, -2, v154
    v_min_u32 v155, -2, v155
    v_mfma_f32_16x16x32_bf16 v[168:171], v[40:43], a[12:15], v[168:171]
    ds_read_b64_tr_b16 v[62:63], v27 offset:18688
    buffer_store_dwordx4 v[152:155], v13, s[56:59], s39 offen offset:0 sc1
    v_mfma_f32_16x16x32_bf16 v[172:175], v[44:47], a[12:15], v[172:175]
    ds_read_b64_tr_b16 v[32:33], v26 offset:32768
    v_mfma_f32_16x16x32_bf16 v[164:167], v[44:47], a[8:11], v[164:167]
    ds_read_b64_tr_b16 v[34:35], v26 offset:33024
    s_waitcnt lgkmcnt(6)
    v_mfma_f32_16x16x32_bf16 v[160:163], v[48:51], a[16:19], v[160:163]
    ds_read_b64_tr_b16 v[36:37], v27 offset:32768
    v_mfma_f32_16x16x32_bf16 v[168:171], v[48:51], a[20:23], v[168:171]
    ds_read_b64_tr_b16 v[38:39], v27 offset:33024
    v_mfma_f32_16x16x32_bf16 v[172:175], v[52:55], a[20:23], v[172:175]
    ds_read_b64_tr_b16 v[40:41], v26 offset:34816
    v_mfma_f32_16x16x32_bf16 v[164:167], v[52:55], a[16:19], v[164:167]
    ds_read_b64_tr_b16 v[42:43], v26 offset:35072
    s_waitcnt lgkmcnt(6)
    v_mfma_f32_16x16x32_bf16 v[160:163], v[56:59], a[24:27], v[160:163]
    ds_read_b64_tr_b16 v[44:45], v27 offset:34816
    v_mfma_f32_16x16x32_bf16 v[168:171], v[56:59], a[28:31], v[168:171]
    ds_read_b64_tr_b16 v[46:47], v27 offset:35072
    v_mfma_f32_16x16x32_bf16 v[172:175], v[60:63], a[28:31], v[172:175]
    ds_read_b64_tr_b16 v[48:49], v24 offset:0
    v_mfma_f32_16x16x32_bf16 v[164:167], v[60:63], a[24:27], v[164:167]
    ds_read_b64_tr_b16 v[50:51], v24 offset:256
    s_waitcnt lgkmcnt(6)
    v_mfma_f32_16x16x32_bf16 v[160:163], v[32:35], a[32:35], v[160:163]
    ds_read_b64_tr_b16 v[52:53], v25 offset:0
    v_mfma_f32_16x16x32_bf16 v[168:171], v[32:35], a[36:39], v[168:171]
    ds_read_b64_tr_b16 v[54:55], v25 offset:256
    v_mfma_f32_16x16x32_bf16 v[172:175], v[36:39], a[36:39], v[172:175]
    ds_read_b64_tr_b16 v[56:57], v24 offset:2048
    v_mfma_f32_16x16x32_bf16 v[164:167], v[36:39], a[32:35], v[164:167]
    ds_read_b64_tr_b16 v[58:59], v24 offset:2304
    s_waitcnt lgkmcnt(6)
    v_mfma_f32_16x16x32_bf16 v[160:163], v[40:43], a[40:43], v[160:163]
    ds_read_b64_tr_b16 v[60:61], v25 offset:2048
    v_mfma_f32_16x16x32_bf16 v[168:171], v[40:43], a[44:47], v[168:171]
    ds_read_b64_tr_b16 v[62:63], v25 offset:2304
    v_mfma_f32_16x16x32_bf16 v[172:175], v[44:47], a[44:47], v[172:175]
    ds_read_b64_tr_b16 v[32:33], v24 offset:16384
    v_mfma_f32_16x16x32_bf16 v[164:167], v[44:47], a[40:43], v[164:167]
    ds_read_b64_tr_b16 v[34:35], v24 offset:16640
    s_waitcnt lgkmcnt(6)
    v_mfma_f32_16x16x32_bf16 v[160:163], v[48:51], a[48:51], v[160:163]
    ds_read_b64_tr_b16 v[36:37], v25 offset:16384
    v_mfma_f32_16x16x32_bf16 v[168:171], v[48:51], a[52:55], v[168:171]
    ds_read_b64_tr_b16 v[38:39], v25 offset:16640
    v_mfma_f32_16x16x32_bf16 v[172:175], v[52:55], a[52:55], v[172:175]
    ds_read_b64_tr_b16 v[40:41], v24 offset:18432
    v_mfma_f32_16x16x32_bf16 v[164:167], v[52:55], a[48:51], v[164:167]
    ds_read_b64_tr_b16 v[42:43], v24 offset:18688
    s_waitcnt lgkmcnt(6)
    v_mfma_f32_16x16x32_bf16 v[160:163], v[56:59], a[56:59], v[160:163]
    ds_read_b64_tr_b16 v[44:45], v25 offset:18432
    v_mfma_f32_16x16x32_bf16 v[168:171], v[56:59], a[60:63], v[168:171]
    ds_read_b64_tr_b16 v[46:47], v25 offset:18688
    v_mfma_f32_16x16x32_bf16 v[172:175], v[60:63], a[60:63], v[172:175]
    ds_read_b64_tr_b16 v[48:49], v24 offset:32768
    v_mfma_f32_16x16x32_bf16 v[164:167], v[60:63], a[56:59], v[164:167]
    ds_read_b64_tr_b16 v[50:51], v24 offset:33024
    s_waitcnt lgkmcnt(6)
    v_mfma_f32_16x16x32_bf16 v[160:163], v[32:35], a[64:67], v[160:163]
    ds_read_b64_tr_b16 v[52:53], v25 offset:32768
    v_mfma_f32_16x16x32_bf16 v[168:171], v[32:35], a[68:71], v[168:171]
    ds_read_b64_tr_b16 v[54:55], v25 offset:33024
    v_mfma_f32_16x16x32_bf16 v[172:175], v[36:39], a[68:71], v[172:175]
    ds_read_b64_tr_b16 v[56:57], v24 offset:34816
    v_mfma_f32_16x16x32_bf16 v[164:167], v[36:39], a[64:67], v[164:167]
    ds_read_b64_tr_b16 v[58:59], v24 offset:35072
    s_waitcnt lgkmcnt(6)
    v_mfma_f32_16x16x32_bf16 v[160:163], v[40:43], a[72:75], v[160:163]
    ds_read_b64_tr_b16 v[60:61], v25 offset:34816
    v_mfma_f32_16x16x32_bf16 v[168:171], v[40:43], a[76:79], v[168:171]
    ds_read_b64_tr_b16 v[62:63], v25 offset:35072
    v_mfma_f32_16x16x32_bf16 v[172:175], v[44:47], a[76:79], v[172:175]
    ds_read_b64_tr_b16 v[32:33], v24 offset:49152
    v_mfma_f32_16x16x32_bf16 v[164:167], v[44:47], a[72:75], v[164:167]
    ds_read_b64_tr_b16 v[34:35], v24 offset:49408
    s_waitcnt lgkmcnt(6)
    v_mfma_f32_16x16x32_bf16 v[160:163], v[48:51], a[80:83], v[160:163]
    ds_read_b64_tr_b16 v[36:37], v25 offset:49152
    v_mfma_f32_16x16x32_bf16 v[168:171], v[48:51], a[84:87], v[168:171]
    ds_read_b64_tr_b16 v[38:39], v25 offset:49408
    v_mfma_f32_16x16x32_bf16 v[172:175], v[52:55], a[84:87], v[172:175]
    ds_read_b64_tr_b16 v[40:41], v24 offset:51200
    v_mfma_f32_16x16x32_bf16 v[164:167], v[52:55], a[80:83], v[164:167]
    ds_read_b64_tr_b16 v[42:43], v24 offset:51456
    s_waitcnt lgkmcnt(6)
    v_mfma_f32_16x16x32_bf16 v[160:163], v[56:59], a[88:91], v[160:163]
    ds_read_b64_tr_b16 v[44:45], v25 offset:51200
    v_mfma_f32_16x16x32_bf16 v[168:171], v[56:59], a[92:95], v[168:171]
    ds_read_b64_tr_b16 v[46:47], v25 offset:51456
    v_mfma_f32_16x16x32_bf16 v[172:175], v[60:63], a[92:95], v[172:175]
    ds_read_b64_tr_b16 v[48:49], v26 offset:49152
    v_mfma_f32_16x16x32_bf16 v[164:167], v[60:63], a[88:91], v[164:167]
    ds_read_b64_tr_b16 v[50:51], v26 offset:49408
    s_waitcnt lgkmcnt(6)
    v_mfma_f32_16x16x32_bf16 v[160:163], v[32:35], a[96:99], v[160:163]
    ds_read_b64_tr_b16 v[52:53], v27 offset:49152
    v_mfma_f32_16x16x32_bf16 v[168:171], v[32:35], a[100:103], v[168:171]
    ds_read_b64_tr_b16 v[54:55], v27 offset:49408
    v_mfma_f32_16x16x32_bf16 v[172:175], v[36:39], a[100:103], v[172:175]
    ds_read_b64_tr_b16 v[56:57], v26 offset:51200
    v_mfma_f32_16x16x32_bf16 v[164:167], v[36:39], a[96:99], v[164:167]
    ds_read_b64_tr_b16 v[58:59], v26 offset:51456
    s_waitcnt lgkmcnt(6)
    v_mfma_f32_16x16x32_bf16 v[160:163], v[40:43], a[104:107], v[160:163]
    ds_read_b64_tr_b16 v[60:61], v27 offset:51200
    v_mfma_f32_16x16x32_bf16 v[168:171], v[40:43], a[108:111], v[168:171]
    ds_read_b64_tr_b16 v[62:63], v27 offset:51456
    v_mfma_f32_16x16x32_bf16 v[172:175], v[44:47], a[108:111], v[172:175]
    ds_read_b64_tr_b16 v[32:33], v28 offset:0
    v_mfma_f32_16x16x32_bf16 v[164:167], v[44:47], a[104:107], v[164:167]
    ds_read_b64_tr_b16 v[34:35], v28 offset:256
    s_waitcnt lgkmcnt(6)
    v_mfma_f32_16x16x32_bf16 v[160:163], v[48:51], a[112:115], v[160:163]
    ds_read_b64_tr_b16 v[36:37], v30 offset:0
    v_mfma_f32_16x16x32_bf16 v[168:171], v[48:51], a[116:119], v[168:171]
    ds_read_b64_tr_b16 v[38:39], v30 offset:256
    v_mfma_f32_16x16x32_bf16 v[172:175], v[52:55], a[116:119], v[172:175]
    ds_read_b64_tr_b16 v[40:41], v28 offset:2048
    v_mfma_f32_16x16x32_bf16 v[164:167], v[52:55], a[112:115], v[164:167]
    ds_read_b64_tr_b16 v[42:43], v28 offset:2304
    s_waitcnt lgkmcnt(6)
    v_mfma_f32_16x16x32_bf16 v[160:163], v[56:59], a[120:123], v[160:163]
    ds_read_b64_tr_b16 v[44:45], v30 offset:2048
    v_mfma_f32_16x16x32_bf16 v[168:171], v[56:59], a[124:127], v[168:171]
    ds_read_b64_tr_b16 v[46:47], v30 offset:2304
    v_mfma_f32_16x16x32_bf16 v[172:175], v[60:63], a[124:127], v[172:175]
    ds_read_b64_tr_b16 v[48:49], v26 offset:4096
    v_mfma_f32_16x16x32_bf16 v[164:167], v[60:63], a[120:123], v[164:167]
    ds_read_b64_tr_b16 v[50:51], v26 offset:4352
    s_waitcnt lgkmcnt(6)
    v_mfma_f32_16x16x32_bf16 v[160:163], v[32:35], a[128:131], v[160:163]
    ds_read_b64_tr_b16 v[52:53], v27 offset:4096
    v_mfma_f32_16x16x32_bf16 v[168:171], v[32:35], a[132:135], v[168:171]
    ds_read_b64_tr_b16 v[54:55], v27 offset:4352
    v_mfma_f32_16x16x32_bf16 v[172:175], v[36:39], a[132:135], v[172:175]
    ds_read_b64_tr_b16 v[56:57], v26 offset:6144
    v_mfma_f32_16x16x32_bf16 v[164:167], v[36:39], a[128:131], v[164:167]
    ds_read_b64_tr_b16 v[58:59], v26 offset:6400
    s_waitcnt lgkmcnt(6)
    v_mfma_f32_16x16x32_bf16 v[160:163], v[40:43], a[136:139], v[160:163]
    ds_read_b64_tr_b16 v[60:61], v27 offset:6144
    v_mfma_f32_16x16x32_bf16 v[168:171], v[40:43], a[140:143], v[168:171]
    ds_read_b64_tr_b16 v[62:63], v27 offset:6400
    v_mfma_f32_16x16x32_bf16 v[172:175], v[44:47], a[140:143], v[172:175]
    ds_read_b64_tr_b16 v[32:33], v26 offset:24576
    v_mfma_f32_16x16x32_bf16 v[164:167], v[44:47], a[136:139], v[164:167]
    ds_read_b64_tr_b16 v[34:35], v26 offset:24832
    s_waitcnt lgkmcnt(6)
    v_mfma_f32_16x16x32_bf16 v[160:163], v[48:51], a[144:147], v[160:163]
    ds_read_b64_tr_b16 v[36:37], v27 offset:24576
    v_mfma_f32_16x16x32_bf16 v[168:171], v[48:51], a[148:151], v[168:171]
    ds_read_b64_tr_b16 v[38:39], v27 offset:24832
    v_mfma_f32_16x16x32_bf16 v[172:175], v[52:55], a[148:151], v[172:175]
    ds_read_b64_tr_b16 v[40:41], v26 offset:26624
    v_mfma_f32_16x16x32_bf16 v[164:167], v[52:55], a[144:147], v[164:167]
    ds_read_b64_tr_b16 v[42:43], v26 offset:26880
    s_waitcnt lgkmcnt(6)
    v_mfma_f32_16x16x32_bf16 v[160:163], v[56:59], a[152:155], v[160:163]
    ds_read_b64_tr_b16 v[44:45], v27 offset:26624
    v_mfma_f32_16x16x32_bf16 v[168:171], v[56:59], a[156:159], v[168:171]
    ds_read_b64_tr_b16 v[46:47], v27 offset:26880
    v_mfma_f32_16x16x32_bf16 v[172:175], v[60:63], a[156:159], v[172:175]
    ds_read_b64_tr_b16 v[48:49], v26 offset:45056
    v_mfma_f32_16x16x32_bf16 v[164:167], v[60:63], a[152:155], v[164:167]
    ds_read_b64_tr_b16 v[50:51], v26 offset:45312
    s_waitcnt lgkmcnt(6)
    v_mfma_f32_16x16x32_bf16 v[160:163], v[32:35], a[160:163], v[160:163]
    ds_read_b64_tr_b16 v[52:53], v27 offset:45056
    v_mfma_f32_16x16x32_bf16 v[168:171], v[32:35], a[164:167], v[168:171]
    ds_read_b64_tr_b16 v[54:55], v27 offset:45312
    v_mfma_f32_16x16x32_bf16 v[172:175], v[36:39], a[164:167], v[172:175]
    ds_read_b64_tr_b16 v[56:57], v26 offset:47104
    v_mfma_f32_16x16x32_bf16 v[164:167], v[36:39], a[160:163], v[164:167]
    ds_read_b64_tr_b16 v[58:59], v26 offset:47360
    s_waitcnt lgkmcnt(6)
    v_mfma_f32_16x16x32_bf16 v[160:163], v[40:43], a[168:171], v[160:163]
    ds_read_b64_tr_b16 v[60:61], v27 offset:47104
    v_mfma_f32_16x16x32_bf16 v[168:171], v[40:43], a[172:175], v[168:171]
    ds_read_b64_tr_b16 v[62:63], v27 offset:47360
    v_mfma_f32_16x16x32_bf16 v[172:175], v[44:47], a[172:175], v[172:175]
    ds_read_b64_tr_b16 v[32:33], v24 offset:20480
    v_mfma_f32_16x16x32_bf16 v[164:167], v[44:47], a[168:171], v[164:167]
    ds_read_b64_tr_b16 v[34:35], v24 offset:20736
    s_waitcnt lgkmcnt(6)
    v_mfma_f32_16x16x32_bf16 v[160:163], v[48:51], a[176:179], v[160:163]
    ds_read_b64_tr_b16 v[36:37], v25 offset:20480
    buffer_load_dwordx4 v[96:99], v13, s[56:59], s44 offen offset:0 sc1
    v_mfma_f32_16x16x32_bf16 v[168:171], v[48:51], a[180:183], v[168:171]
    ds_read_b64_tr_b16 v[38:39], v25 offset:20736
    buffer_load_dwordx4 v[100:103], v13, s[56:59], s44 offen offset:1024 sc1
    v_mfma_f32_16x16x32_bf16 v[172:175], v[52:55], a[180:183], v[172:175]
    ds_read_b64_tr_b16 v[40:41], v24 offset:22528
    buffer_load_dwordx4 v[104:107], v13, s[56:59], s45 offen offset:0 sc1
    v_mfma_f32_16x16x32_bf16 v[164:167], v[52:55], a[176:179], v[164:167]
    ds_read_b64_tr_b16 v[42:43], v24 offset:22784
    buffer_load_dwordx4 v[108:111], v13, s[56:59], s45 offen offset:1024 sc1
    s_waitcnt lgkmcnt(6)
    v_mfma_f32_16x16x32_bf16 v[160:163], v[56:59], a[184:187], v[160:163]
    ds_read_b64_tr_b16 v[44:45], v25 offset:22528
    buffer_load_dwordx4 v[112:115], v13, s[56:59], s46 offen offset:0 sc1
    v_mfma_f32_16x16x32_bf16 v[168:171], v[56:59], a[188:191], v[168:171]
    ds_read_b64_tr_b16 v[46:47], v25 offset:22784
    buffer_load_dwordx4 v[116:119], v13, s[56:59], s46 offen offset:1024 sc1
    v_mfma_f32_16x16x32_bf16 v[172:175], v[60:63], a[188:191], v[172:175]
    ds_read_b64_tr_b16 v[48:49], v24 offset:40960
    buffer_load_dword v120, v13, s[56:59], s47 offen offset:0 sc1
    v_mfma_f32_16x16x32_bf16 v[164:167], v[60:63], a[184:187], v[164:167]
    ds_read_b64_tr_b16 v[50:51], v24 offset:41216
    buffer_load_dword v121, v13, s[56:59], s47 offen offset:1024 sc1
    s_waitcnt lgkmcnt(6)
    v_mfma_f32_16x16x32_bf16 v[160:163], v[32:35], a[192:195], v[160:163]
    ds_read_b64_tr_b16 v[52:53], v25 offset:40960
    buffer_load_dword v122, v13, s[56:59], s47 offen offset:2048 sc1
    v_mfma_f32_16x16x32_bf16 v[168:171], v[32:35], a[196:199], v[168:171]
    ds_read_b64_tr_b16 v[54:55], v25 offset:41216
    buffer_load_dword v123, v13, s[56:59], s47 offen offset:3072 sc1
    v_mfma_f32_16x16x32_bf16 v[172:175], v[36:39], a[196:199], v[172:175]
    ds_read_b64_tr_b16 v[56:57], v24 offset:43008
    v_mfma_f32_16x16x32_bf16 v[164:167], v[36:39], a[192:195], v[164:167]
    ds_read_b64_tr_b16 v[58:59], v24 offset:43264
    s_waitcnt lgkmcnt(6)
    v_mfma_f32_16x16x32_bf16 v[160:163], v[40:43], a[200:203], v[160:163]
    ds_read_b64_tr_b16 v[60:61], v25 offset:43008
    v_mfma_f32_16x16x32_bf16 v[168:171], v[40:43], a[204:207], v[168:171]
    ds_read_b64_tr_b16 v[62:63], v25 offset:43264
    v_mfma_f32_16x16x32_bf16 v[172:175], v[44:47], a[204:207], v[172:175]
    ds_read_b64_tr_b16 v[32:33], v24 offset:61440
    v_mfma_f32_16x16x32_bf16 v[164:167], v[44:47], a[200:203], v[164:167]
    ds_read_b64_tr_b16 v[34:35], v24 offset:61696
    s_waitcnt lgkmcnt(6)
    v_mfma_f32_16x16x32_bf16 v[160:163], v[48:51], a[208:211], v[160:163]
    ds_read_b64_tr_b16 v[36:37], v25 offset:61440
    v_mfma_f32_16x16x32_bf16 v[168:171], v[48:51], a[212:215], v[168:171]
    ds_read_b64_tr_b16 v[38:39], v25 offset:61696
    v_mfma_f32_16x16x32_bf16 v[172:175], v[52:55], a[212:215], v[172:175]
    ds_read_b64_tr_b16 v[40:41], v24 offset:63488
    v_mfma_f32_16x16x32_bf16 v[164:167], v[52:55], a[208:211], v[164:167]
    ds_read_b64_tr_b16 v[42:43], v24 offset:63744
    s_waitcnt lgkmcnt(6)
    v_mfma_f32_16x16x32_bf16 v[160:163], v[56:59], a[216:219], v[160:163]
    ds_read_b64_tr_b16 v[44:45], v25 offset:63488
    v_mfma_f32_16x16x32_bf16 v[168:171], v[56:59], a[220:223], v[168:171]
    ds_read_b64_tr_b16 v[46:47], v25 offset:63744
    v_mfma_f32_16x16x32_bf16 v[172:175], v[60:63], a[220:223], v[172:175]
    ds_read_b64_tr_b16 v[48:49], v28 offset:4096
    v_mfma_f32_16x16x32_bf16 v[164:167], v[60:63], a[216:219], v[164:167]
    ds_read_b64_tr_b16 v[50:51], v28 offset:4352
    s_waitcnt lgkmcnt(6)
    v_mfma_f32_16x16x32_bf16 v[160:163], v[32:35], a[224:227], v[160:163]
    ds_read_b64_tr_b16 v[52:53], v30 offset:4096
    v_mfma_f32_16x16x32_bf16 v[168:171], v[32:35], a[228:231], v[168:171]
    ds_read_b64_tr_b16 v[54:55], v30 offset:4352
    v_mfma_f32_16x16x32_bf16 v[172:175], v[36:39], a[228:231], v[172:175]
    ds_read_b64_tr_b16 v[56:57], v28 offset:6144
    v_mfma_f32_16x16x32_bf16 v[164:167], v[36:39], a[224:227], v[164:167]
    ds_read_b64_tr_b16 v[58:59], v28 offset:6400
    s_waitcnt lgkmcnt(6)
    v_mfma_f32_16x16x32_bf16 v[160:163], v[40:43], a[232:235], v[160:163]
    ds_read_b64_tr_b16 v[60:61], v30 offset:6144
    v_mfma_f32_16x16x32_bf16 v[168:171], v[40:43], a[236:239], v[168:171]
    ds_read_b64_tr_b16 v[62:63], v30 offset:6400
    v_mfma_f32_16x16x32_bf16 v[172:175], v[44:47], a[236:239], v[172:175]
    ds_read_b64_tr_b16 v[32:33], v26 offset:12288
    v_mfma_f32_16x16x32_bf16 v[164:167], v[44:47], a[232:235], v[164:167]
    ds_read_b64_tr_b16 v[34:35], v26 offset:12544
    s_waitcnt lgkmcnt(6)
    v_mfma_f32_16x16x32_bf16 v[160:163], v[48:51], a[240:243], v[160:163]
    ds_read_b64_tr_b16 v[36:37], v27 offset:12288
    v_mfma_f32_16x16x32_bf16 v[168:171], v[48:51], a[244:247], v[168:171]
    ds_read_b64_tr_b16 v[38:39], v27 offset:12544
    v_mfma_f32_16x16x32_bf16 v[172:175], v[52:55], a[244:247], v[172:175]
    ds_read_b64_tr_b16 v[40:41], v26 offset:14336
    v_mfma_f32_16x16x32_bf16 v[164:167], v[52:55], a[240:243], v[164:167]
    ds_read_b64_tr_b16 v[42:43], v26 offset:14592
    s_waitcnt lgkmcnt(6)
    v_mfma_f32_16x16x32_bf16 v[160:163], v[56:59], a[248:251], v[160:163]
    ds_read_b64_tr_b16 v[44:45], v27 offset:14336
    v_mfma_f32_16x16x32_bf16 v[168:171], v[56:59], a[252:255], v[168:171]
    ds_read_b64_tr_b16 v[46:47], v27 offset:14592
    v_mfma_f32_16x16x32_bf16 v[172:175], v[60:63], a[252:255], v[172:175]
    ds_read_b64_tr_b16 v[48:49], v26 offset:40960
    v_mfma_f32_16x16x32_bf16 v[164:167], v[60:63], a[248:251], v[164:167]
    ds_read_b64_tr_b16 v[50:51], v26 offset:41216
    s_waitcnt lgkmcnt(6)
    v_mfma_f32_16x16x32_bf16 v[160:163], v[32:35], v[64:67], v[160:163]
    ds_read_b64_tr_b16 v[52:53], v27 offset:40960
    v_mfma_f32_16x16x32_bf16 v[168:171], v[32:35], v[68:71], v[168:171]
    ds_read_b64_tr_b16 v[54:55], v27 offset:41216
    v_mfma_f32_16x16x32_bf16 v[172:175], v[36:39], v[68:71], v[172:175]
    ds_read_b64_tr_b16 v[56:57], v26 offset:43008
    v_mfma_f32_16x16x32_bf16 v[164:167], v[36:39], v[64:67], v[164:167]
    ds_read_b64_tr_b16 v[58:59], v26 offset:43264
    s_waitcnt lgkmcnt(6)
    v_mfma_f32_16x16x32_bf16 v[160:163], v[40:43], v[72:75], v[160:163]
    ds_read_b64_tr_b16 v[60:61], v27 offset:43008
    v_mfma_f32_16x16x32_bf16 v[168:171], v[40:43], v[76:79], v[168:171]
    ds_read_b64_tr_b16 v[62:63], v27 offset:43264
    v_mfma_f32_16x16x32_bf16 v[172:175], v[44:47], v[76:79], v[172:175]
    v_mfma_f32_16x16x32_bf16 v[164:167], v[44:47], v[72:75], v[164:167]
    s_waitcnt lgkmcnt(4)
    v_mfma_f32_16x16x32_bf16 v[160:163], v[48:51], v[80:83], v[160:163]
    v_mfma_f32_16x16x32_bf16 v[168:171], v[48:51], v[84:87], v[168:171]
    v_mfma_f32_16x16x32_bf16 v[172:175], v[52:55], v[84:87], v[172:175]
    v_mfma_f32_16x16x32_bf16 v[164:167], v[52:55], v[80:83], v[164:167]
    s_waitcnt lgkmcnt(0)
    v_mfma_f32_16x16x32_bf16 v[160:163], v[56:59], v[88:91], v[160:163]
    v_mfma_f32_16x16x32_bf16 v[168:171], v[56:59], v[92:95], v[168:171]
    v_mfma_f32_16x16x32_bf16 v[172:175], v[60:63], v[92:95], v[172:175]
    v_mfma_f32_16x16x32_bf16 v[164:167], v[60:63], v[88:91], v[164:167]
K5_poll:
    s_waitcnt vmcnt(0)
    v_max3_u32 v2, v96, v97, v98
    v_max3_u32 v3, v99, v100, v101
    v_max3_u32 v2, v2, v102, v103
    v_max3_u32 v3, v3, v104, v105
    v_max3_u32 v2, v2, v106, v107
    v_max3_u32 v3, v3, v108, v109
    v_max3_u32 v2, v2, v110, v111
    v_max3_u32 v3, v3, v112, v113
    v_max3_u32 v2, v2, v114, v115
    v_max3_u32 v3, v3, v116, v117
    v_max3_u32 v2, v2, v118, v119
    v_max3_u32 v3, v3, v120, v121
    v_max3_u32 v2, v2, v122, v123
    v_max_u32 v2, v2, v3
    v_cmp_eq_u32 vcc, -1, v2
    s_cbranch_vccz K5_got
    s_cmp_eq_u32 s79, 0
    s_cbranch_scc1 K5_got
    s_sub_u32 s79, s79, 1
    buffer_load_dwordx4 v[96:99], v13, s[56:59], s44 offen offset:0 sc1
    buffer_load_dwordx4 v[100:103], v13, s[56:59], s44 offen offset:1024 sc1
    buffer_load_dwordx4 v[104:107], v13, s[56:59], s45 offen offset:0 sc1
    buffer_load_dwordx4 v[108:111], v13, s[56:59], s45 offen offset:1024 sc1
    buffer_load_dwordx4 v[112:115], v13, s[56:59], s46 offen offset:0 sc1
    buffer_load_dwordx4 v[116:119], v13, s[56:59], s46 offen offset:1024 sc1
    buffer_load_dword v120, v13, s[56:59], s47 offen offset:0 sc1
    buffer_load_dword v121, v13, s[56:59], s47 offen offset:1024 sc1
    buffer_load_dword v122, v13, s[56:59], s47 offen offset:2048 sc1
    buffer_load_dword v123, v13, s[56:59], s47 offen offset:3072 sc1
    s_branch K5_poll
K5_got:
    v_lshlrev_b32 v40, 16, v96
    v_and_b32 v41, 0xffff0000, v96
    v_lshlrev_b32 v42, 16, v97
    v_and_b32 v43, 0xffff0000, v97
    v_lshlrev_b32 v44, 16, v98
    v_and_b32 v45, 0xffff0000, v98
    v_lshlrev_b32 v46, 16, v99
    v_and_b32 v47, 0xffff0000, v99
    v_pk_add_f32 v[160:161], v[160:161], v[40:41]
    v_pk_add_f32 v[162:163], v[162:163], v[42:43]
    v_pk_add_f32 v[164:165], v[164:165], v[44:45]
    v_pk_add_f32 v[166:167], v[166:167], v[46:47]
    v_lshlrev_b32 v32, 16, v104
    v_and_b32 v33, 0xffff0000, v104
    v_lshlrev_b32 v34, 16, v105
    v_and_b32 v35, 0xffff0000, v105
    v_lshlrev_b32 v36, 16, v106
    v_and_b32 v37, 0xffff0000, v106
    v_lshlrev_b32 v38, 16, v107
    v_and_b32 v39, 0xffff0000, v107
    v_pk_add_f32 v[160:161], v[160:161], v[32:33]
    v_pk_add_f32 v[162:163], v[162:163], v[34:35]
    v_pk_add_f32 v[164:165], v[164:165], v[36:37]
    v_pk_add_f32 v[166:167], v[166:167], v[38:39]
    v_lshlrev_b32 v40, 16, v112
    v_and_b32 v41, 0xffff0000, v112
    v_lshlrev_b32 v42, 16, v113
    v_and_b32 v43, 0xffff0000, v113
    v_lshlrev_b32 v44, 16, v114
    v_and_b32 v45, 0xffff0000, v114
    v_lshlrev_b32 v46, 16, v115
    v_and_b32 v47, 0xffff0000, v115
    v_pk_add_f32 v[160:161], v[160:161], v[40:41]
    v_pk_add_f32 v[162:163], v[162:163], v[42:43]
    v_pk_add_f32 v[164:165], v[164:165], v[44:45]
    v_pk_add_f32 v[166:167], v[166:167], v[46:47]
    v_cvt_pk_bf16_f32 v232, v160, v161
    v_cvt_pk_bf16_f32 v233, v162, v163
    v_cvt_pk_bf16_f32 v234, v164, v165
    v_cvt_pk_bf16_f32 v235, v166, v167
    s_nop 1
    v_permlane16_swap_b32 v232, v234
    v_permlane16_swap_b32 v233, v235
    buffer_store_dwordx4 v[232:235], v10, s[32:35], 0 offen
    v_lshlrev_b32 v40, 16, v100
    v_and_b32 v41, 0xffff0000, v100
    v_lshlrev_b32 v42, 16, v101
    v_and_b32 v43, 0xffff0000, v101
    v_lshlrev_b32 v44, 16, v102
    v_and_b32 v45, 0xffff0000, v102
    v_lshlrev_b32 v46, 16, v103
    v_and_b32 v47, 0xffff0000, v103
    v_pk_add_f32 v[168:169], v[168:169], v[40:41]
    v_pk_add_f32 v[170:171], v[170:171], v[42:43]
    v_pk_add_f32 v[172:173], v[172:173], v[44:45]
    v_pk_add_f32 v[174:175], v[174:175], v[46:47]
    v_lshlrev_b32 v32, 16, v108
    v_and_b32 v33, 0xffff0000, v108
    v_lshlrev_b32 v34, 16, v109
    v_and_b32 v35, 0xffff0000, v109
    v_lshlrev_b32 v36, 16, v110
    v_and_b32 v37, 0xffff0000, v110
    v_lshlrev_b32 v38, 16, v111
    v_and_b32 v39, 0xffff0000, v111
    v_pk_add_f32 v[168:169], v[168:169], v[32:33]
    v_pk_add_f32 v[170:171], v[170:171], v[34:35]
    v_pk_add_f32 v[172:173], v[172:173], v[36:37]
    v_pk_add_f32 v[174:175], v[174:175], v[38:39]
    v_lshlrev_b32 v40, 16, v116
    v_and_b32 v41, 0xffff0000, v116
    v_lshlrev_b32 v42, 16, v117
    v_and_b32 v43, 0xffff0000, v117
    v_lshlrev_b32 v44, 16, v118
    v_and_b32 v45, 0xffff0000, v118
    v_lshlrev_b32 v46, 16, v119
    v_and_b32 v47, 0xffff0000, v119
    v_pk_add_f32 v[168:169], v[168:169], v[40:41]
    v_pk_add_f32 v[170:171], v[170:171], v[42:43]
    v_pk_add_f32 v[172:173], v[172:173], v[44:45]
    v_pk_add_f32 v[174:175], v[174:175], v[46:47]
    v_cvt_pk_bf16_f32 v236, v168, v169
    v_cvt_pk_bf16_f32 v237, v170, v171
    v_cvt_pk_bf16_f32 v238, v172, v173
    v_cvt_pk_bf16_f32 v239, v174, v175
    s_nop 1
    v_permlane16_swap_b32 v236, v238
    v_permlane16_swap_b32 v237, v239
    buffer_store_dwordx4 v[236:239], v11, s[32:35], 0 offen
    v_lshlrev_b32 v32, 16, v120
    v_and_b32 v33, 0xffff0000, v120
    v_lshlrev_b32 v34, 16, v121
    v_and_b32 v35, 0xffff0000, v121
    v_lshlrev_b32 v36, 16, v122
    v_and_b32 v37, 0xffff0000, v122
    v_lshlrev_b32 v38, 16, v123
    v_and_b32 v39, 0xffff0000, v123
    v_pk_add_f32 v[242:243], v[242:243], v[32:33]
    v_pk_add_f32 v[242:243], v[242:243], v[34:35]
    v_pk_add_f32 v[242:243], v[242:243], v[36:37]
    v_pk_add_f32 v[242:243], v[242:243], v[38:39]
    v_cvt_pk_bf16_f32 v240, v242, v243
    buffer_store_dword v240, v12, s[32:35], 0 offen
K5_fin:
K4_end:
    s_endpgm
K4_slowp:
    s_cmp_eq_u32 s79, 0
    s_cbranch_scc1 K4_okp
    s_sub_u32 s79, s79, 1
    buffer_load_dword v124, v123, s[72:75], s101 offen sc1
    s_waitcnt vmcnt(0)
    v_cmp_ne_u32 vcc, v22, v124
    s_cbranch_vccnz K4_slowp
    s_branch K4_okp
K4_slowk:
    s_cmp_eq_u32 s79, 0
    s_cbranch_scc1 K4_okk
    s_sub_u32 s79, s79, 1
    s_waitcnt lgkmcnt(0)
    buffer_load_dwordx4 v[32:35], v28, s[24:27], s19 offen sc1
    buffer_load_dwordx4 v[36:39], v28, s[24:27], s20 offen sc1
    buffer_load_dwordx4 v[40:43], v28, s[24:27], s21 offen sc1
    s_waitcnt vmcnt(0)
    s_branch K4_kc
K4_slowa:
    s_cmp_eq_u32 s79, 0
    s_cbranch_scc1 K4_oka
    s_sub_u32 s79, s79, 1
    buffer_load_dwordx4 v[168:171], v4, s[72:75], s35 offen sc1
    s_waitcnt vmcnt(0)
    v_xor_b32 v168, v22, v168
    v_xor_b32 v169, v22, v169
    v_xor_b32 v170, v22, v170
    v_xor_b32 v171, v22, v171
    v_or3_b32 v168, v168, v169, v170
    v_or_b32 v168, v168, v171
    v_cmp_ne_u32 vcc, 0, v168
    s_cbranch_vccnz K4_slowa
    s_branch K4_oka
K4_slowb0:
    s_cmp_eq_u32 s79, 0
    s_cbranch_scc1 K4_okb0
    s_sub_u32 s79, s79, 1
    s_add_u32 s45, s63, 4096
    buffer_load_dwordx4 a[0:3], v5, s[24:27], s63 offen offset:0 sc1
    buffer_load_dwordx4 a[4:7], v6, s[24:27], s63 offen offset:0 sc1
    buffer_load_dwordx4 a[8:11], v7, s[24:27], s63 offen offset:0 sc1
    buffer_load_dwordx4 a[12:15], v8, s[24:27], s63 offen offset:0 sc1
    buffer_load_dwordx4 a[16:19], v5, s[24:27], s63 offen offset:1024 sc1
    buffer_load_dwordx4 a[20:23], v6, s[24:27], s63 offen offset:1024 sc1
    buffer_load_dwordx4 a[24:27], v7, s[24:27], s63 offen offset:1024 sc1
    buffer_load_dwordx4 a[28:31], v8, s[24:27], s63 offen offset:1024 sc1
    buffer_load_dwordx4 a[32:35], v5, s[24:27], s63 offen offset:2048 sc1
    buffer_load_dwordx4 a[36:39], v6, s[24:27], s63 offen offset:2048 sc1
    buffer_load_dwordx4 a[40:43], v7, s[24:27], s63 offen offset:2048 sc1
    buffer_load_dwordx4 a[44:47], v8, s[24:27], s63 offen offset:2048 sc1
    buffer_load_dwordx4 a[48:51], v5, s[24:27], s63 offen offset:3072 sc1
    buffer_load_dwordx4 a[52:55], v6, s[24:27], s63 offen offset:3072 sc1
    buffer_load_dwordx4 a[56:59], v7, s[24:27], s63 offen offset:3072 sc1
    buffer_load_dwordx4 a[60:63], v8, s[24:27], s63 offen offset:3072 sc1
    s_waitcnt vmcnt(0)
    v_accvgpr_read_b32 v100, a0
    v_accvgpr_read_b32 v101, a2
    v_accvgpr_read_b32 v102, a4
    v_accvgpr_read_b32 v103, a6
    v_accvgpr_read_b32 v104, a8
    v_accvgpr_read_b32 v105, a10
    v_accvgpr_read_b32 v106, a12
    v_accvgpr_read_b32 v107, a14
    v_max3_u32 v100, v100, v101, v102
    v_max3_u32 v103, v103, v104, v105
    v_max3_u32 v100, v100, v103, v106
    v_max3_u32 v100, v100, v107, v107
    v_cmp_eq_u32 vcc, -1, v100
    s_cbranch_vccnz K4_slowb0
    s_branch K4_okb0
K4_slowb1:
    s_cmp_eq_u32 s79, 0
    s_cbranch_scc1 K4_okb1
    s_sub_u32 s79, s79, 1
    s_add_u32 s45, s63, 4096
    buffer_load_dwordx4 a[16:19], v5, s[24:27], s63 offen offset:1024 sc1
    buffer_load_dwordx4 a[20:23], v6, s[24:27], s63 offen offset:1024 sc1
    buffer_load_dwordx4 a[24:27], v7, s[24:27], s63 offen offset:1024 sc1
    buffer_load_dwordx4 a[28:31], v8, s[24:27], s63 offen offset:1024 sc1
    buffer_load_dwordx4 a[32:35], v5, s[24:27], s63 offen offset:2048 sc1
    buffer_load_dwordx4 a[36:39], v6, s[24:27], s63 offen offset:2048 sc1
    buffer_load_dwordx4 a[40:43], v7, s[24:27], s63 offen offset:2048 sc1
    buffer_load_dwordx4 a[44:47], v8, s[24:27], s63 offen offset:2048 sc1
    buffer_load_dwordx4 a[48:51], v5, s[24:27], s63 offen offset:3072 sc1
    buffer_load_dwordx4 a[52:55], v6, s[24:27], s63 offen offset:3072 sc1
    buffer_load_dwordx4 a[56:59], v7, s[24:27], s63 offen offset:3072 sc1
    buffer_load_dwordx4 a[60:63], v8, s[24:27], s63 offen offset:3072 sc1
    buffer_load_dwordx4 a[64:67], v5, s[24:27], s45 offen offset:0 sc1
    buffer_load_dwordx4 a[68:71], v6, s[24:27], s45 offen offset:0 sc1
    buffer_load_dwordx4 a[72:75], v7, s[24:27], s45 offen offset:0 sc1
    buffer_load_dwordx4 a[76:79], v8, s[24:27], s45 offen offset:0 sc1
    s_waitcnt vmcnt(0)
    v_accvgpr_read_b32 v100, a16
    v_accvgpr_read_b32 v101, a18
    v_accvgpr_read_b32 v102, a20
    v_accvgpr_read_b32 v103, a22
    v_accvgpr_read_b32 v104, a24
    v_accvgpr_read_b32 v105, a26
    v_accvgpr_read_b32 v106, a28
    v_accvgpr_read_b32 v107, a30
    v_max3_u32 v100, v100, v101, v102
    v_max3_u32 v103, v103, v104, v105
    v_max3_u32 v100, v100, v103, v106
    v_max3_u32 v100, v100, v107, v107
    v_cmp_eq_u32 vcc, -1, v100
    s_cbranch_vccnz K4_slowb1
    s_branch K4_okb1
K4_slowb2:
    s_cmp_eq_u32 s79, 0
    s_cbranch_scc1 K4_okb2
    s_sub_u32 s79, s79, 1
    s_add_u32 s45, s63, 4096
    buffer_load_dwordx4 a[32:35], v5, s[24:27], s63 offen offset:2048 sc1
    buffer_load_dwordx4 a[36:39], v6, s[24:27], s63 offen offset:2048 sc1
    buffer_load_dwordx4 a[40:43], v7, s[24:27], s63 offen offset:2048 sc1
    buffer_load_dwordx4 a[44:47], v8, s[24:27], s63 offen offset:2048 sc1
    buffer_load_dwordx4 a[48:51], v5, s[24:27], s63 offen offset:3072 sc1
    buffer_load_dwordx4 a[52:55], v6, s[24:27], s63 offen offset:3072 sc1
    buffer_load_dwordx4 a[56:59], v7, s[24:27], s63 offen offset:3072 sc1
    buffer_load_dwordx4 a[60:63], v8, s[24:27], s63 offen offset:3072 sc1
    buffer_load_dwordx4 a[64:67], v5, s[24:27], s45 offen offset:0 sc1
    buffer_load_dwordx4 a[68:71], v6, s[24:27], s45 offen offset:0 sc1
    buffer_load_dwordx4 a[72:75], v7, s[24:27], s45 offen offset:0 sc1
    buffer_load_dwordx4 a[76:79], v8, s[24:27], s45 offen offset:0 sc1
    buffer_load_dwordx4 a[80:83], v5, s[24:27], s45 offen offset:1024 sc1
    buffer_load_dwordx4 a[84:87], v6, s[24:27], s45 offen offset:1024 sc1
    buffer_load_dwordx4 a[88:91], v7, s[24:27], s45 offen offset:1024 sc1
    buffer_load_dwordx4 a[92:95], v8, s[24:27], s45 offen offset:1024 sc1
    s_waitcnt vmcnt(0)
    v_accvgpr_read_b32 v100, a32
    v_accvgpr_read_b32 v101, a34
    v_accvgpr_read_b32 v102, a36
    v_accvgpr_read_b32 v103, a38
    v_accvgpr_read_b32 v104, a40
    v_accvgpr_read_b32 v105, a42
    v_accvgpr_read_b32 v106, a44
    v_accvgpr_read_b32 v107, a46
    v_max3_u32 v100, v100, v101, v102
    v_max3_u32 v103, v103, v104, v105
    v_max3_u32 v100, v100, v103, v106
    v_max3_u32 v100, v100, v107, v107
    v_cmp_eq_u32 vcc, -1, v100
    s_cbranch_vccnz K4_slowb2
    s_branch K4_okb2
K4_slowf:
    s_cmp_eq_u32 s79, 0
    s_cbranch_scc1 K4_okf
    s_sub_u32 s79, s79, 1
    buffer_load_dword v97, v96, s[72:75], 0 offen sc1
    s_waitcnt vmcnt(0)
    v_cmp_ne_u32 vcc, v22, v97
    s_cbranch_vccnz K4_slowf
    s_branch K4_okf
K4_slowb3:
    s_cmp_eq_u32 s79, 0
    s_cbranch_scc1 K4_okb3
    s_sub_u32 s79, s79, 1
    s_add_u32 s45, s63, 4096
    buffer_load_dwordx4 a[48:51], v5, s[24:27], s63 offen offset:3072 sc1
    buffer_load_dwordx4 a[52:55], v6, s[24:27], s63 offen offset:3072 sc1
    buffer_load_dwordx4 a[56:59], v7, s[24:27], s63 offen offset:3072 sc1
    buffer_load_dwordx4 a[60:63], v8, s[24:27], s63 offen offset:3072 sc1
    buffer_load_dwordx4 a[64:67], v5, s[24:27], s45 offen offset:0 sc1
    buffer_load_dwordx4 a[68:71], v6, s[24:27], s45 offen offset:0 sc1
    buffer_load_dwordx4 a[72:75], v7, s[24:27], s45 offen offset:0 sc1
    buffer_load_dwordx4 a[76:79], v8, s[24:27], s45 offen offset:0 sc1
    buffer_load_dwordx4 a[80:83], v5, s[24:27], s45 offen offset:1024 sc1
    buffer_load_dwordx4 a[84:87], v6, s[24:27], s45 offen offset:1024 sc1
    buffer_load_dwordx4 a[88:91], v7, s[24:27], s45 offen offset:1024 sc1
    buffer_load_dwordx4 a[92:95], v8, s[24:27], s45 offen offset:1024 sc1
    s_waitcnt vmcnt(0)
    v_accvgpr_read_b32 v100, a48
    v_accvgpr_read_b32 v101, a50
    v_accvgpr_read_b32 v102, a52
    v_accvgpr_read_b32 v103, a54
    v_accvgpr_read_b32 v104, a56
    v_accvgpr_read_b32 v105, a58
    v_accvgpr_read_b32 v106, a60
    v_accvgpr_read_b32 v107, a62
    v_max3_u32 v100, v100, v101, v102
    v_max3_u32 v103, v103, v104, v105
    v_max3_u32 v100, v100, v103, v106
    v_max3_u32 v100, v100, v107, v107
    v_cmp_eq_u32 vcc, -1, v100
    s_cbranch_vccnz K4_slowb3
    s_branch K4_okb3
K4_slowb4:
    s_cmp_eq_u32 s79, 0
    s_cbranch_scc1 K4_okb4
    s_sub_u32 s79, s79, 1
    s_add_u32 s45, s63, 4096
    buffer_load_dwordx4 a[64:67], v5, s[24:27], s45 offen offset:0 sc1
    buffer_load_dwordx4 a[68:71], v6, s[24:27], s45 offen offset:0 sc1
    buffer_load_dwordx4 a[72:75], v7, s[24:27], s45 offen offset:0 sc1
    buffer_load_dwordx4 a[76:79], v8, s[24:27], s45 offen offset:0 sc1
    buffer_load_dwordx4 a[80:83], v5, s[24:27], s45 offen offset:1024 sc1
    buffer_load_dwordx4 a[84:87], v6, s[24:27], s45 offen offset:1024 sc1
    buffer_load_dwordx4 a[88:91], v7, s[24:27], s45 offen offset:1024 sc1
    buffer_load_dwordx4 a[92:95], v8, s[24:27], s45 offen offset:1024 sc1
    s_waitcnt vmcnt(0)
    v_accvgpr_read_b32 v100, a64
    v_accvgpr_read_b32 v101, a66
    v_accvgpr_read_b32 v102, a68
    v_accvgpr_read_b32 v103, a70
    v_accvgpr_read_b32 v104, a72
    v_accvgpr_read_b32 v105, a74
    v_accvgpr_read_b32 v106, a76
    v_accvgpr_read_b32 v107, a78
    v_max3_u32 v100, v100, v101, v102
    v_max3_u32 v103, v103, v104, v105
    v_max3_u32 v100, v100, v103, v106
    v_max3_u32 v100, v100, v107, v107
    v_cmp_eq_u32 vcc, -1, v100
    s_cbranch_vccnz K4_slowb4
    s_branch K4_okb4
K4_slowb5:
    s_cmp_eq_u32 s79, 0
    s_cbranch_scc1 K4_okb5
    s_sub_u32 s79, s79, 1
    s_add_u32 s45, s63, 4096
    buffer_load_dwordx4 a[80:83], v5, s[24:27], s45 offen offset:1024 sc1
    buffer_load_dwordx4 a[84:87], v6, s[24:27], s45 offen offset:1024 sc1
    buffer_load_dwordx4 a[88:91], v7, s[24:27], s45 offen offset:1024 sc1
    buffer_load_dwordx4 a[92:95], v8, s[24:27], s45 offen offset:1024 sc1
    s_waitcnt vmcnt(0)
    v_accvgpr_read_b32 v100, a80
    v_accvgpr_read_b32 v101, a82
    v_accvgpr_read_b32 v102, a84
    v_accvgpr_read_b32 v103, a86
    v_accvgpr_read_b32 v104, a88
    v_accvgpr_read_b32 v105, a90
    v_accvgpr_read_b32 v106, a92
    v_accvgpr_read_b32 v107, a94
    v_max3_u32 v100, v100, v101, v102
    v_max3_u32 v103, v103, v104, v105
    v_max3_u32 v100, v100, v103, v106
    v_max3_u32 v100, v100, v107, v107
    v_cmp_eq_u32 vcc, -1, v100
    s_cbranch_vccnz K4_slowb5
    s_branch K4_okb5
K4_slow0:
    s_cmp_eq_u32 s79, 0
    s_cbranch_scc1 K4_ok0
    s_sub_u32 s79, s79, 1
    buffer_load_dword v19, v30, s[72:75], 0 offen sc1
    s_waitcnt vmcnt(0)
    v_cmp_ne_u32 vcc, v22, v19
    s_cbranch_vccnz K4_slow0
    s_branch K4_ok0
K4_slow1:
    s_cmp_eq_u32 s79, 0
    s_cbranch_scc1 K4_ok1
    s_sub_u32 s79, s79, 1
    buffer_load_dword v19, v23, s[72:75], s100 offen sc1
    s_waitcnt vmcnt(0)
    v_cmp_ne_u32 vcc, v22, v19
    s_cbranch_vccnz K4_slow1
    s_branch K4_ok1
K4_slow2:
    s_cmp_eq_u32 s79, 0
    s_cbranch_scc1 K4_ok2
    s_sub_u32 s79, s79, 1
    buffer_load_dword v19, v15, s[72:75], s101 offen sc1
    s_waitcnt vmcnt(0)
    v_cmp_ne_u32 vcc, v22, v19
    s_cbranch_vccnz K4_slow2
    s_branch K4_ok2
CODE_END:
.section .rodata,"a"
.p2align 6
.amdhsa_kernel k4_kernel
  .amdhsa_next_free_vgpr 512
  .amdhsa_next_free_sgpr 102
  .amdhsa_accum_offset 256
  .amdhsa_group_segment_fixed_size 0
  .amdhsa_kernarg_size 104
  .amdhsa_user_sgpr_count 2
  .amdhsa_user_sgpr_kernarg_segment_ptr 1
  .amdhsa_system_sgpr_workgroup_id_x 1
  .amdhsa_float_denorm_mode_32 3
.end_amdhsa_kernel
```
